```python
import torch

def _softmax(x, axis=-1):
    return torch.softmax(x, dim=axis)
def _gelu(x):
    return torch.nn.functional.gelu(x, approximate="tanh")
def _silu(x):
    return torch.nn.functional.silu(x)
def _sigmoid(x):
    return torch.sigmoid(x)
def _layernorm(x, axis=-1, eps=1e-5):
    m = x.mean(dim=axis, keepdim=True)
    v = x.var(dim=axis, keepdim=True, unbiased=False)
    return (x - m) / torch.sqrt(v + eps)
def _scatter_add(tgt, idx, src, axis=0):
    return tgt.clone().index_add_(axis, idx, src)
def _segment_sum(src, seg, n):
    out = torch.zeros((n,) + src.shape[1:], dtype=src.dtype)
    return out.index_add_(0, seg, src)
def _pad(x, pw):
    flat = tuple(v for pair in reversed(pw) for v in pair)
    return torch.nn.functional.pad(x, flat)

kernel_name = 'gated_mix__compressed_kv_cla__gqa_block_cached__decode'

def setup_inputs():

    _w = (lambda a: (lambda t: t.to(torch.bfloat16) if t.is_floating_point() else t)(torch.as_tensor(a)))
    def _A_setup():
        B, H, Sq, Sk, D, M = 1, 32, 1, 16384, 128, 576
        Dc = 4 * D
        return {
            "x": _w((lambda *s: torch.randn(*s, dtype=torch.bfloat16) * 0.05)(B, Sq, M)),
            "c_kv": _w((lambda *s: torch.randn(*s, dtype=torch.bfloat16) * 0.2)(B, Sk, Dc)),
            "w_q": _w((lambda *s: torch.randn(*s, dtype=torch.bfloat16) * 3.2)(M, H, D) * (M ** -0.5)),
            "w_uk": _w((lambda *s: torch.randn(*s, dtype=torch.bfloat16) * 3.2)(Dc, H, D) * (Dc ** -0.5)),
            "w_uv": _w((lambda *s: torch.randn(*s, dtype=torch.bfloat16) * 0.2)(Dc, H, D) * (Dc ** -0.5)),
            "w_o": _w((lambda *s: torch.randn(*s, dtype=torch.bfloat16) * 0.2)(H, D, M) * ((H * D) ** -0.5)),
        }
    _A_in = _A_setup()

    def _B_setup():
        B, Sq, D = 1, 1, 576
        Hq, Hkv, Sk, Dh = 32, 16, 16384, 128
        assert Hq % Hkv == 0, (Hq, Hkv)
        return {
            "x": _w((lambda *s: torch.randn(*s, dtype=torch.bfloat16) * 0.05)(B, Sq, D)),
            "k_cache": _w((lambda *s: torch.randn(*s, dtype=torch.bfloat16) * 3.2)(B, Hkv, Sk, Dh)),
            "v_cache": _w((lambda *s: torch.randn(*s, dtype=torch.bfloat16) * 0.1)(B, Hkv, Sk, Dh)),
            "wq": _w((lambda *s: torch.randn(*s, dtype=torch.bfloat16) * 3.2)(D, Hq * Dh) * (D ** -0.5)),
            "wo": _w((lambda *s: torch.randn(*s, dtype=torch.bfloat16) * 0.1)(Hq * Dh, D) * ((Hq * Dh) ** -0.5)),
        }
    _B_in = _B_setup()

    return {
        "A_x": _A_in["x"],
        "A_c_kv": _A_in["c_kv"],
        "A_w_q": _A_in["w_q"],
        "A_w_uk": _A_in["w_uk"],
        "A_w_uv": _A_in["w_uv"],
        "A_w_o": _A_in["w_o"],
        "B_x": _B_in["x"],
        "B_k_cache": _B_in["k_cache"],
        "B_v_cache": _B_in["v_cache"],
        "B_wq": _B_in["wq"],
        "B_wo": _B_in["wo"],
        "gate_w": _w((lambda *s: torch.randn(*s, dtype=torch.bfloat16) * 0.05)(576) * 16.0),
    }

def reference(A_x, A_c_kv, A_w_q, A_w_uk, A_w_uv, A_w_o, B_x, B_k_cache, B_v_cache, B_wq, B_wo, gate_w):
    def _A_ref(x, c_kv, w_q, w_uk, w_uv, w_o):
        B, Sq, M = x.shape[0], x.shape[1], x.shape[2]
        Sk = c_kv.shape[1]
        H, D = w_q.shape[1], w_q.shape[2]
        q = torch.einsum("bqm,mhd->bhqd", x, w_q)
        k = torch.einsum("bkc,chd->bhkd", c_kv, w_uk)
        v = torch.einsum("bkc,chd->bhkd", c_kv, w_uv)
        scores = torch.einsum("bhqd,bhkd->bhqk", q, k) * (D ** -0.5)
        off = Sk - Sq
        qi = torch.arange(Sq)[:, None]
        kj = torch.arange(Sk)[None, :]
        cmask = kj <= (qi + off)
        scores = torch.where(cmask[None, None], scores, -1e9)
        p = _softmax(scores, axis=-1)
        ctx = torch.einsum("bhqk,bhkd->bhqd", p, v)
        return torch.einsum("bhqd,hdm->bqm", ctx, w_o)

    def _B_ref(x, k_cache, v_cache, wq, wo):
        B, Sq, D = x.shape
        Hq, Dh = 32, 128
        Hkv = k_cache.shape[1]
        rep = Hq // Hkv
        q = (lambda x, *d: x.permute(*d))((x @ wq).reshape(B, Sq, Hq, Dh), 0, 2, 1, 3)
        k = (lambda x, n, axis: torch.repeat_interleave(x, n, dim=axis))(k_cache, rep, axis=1)
        v = (lambda x, n, axis: torch.repeat_interleave(x, n, dim=axis))(v_cache, rep, axis=1)
        scores = torch.einsum("bhqd,bhkd->bhqk", q, k) * (Dh ** -0.5)
        p = _softmax(scores, axis=-1)
        o = torch.einsum("bhqk,bhkd->bhqd", p, v)
        return (lambda x, *d: x.permute(*d))(o, 0, 2, 1, 3).reshape(B, Sq, Hq * Dh) @ wo

    x = A_x
    g = _sigmoid((x * gate_w).sum(-1, keepdims=True))
    a = _A_ref(x, A_c_kv, A_w_q, A_w_uk, A_w_uv, A_w_o)
    b = _B_ref(x, B_k_cache, B_v_cache, B_wq, B_wo)
    return g * a + (1 - g) * b
```

```asm
; @launch grid=(256,1,1) block=(512,1,1) lds=141376
.amdgcn_target "amdgcn-amd-amdhsa--gfx950"
.text
.globl gated_mix__compressed_kv_cla__gqa_block_cached__decode_kernel
.p2align 8
.type gated_mix__compressed_kv_cla__gqa_block_cached__decode_kernel,@function
gated_mix__compressed_kv_cla__gqa_block_cached__decode_kernel:
    s_cmp_ge_u32 s2, 256
    s_cbranch_scc1 L_end
    s_and_b32 s54, s2, 7
    s_lshr_b32 s55, s2, 3
    s_load_dwordx2 s[12:13], s[0:1], 112
    s_load_dwordx2 s[4:5], s[0:1], 0
    s_cmp_ge_u32 s55, 12
    s_cbranch_scc0 L_wA
    s_load_dwordx2 s[8:9], s[0:1], 72
    s_load_dwordx2 s[40:41], s[0:1], 56
    s_load_dwordx2 s[44:45], s[0:1], 64
    s_load_dwordx2 s[48:49], s[0:1], 80
    s_mov_b32 s6, 0x480
    s_mov_b32 s7, 0x20000
    s_mov_b32 s10, 0x480000
    s_mov_b32 s11, 0x20000
    s_mov_b32 s14, 0x10000000
    s_mov_b32 s15, 0x20000
    s_mov_b32 s42, 0x4000000
    s_mov_b32 s43, 0x20000
    s_mov_b32 s46, 0x4000000
    s_mov_b32 s47, 0x20000
    s_mov_b32 s50, 0x480000
    s_mov_b32 s51, 0x20000
    v_and_b32 v1, 63, v0
    v_lshrrev_b32 v4, 6, v0
    v_and_b32 v2, 15, v1
    v_lshrrev_b32 v3, 4, v1
    v_readfirstlane_b32 s53, v4
    s_mov_b32 s64, 0x3e0293ee
    s_mov_b32 s65, 0x05040100
    s_mov_b32 s66, 0x07060302
    s_waitcnt lgkmcnt(0)
L_roleB:
    s_getreg_b32 s100, hwreg(HW_REG_XCC_ID)
    s_sub_u32 s60, s55, 12
    s_cmp_ge_u32 s60, 10
    s_cselect_b32 s61, 10, 0
    s_cselect_b32 s57, 8, 0
    s_sub_u32 s58, s60, s61
    s_lshl_b32 s56, s54, 4
    s_add_u32 s56, s56, s58
    s_sub_u32 s56, s56, 2
    s_add_u32 s56, s56, s57
    s_mov_b32 s98, s58
    s_cmp_ge_u32 s58, 2
    s_cselect_b32 s98, 1, 0
    s_sub_u32 s60, s55, 20
    s_cmp_lt_u32 s60, 2
    s_cselect_b32 s98, 2, s98
    s_add_u32 s57, s57, s54
    v_lshlrev_b32 v4, 4, v1
    v_add_u32 v5, 4096, v4
    s_and_b32 s60, s53, 3
    s_lshl_b32 s61, s58, 2
    s_add_u32 s60, s60, s61
    s_cmp_ge_u32 s53, 4
    s_cselect_b32 s61, 280, 0
    s_add_u32 s60, s60, s61
    s_cmp_ge_u32 s53, 4
    s_cselect_b32 s61, 280, 0
    s_sub_u32 s60, s60, s61
    s_mul_i32 s60, s60, 1024
    s_lshl_b32 s61, s61, 13
    s_add_u32 s60, s60, s61
    s_lshl_b32 s61, s57, 22
    s_add_u32 s71, s60, s61
    s_load_dword s73, s[12:13], 0
    s_cmp_eq_u32 s98, 0
    s_cbranch_scc1 L_bnu_1
    s_and_b32 s60, s56, 7
    s_or_b32 s60, s60, s53
    s_cmp_eq_u32 s60, 0
    s_cbranch_scc0 L_bci_3
    s_lshl_b32 s60, s56, 4
    s_add_u32 s60, s60, 118784
    v_lshlrev_b32 v8, 2, v1
    v_add_u32 v8, s60, v8
    v_mov_b32 v9, 0
    s_mov_b32 exec_lo, 0xffffffff
    s_mov_b32 exec_hi, 0x0
    buffer_store_dword v9, v8, s[12:15], 0 offen sc0 sc1
    s_mov_b64 exec, -1
L_bci_3:
    s_cmp_eq_u32 s98, 2
    s_cbranch_scc1 L_bwide_4
    v_lshrrev_b32 v12, 2, v1
    s_mul_i32 s60, s53, 16
    v_add_u32 v12, s60, v12
    v_lshlrev_b32 v11, 13, v12
    v_lshlrev_b32 v12, 1, v12
    v_and_b32 v13, 3, v1
    v_lshlrev_b32 v13, 4, v13
    s_and_b32 s60, s56, 127
    s_lshl_b32 s60, s60, 6
    v_add3_u32 v11, v11, v13, s60
    buffer_load_ushort v180, v12, s[4:7], 0 offen offset:0
    buffer_load_ushort v181, v12, s[4:7], 0 offen offset:256
    buffer_load_ushort v182, v12, s[4:7], 0 offen offset:512
    buffer_load_ushort v183, v12, s[4:7], 0 offen offset:768
    buffer_load_ushort v184, v12, s[4:7], 0 offen offset:1024
    s_mov_b32 s63, 0x0
    buffer_load_dwordx4 v[160:163], v11, s[8:11], s63 offen nt
    s_mov_b32 s63, 0x100000
    buffer_load_dwordx4 v[164:167], v11, s[8:11], s63 offen nt
    s_mov_b32 s63, 0x200000
    buffer_load_dwordx4 v[168:171], v11, s[8:11], s63 offen nt
    s_mov_b32 s63, 0x300000
    buffer_load_dwordx4 v[172:175], v11, s[8:11], s63 offen nt
    s_mov_b32 s63, 0x400000
    buffer_load_dwordx4 v[176:179], v11, s[8:11], s63 offen nt
    s_barrier
    s_add_u32 s63, s71, 0
    buffer_load_dwordx4 v[64:67], v4, s[40:43], s63 offen offset:0 nt
    s_add_u32 s63, s63, 40960
    buffer_load_dwordx4 v[68:71], v4, s[40:43], s63 offen offset:0 nt
    s_add_u32 s63, s63, 40960
    buffer_load_dwordx4 v[72:75], v4, s[40:43], s63 offen offset:0 nt
    s_add_u32 s63, s63, 40960
    buffer_load_dwordx4 v[76:79], v4, s[40:43], s63 offen offset:0 nt
    s_add_u32 s63, s63, 40960
    buffer_load_dwordx4 v[80:83], v4, s[40:43], s63 offen offset:0 nt
    s_add_u32 s63, s63, 40960
    buffer_load_dwordx4 v[84:87], v4, s[40:43], s63 offen offset:0 nt
    s_add_u32 s63, s63, 40960
    buffer_load_dwordx4 v[88:91], v4, s[40:43], s63 offen offset:0 nt
    s_add_u32 s63, s63, 40960
    buffer_load_dwordx4 v[92:95], v4, s[40:43], s63 offen offset:0 nt
    s_add_u32 s63, s71, 0
    buffer_load_dwordx4 v[128:131], v4, s[44:47], s63 offen offset:0 nt
    s_add_u32 s63, s63, 40960
    buffer_load_dwordx4 v[132:135], v4, s[44:47], s63 offen offset:0 nt
    s_add_u32 s63, s63, 40960
    buffer_load_dwordx4 v[136:139], v4, s[44:47], s63 offen offset:0 nt
    s_add_u32 s63, s63, 40960
    buffer_load_dwordx4 v[140:143], v4, s[44:47], s63 offen offset:0 nt
    s_add_u32 s63, s63, 40960
    buffer_load_dwordx4 v[144:147], v4, s[44:47], s63 offen offset:0 nt
    s_add_u32 s63, s63, 40960
    buffer_load_dwordx4 v[148:151], v4, s[44:47], s63 offen offset:0 nt
    s_add_u32 s63, s63, 40960
    buffer_load_dwordx4 v[152:155], v4, s[44:47], s63 offen offset:0 nt
    s_add_u32 s63, s63, 40960
    buffer_load_dwordx4 v[156:159], v4, s[44:47], s63 offen offset:0 nt
    s_waitcnt lgkmcnt(0)
    s_mul_i32 s52, s73, 1664525
    s_add_u32 s52, s52, 1013904223
    s_waitcnt vmcnt(16)
    v_lshlrev_b32 v13, 16, v180
    v_dot2_f32_bf16 v16, v160, v180, 0
    v_dot2_f32_bf16 v18, v161, v180, 0
    v_dot2_f32_bf16 v20, v162, v180, 0
    v_dot2_f32_bf16 v22, v163, v180, 0
    v_dot2_f32_bf16 v17, v160, v13, 0
    v_dot2_f32_bf16 v19, v161, v13, 0
    v_dot2_f32_bf16 v21, v162, v13, 0
    v_dot2_f32_bf16 v23, v163, v13, 0
    v_lshlrev_b32 v13, 16, v181
    v_dot2_f32_bf16 v16, v164, v181, v16
    v_dot2_f32_bf16 v18, v165, v181, v18
    v_dot2_f32_bf16 v20, v166, v181, v20
    v_dot2_f32_bf16 v22, v167, v181, v22
    v_dot2_f32_bf16 v17, v164, v13, v17
    v_dot2_f32_bf16 v19, v165, v13, v19
    v_dot2_f32_bf16 v21, v166, v13, v21
    v_dot2_f32_bf16 v23, v167, v13, v23
    v_lshlrev_b32 v13, 16, v182
    v_dot2_f32_bf16 v16, v168, v182, v16
    v_dot2_f32_bf16 v18, v169, v182, v18
    v_dot2_f32_bf16 v20, v170, v182, v20
    v_dot2_f32_bf16 v22, v171, v182, v22
    v_dot2_f32_bf16 v17, v168, v13, v17
    v_dot2_f32_bf16 v19, v169, v13, v19
    v_dot2_f32_bf16 v21, v170, v13, v21
    v_dot2_f32_bf16 v23, v171, v13, v23
    v_lshlrev_b32 v13, 16, v183
    v_dot2_f32_bf16 v16, v172, v183, v16
    v_dot2_f32_bf16 v18, v173, v183, v18
    v_dot2_f32_bf16 v20, v174, v183, v20
    v_dot2_f32_bf16 v22, v175, v183, v22
    v_dot2_f32_bf16 v17, v172, v13, v17
    v_dot2_f32_bf16 v19, v173, v13, v19
    v_dot2_f32_bf16 v21, v174, v13, v21
    v_dot2_f32_bf16 v23, v175, v13, v23
    v_lshlrev_b32 v13, 16, v184
    v_dot2_f32_bf16 v16, v176, v184, v16
    v_dot2_f32_bf16 v18, v177, v184, v18
    v_dot2_f32_bf16 v20, v178, v184, v20
    v_dot2_f32_bf16 v22, v179, v184, v22
    v_dot2_f32_bf16 v17, v176, v13, v17
    v_dot2_f32_bf16 v19, v177, v13, v19
    v_dot2_f32_bf16 v21, v178, v13, v21
    v_dot2_f32_bf16 v23, v179, v13, v23
    v_add_f32_dpp v16, v16, v16 row_ror:4 row_mask:0xf bank_mask:0xf
    v_add_f32_dpp v17, v17, v17 row_ror:4 row_mask:0xf bank_mask:0xf
    v_add_f32_dpp v18, v18, v18 row_ror:4 row_mask:0xf bank_mask:0xf
    v_add_f32_dpp v19, v19, v19 row_ror:4 row_mask:0xf bank_mask:0xf
    v_add_f32_dpp v20, v20, v20 row_ror:4 row_mask:0xf bank_mask:0xf
    v_add_f32_dpp v21, v21, v21 row_ror:4 row_mask:0xf bank_mask:0xf
    v_add_f32_dpp v22, v22, v22 row_ror:4 row_mask:0xf bank_mask:0xf
    v_add_f32_dpp v23, v23, v23 row_ror:4 row_mask:0xf bank_mask:0xf
    v_add_f32_dpp v16, v16, v16 row_ror:8 row_mask:0xf bank_mask:0xf
    v_add_f32_dpp v17, v17, v17 row_ror:8 row_mask:0xf bank_mask:0xf
    v_add_f32_dpp v18, v18, v18 row_ror:8 row_mask:0xf bank_mask:0xf
    v_add_f32_dpp v19, v19, v19 row_ror:8 row_mask:0xf bank_mask:0xf
    v_add_f32_dpp v20, v20, v20 row_ror:8 row_mask:0xf bank_mask:0xf
    v_add_f32_dpp v21, v21, v21 row_ror:8 row_mask:0xf bank_mask:0xf
    v_add_f32_dpp v22, v22, v22 row_ror:8 row_mask:0xf bank_mask:0xf
    v_add_f32_dpp v23, v23, v23 row_ror:8 row_mask:0xf bank_mask:0xf
    v_and_b32 v13, 3, v1
    v_lshlrev_b32 v13, 5, v13
    v_mul_u32_u24 v12, 128, v3
    s_mul_i32 s60, s53, 512
    s_add_u32 s60, s60, 136704
    v_add3_u32 v11, v13, v12, s60
    s_mov_b32 exec_lo, 0xf000f
    s_mov_b32 exec_hi, 0xf000f
    ds_write_b128 v11, v[16:19]
    ds_write_b128 v11, v[20:23] offset:16
    s_mov_b64 exec, -1
    s_waitcnt lgkmcnt(0)
    s_barrier
    s_cmp_eq_u32 s53, 0
    s_cbranch_scc0 L_p1pub_5
    v_mul_u32_u24 v12, 1024, v3
    v_lshlrev_b32 v13, 3, v2
    v_add3_u32 v11, v12, v13, 0
    v_add_u32 v11, 136704, v11
    ds_read_b64 v[160:161], v11 offset:0
    ds_read_b64 v[162:163], v11 offset:128
    ds_read_b64 v[164:165], v11 offset:256
    ds_read_b64 v[166:167], v11 offset:384
    ds_read_b64 v[168:169], v11 offset:512
    ds_read_b64 v[170:171], v11 offset:640
    ds_read_b64 v[172:173], v11 offset:768
    ds_read_b64 v[174:175], v11 offset:896
    s_waitcnt lgkmcnt(0)
    v_add_f32 v160, v160, v168
    v_add_f32 v161, v161, v169
    v_add_f32 v162, v162, v170
    v_add_f32 v163, v163, v171
    v_add_f32 v164, v164, v172
    v_add_f32 v165, v165, v173
    v_add_f32 v166, v166, v174
    v_add_f32 v167, v167, v175
    v_add_f32 v160, v160, v164
    v_add_f32 v161, v161, v165
    v_add_f32 v162, v162, v166
    v_add_f32 v163, v163, v167
    v_add_f32 v160, v160, v162
    v_add_f32 v161, v161, v163
    v_mov_b32 v162, v160
    v_mov_b32 v163, v161
    s_nop 0
    v_permlane16_swap_b32 v160, v162
    v_permlane16_swap_b32 v161, v163
    v_add_f32 v160, v160, v162
    v_add_f32 v161, v161, v163
    v_mov_b32 v162, v160
    v_mov_b32 v163, v161
    s_nop 0
    v_permlane32_swap_b32 v160, v162
    v_permlane32_swap_b32 v161, v163
    v_add_f32 v160, v160, v162
    v_add_f32 v161, v161, v163
    v_cvt_pk_bf16_f32 v164, v160, v161
    v_mov_b32 v165, s52
    s_lshl_b32 s60, s56, 7
    s_add_u32 s60, s60, 4096
    v_add_u32 v11, s60, v13
    s_mov_b32 exec_lo, 0xffff
    s_mov_b32 exec_hi, 0x0
    buffer_store_dwordx2 v[164:165], v11, s[12:15], 0 offen sc0 sc1
    s_mov_b64 exec, -1
L_p1pub_5:
    s_barrier
    s_branch L_bj_2
L_bwide_4:
    v_lshrrev_b32 v12, 2, v1
    s_mul_i32 s60, s53, 16
    v_add_u32 v12, s60, v12
    v_lshlrev_b32 v11, 13, v12
    v_lshlrev_b32 v12, 1, v12
    v_and_b32 v13, 3, v1
    v_lshlrev_b32 v13, 4, v13
    s_and_b32 s60, s56, 127
    s_lshl_b32 s60, s60, 6
    v_add3_u32 v11, v11, v13, s60
    buffer_load_ushort v180, v12, s[4:7], 0 offen offset:0
    buffer_load_ushort v181, v12, s[4:7], 0 offen offset:256
    buffer_load_ushort v182, v12, s[4:7], 0 offen offset:512
    buffer_load_ushort v183, v12, s[4:7], 0 offen offset:768
    buffer_load_ushort v184, v12, s[4:7], 0 offen offset:1024
    s_mov_b32 s63, 0x0
    buffer_load_dwordx4 v[160:163], v11, s[8:11], s63 offen nt
    s_mov_b32 s63, 0x100000
    buffer_load_dwordx4 v[164:167], v11, s[8:11], s63 offen nt
    s_mov_b32 s63, 0x200000
    buffer_load_dwordx4 v[168:171], v11, s[8:11], s63 offen nt
    s_mov_b32 s63, 0x300000
    buffer_load_dwordx4 v[172:175], v11, s[8:11], s63 offen nt
    s_mov_b32 s63, 0x400000
    buffer_load_dwordx4 v[176:179], v11, s[8:11], s63 offen nt
    s_barrier
    s_add_u32 s63, s71, 0
    buffer_load_dwordx4 v[64:67], v4, s[40:43], s63 offen offset:0 nt
    s_add_u32 s63, s63, 40960
    buffer_load_dwordx4 v[68:71], v4, s[40:43], s63 offen offset:0 nt
    s_add_u32 s63, s63, 40960
    buffer_load_dwordx4 v[72:75], v4, s[40:43], s63 offen offset:0 nt
    s_add_u32 s63, s63, 40960
    buffer_load_dwordx4 v[76:79], v4, s[40:43], s63 offen offset:0 nt
    s_waitcnt lgkmcnt(0)
    s_mul_i32 s52, s73, 1664525
    s_add_u32 s52, s52, 1013904223
    s_waitcnt vmcnt(4)
    v_lshlrev_b32 v13, 16, v180
    v_dot2_f32_bf16 v16, v160, v180, 0
    v_dot2_f32_bf16 v18, v161, v180, 0
    v_dot2_f32_bf16 v20, v162, v180, 0
    v_dot2_f32_bf16 v22, v163, v180, 0
    v_dot2_f32_bf16 v17, v160, v13, 0
    v_dot2_f32_bf16 v19, v161, v13, 0
    v_dot2_f32_bf16 v21, v162, v13, 0
    v_dot2_f32_bf16 v23, v163, v13, 0
    v_lshlrev_b32 v13, 16, v181
    v_dot2_f32_bf16 v16, v164, v181, v16
    v_dot2_f32_bf16 v18, v165, v181, v18
    v_dot2_f32_bf16 v20, v166, v181, v20
    v_dot2_f32_bf16 v22, v167, v181, v22
    v_dot2_f32_bf16 v17, v164, v13, v17
    v_dot2_f32_bf16 v19, v165, v13, v19
    v_dot2_f32_bf16 v21, v166, v13, v21
    v_dot2_f32_bf16 v23, v167, v13, v23
    v_lshlrev_b32 v13, 16, v182
    v_dot2_f32_bf16 v16, v168, v182, v16
    v_dot2_f32_bf16 v18, v169, v182, v18
    v_dot2_f32_bf16 v20, v170, v182, v20
    v_dot2_f32_bf16 v22, v171, v182, v22
    v_dot2_f32_bf16 v17, v168, v13, v17
    v_dot2_f32_bf16 v19, v169, v13, v19
    v_dot2_f32_bf16 v21, v170, v13, v21
    v_dot2_f32_bf16 v23, v171, v13, v23
    v_lshlrev_b32 v13, 16, v183
    v_dot2_f32_bf16 v16, v172, v183, v16
    v_dot2_f32_bf16 v18, v173, v183, v18
    v_dot2_f32_bf16 v20, v174, v183, v20
    v_dot2_f32_bf16 v22, v175, v183, v22
    v_dot2_f32_bf16 v17, v172, v13, v17
    v_dot2_f32_bf16 v19, v173, v13, v19
    v_dot2_f32_bf16 v21, v174, v13, v21
    v_dot2_f32_bf16 v23, v175, v13, v23
    v_lshlrev_b32 v13, 16, v184
    v_dot2_f32_bf16 v16, v176, v184, v16
    v_dot2_f32_bf16 v18, v177, v184, v18
    v_dot2_f32_bf16 v20, v178, v184, v20
    v_dot2_f32_bf16 v22, v179, v184, v22
    v_dot2_f32_bf16 v17, v176, v13, v17
    v_dot2_f32_bf16 v19, v177, v13, v19
    v_dot2_f32_bf16 v21, v178, v13, v21
    v_dot2_f32_bf16 v23, v179, v13, v23
    v_add_f32_dpp v16, v16, v16 row_ror:4 row_mask:0xf bank_mask:0xf
    v_add_f32_dpp v17, v17, v17 row_ror:4 row_mask:0xf bank_mask:0xf
    v_add_f32_dpp v18, v18, v18 row_ror:4 row_mask:0xf bank_mask:0xf
    v_add_f32_dpp v19, v19, v19 row_ror:4 row_mask:0xf bank_mask:0xf
    v_add_f32_dpp v20, v20, v20 row_ror:4 row_mask:0xf bank_mask:0xf
    v_add_f32_dpp v21, v21, v21 row_ror:4 row_mask:0xf bank_mask:0xf
    v_add_f32_dpp v22, v22, v22 row_ror:4 row_mask:0xf bank_mask:0xf
    v_add_f32_dpp v23, v23, v23 row_ror:4 row_mask:0xf bank_mask:0xf
    v_add_f32_dpp v16, v16, v16 row_ror:8 row_mask:0xf bank_mask:0xf
    v_add_f32_dpp v17, v17, v17 row_ror:8 row_mask:0xf bank_mask:0xf
    v_add_f32_dpp v18, v18, v18 row_ror:8 row_mask:0xf bank_mask:0xf
    v_add_f32_dpp v19, v19, v19 row_ror:8 row_mask:0xf bank_mask:0xf
    v_add_f32_dpp v20, v20, v20 row_ror:8 row_mask:0xf bank_mask:0xf
    v_add_f32_dpp v21, v21, v21 row_ror:8 row_mask:0xf bank_mask:0xf
    v_add_f32_dpp v22, v22, v22 row_ror:8 row_mask:0xf bank_mask:0xf
    v_add_f32_dpp v23, v23, v23 row_ror:8 row_mask:0xf bank_mask:0xf
    v_and_b32 v13, 3, v1
    v_lshlrev_b32 v13, 5, v13
    v_mul_u32_u24 v12, 128, v3
    s_mul_i32 s60, s53, 512
    s_add_u32 s60, s60, 136704
    v_add3_u32 v11, v13, v12, s60
    s_mov_b32 exec_lo, 0xf000f
    s_mov_b32 exec_hi, 0xf000f
    ds_write_b128 v11, v[16:19]
    ds_write_b128 v11, v[20:23] offset:16
    s_mov_b64 exec, -1
    s_waitcnt lgkmcnt(0)
    s_barrier
    s_cmp_eq_u32 s53, 0
    s_cbranch_scc0 L_p1pub_6
    v_mul_u32_u24 v12, 1024, v3
    v_lshlrev_b32 v13, 3, v2
    v_add3_u32 v11, v12, v13, 0
    v_add_u32 v11, 136704, v11
    ds_read_b64 v[160:161], v11 offset:0
    ds_read_b64 v[162:163], v11 offset:128
    ds_read_b64 v[164:165], v11 offset:256
    ds_read_b64 v[166:167], v11 offset:384
    ds_read_b64 v[168:169], v11 offset:512
    ds_read_b64 v[170:171], v11 offset:640
    ds_read_b64 v[172:173], v11 offset:768
    ds_read_b64 v[174:175], v11 offset:896
    s_waitcnt lgkmcnt(0)
    v_add_f32 v160, v160, v168
    v_add_f32 v161, v161, v169
    v_add_f32 v162, v162, v170
    v_add_f32 v163, v163, v171
    v_add_f32 v164, v164, v172
    v_add_f32 v165, v165, v173
    v_add_f32 v166, v166, v174
    v_add_f32 v167, v167, v175
    v_add_f32 v160, v160, v164
    v_add_f32 v161, v161, v165
    v_add_f32 v162, v162, v166
    v_add_f32 v163, v163, v167
    v_add_f32 v160, v160, v162
    v_add_f32 v161, v161, v163
    v_mov_b32 v162, v160
    v_mov_b32 v163, v161
    s_nop 0
    v_permlane16_swap_b32 v160, v162
    v_permlane16_swap_b32 v161, v163
    v_add_f32 v160, v160, v162
    v_add_f32 v161, v161, v163
    v_mov_b32 v162, v160
    v_mov_b32 v163, v161
    s_nop 0
    v_permlane32_swap_b32 v160, v162
    v_permlane32_swap_b32 v161, v163
    v_add_f32 v160, v160, v162
    v_add_f32 v161, v161, v163
    v_cvt_pk_bf16_f32 v164, v160, v161
    v_mov_b32 v165, s52
    s_lshl_b32 s60, s56, 7
    s_add_u32 s60, s60, 4096
    v_add_u32 v11, s60, v13
    s_mov_b32 exec_lo, 0xffff
    s_mov_b32 exec_hi, 0x0
    buffer_store_dwordx2 v[164:165], v11, s[12:15], 0 offen sc0 sc1
    s_mov_b64 exec, -1
L_p1pub_6:
    s_barrier
    s_add_u32 s63, s71, 0
    s_add_u32 s63, s63, 163840
    buffer_load_dwordx4 v[80:83], v4, s[40:43], s63 offen offset:0 nt
    s_add_u32 s63, s63, 40960
    buffer_load_dwordx4 v[84:87], v4, s[40:43], s63 offen offset:0 nt
    s_add_u32 s63, s63, 40960
    buffer_load_dwordx4 v[88:91], v4, s[40:43], s63 offen offset:0 nt
    s_add_u32 s63, s63, 40960
    buffer_load_dwordx4 v[92:95], v4, s[40:43], s63 offen offset:0 nt
    s_add_u32 s63, s71, 0
    buffer_load_dwordx4 v[128:131], v4, s[44:47], s63 offen offset:0 nt
    s_add_u32 s63, s63, 40960
    buffer_load_dwordx4 v[132:135], v4, s[44:47], s63 offen offset:0 nt
    s_add_u32 s63, s63, 40960
    buffer_load_dwordx4 v[136:139], v4, s[44:47], s63 offen offset:0 nt
    s_add_u32 s63, s63, 40960
    buffer_load_dwordx4 v[140:143], v4, s[44:47], s63 offen offset:0 nt
    s_add_u32 s63, s63, 40960
    buffer_load_dwordx4 v[144:147], v4, s[44:47], s63 offen offset:0 nt
    s_add_u32 s63, s63, 40960
    buffer_load_dwordx4 v[148:151], v4, s[44:47], s63 offen offset:0 nt
    s_add_u32 s63, s63, 40960
    buffer_load_dwordx4 v[152:155], v4, s[44:47], s63 offen offset:0 nt
    s_add_u32 s63, s63, 40960
    buffer_load_dwordx4 v[156:159], v4, s[44:47], s63 offen offset:0 nt
    s_branch L_bj_2
L_bnu_1:
    s_add_u32 s63, s71, 0
    buffer_load_dwordx4 v[64:67], v4, s[40:43], s63 offen offset:0 nt
    s_add_u32 s63, s63, 40960
    buffer_load_dwordx4 v[68:71], v4, s[40:43], s63 offen offset:0 nt
    s_add_u32 s63, s63, 40960
    buffer_load_dwordx4 v[72:75], v4, s[40:43], s63 offen offset:0 nt
    s_add_u32 s63, s63, 40960
    buffer_load_dwordx4 v[76:79], v4, s[40:43], s63 offen offset:0 nt
    s_add_u32 s63, s63, 40960
    buffer_load_dwordx4 v[80:83], v4, s[40:43], s63 offen offset:0 nt
    s_add_u32 s63, s63, 40960
    buffer_load_dwordx4 v[84:87], v4, s[40:43], s63 offen offset:0 nt
    s_add_u32 s63, s63, 40960
    buffer_load_dwordx4 v[88:91], v4, s[40:43], s63 offen offset:0 nt
    s_add_u32 s63, s63, 40960
    buffer_load_dwordx4 v[92:95], v4, s[40:43], s63 offen offset:0 nt
    s_add_u32 s63, s71, 0
    buffer_load_dwordx4 v[128:131], v4, s[44:47], s63 offen offset:0 nt
    s_add_u32 s63, s63, 40960
    buffer_load_dwordx4 v[132:135], v4, s[44:47], s63 offen offset:0 nt
    s_add_u32 s63, s63, 40960
    buffer_load_dwordx4 v[136:139], v4, s[44:47], s63 offen offset:0 nt
    s_add_u32 s63, s63, 40960
    buffer_load_dwordx4 v[140:143], v4, s[44:47], s63 offen offset:0 nt
    s_add_u32 s63, s63, 40960
    buffer_load_dwordx4 v[144:147], v4, s[44:47], s63 offen offset:0 nt
    s_add_u32 s63, s63, 40960
    buffer_load_dwordx4 v[148:151], v4, s[44:47], s63 offen offset:0 nt
    s_add_u32 s63, s63, 40960
    buffer_load_dwordx4 v[152:155], v4, s[44:47], s63 offen offset:0 nt
    s_add_u32 s63, s63, 40960
    buffer_load_dwordx4 v[156:159], v4, s[44:47], s63 offen offset:0 nt
    s_waitcnt lgkmcnt(0)
    s_mul_i32 s52, s73, 1664525
    s_add_u32 s52, s52, 1013904223
L_bj_2:
    s_waitcnt vmcnt(8)
    s_barrier
    s_cmp_eq_u32 s53, 0
    s_cbranch_scc0 L_bq1_7
    s_lshl_b32 s60, s57, 10
    s_add_u32 s60, s60, 4096
    v_add_u32 v8, s60, v4
    buffer_load_dwordx4 v[12:15], v8, s[12:15], 0 offen sc1
    s_add_u32 s63, s71, 327680
    buffer_load_dwordx4 v[96:99], v4, s[40:43], s63 offen offset:0 nt
    s_add_u32 s63, s63, 40960
    buffer_load_dwordx4 v[100:103], v4, s[40:43], s63 offen offset:0 nt
    s_add_u32 s63, s63, 40960
    buffer_load_dwordx4 v[104:107], v4, s[40:43], s63 offen offset:0 nt
    s_add_u32 s63, s63, 40960
    buffer_load_dwordx4 v[108:111], v4, s[40:43], s63 offen offset:0 nt
    s_add_u32 s63, s63, 40960
    buffer_load_dwordx4 v[112:115], v4, s[40:43], s63 offen offset:0 nt
    s_add_u32 s63, s63, 40960
    buffer_load_dwordx4 v[116:119], v4, s[40:43], s63 offen offset:0 nt
    s_add_u32 s63, s63, 40960
    buffer_load_dwordx4 v[120:123], v4, s[40:43], s63 offen offset:0 nt
    s_add_u32 s63, s63, 40960
    buffer_load_dwordx4 v[124:127], v4, s[40:43], s63 offen offset:0 nt
    s_waitcnt vmcnt(8)
    v_xor_b32 v9, s52, v13
    v_xor_b32 v10, s52, v15
    v_or_b32 v9, v9, v10
    v_cmp_eq_u32 vcc, 0, v9
    s_cmp_eq_u64 vcc, -1
    s_cbranch_scc1 L_pdone_10
    s_mov_b32 s62, 3000
L_poll_9:
    buffer_load_dwordx4 v[12:15], v8, s[12:15], 0 offen sc1
    s_waitcnt vmcnt(0)
    v_xor_b32 v9, s52, v13
    v_xor_b32 v10, s52, v15
    v_or_b32 v9, v9, v10
    v_cmp_eq_u32 vcc, 0, v9
    s_cmp_eq_u64 vcc, -1
    s_cbranch_scc1 L_pdone_10
    s_sub_u32 s62, s62, 1
    s_cmp_eq_u32 s62, 0
    s_cbranch_scc0 L_poll_9
L_pdone_10:
    v_mov_b32 v13, v14
    v_lshlrev_b32 v8, 3, v1
    v_add_u32 v8, 140800, v8
    ds_write_b64 v8, v[12:13]
    s_waitcnt lgkmcnt(0)
    s_branch L_bq2_8
L_bq1_7:
    s_add_u32 s63, s71, 327680
    buffer_load_dwordx4 v[96:99], v4, s[40:43], s63 offen offset:0 nt
    s_add_u32 s63, s63, 40960
    buffer_load_dwordx4 v[100:103], v4, s[40:43], s63 offen offset:0 nt
    s_add_u32 s63, s63, 40960
    buffer_load_dwordx4 v[104:107], v4, s[40:43], s63 offen offset:0 nt
    s_add_u32 s63, s63, 40960
    buffer_load_dwordx4 v[108:111], v4, s[40:43], s63 offen offset:0 nt
    s_add_u32 s63, s63, 40960
    buffer_load_dwordx4 v[112:115], v4, s[40:43], s63 offen offset:0 nt
    s_add_u32 s63, s63, 40960
    buffer_load_dwordx4 v[116:119], v4, s[40:43], s63 offen offset:0 nt
    s_add_u32 s63, s63, 40960
    buffer_load_dwordx4 v[120:123], v4, s[40:43], s63 offen offset:0 nt
    s_add_u32 s63, s63, 40960
    buffer_load_dwordx4 v[124:127], v4, s[40:43], s63 offen offset:0 nt
L_bq2_8:
    s_barrier
    v_and_b32 v8, 1, v2
    v_lshlrev_b32 v8, 8, v8
    v_lshlrev_b32 v9, 4, v2
    v_add3_u32 v8, v8, v9, 0
    v_add_u32 v8, 140800, v8
    v_xor_b32 v9, 256, v8
    ds_read_b128 v[44:47], v8
    ds_read_b128 v[48:51], v9
    s_add_u32 s63, s71, 327680
    buffer_load_dwordx4 v[160:163], v4, s[44:47], s63 offen offset:0 nt
    s_add_u32 s63, s63, 40960
    buffer_load_dwordx4 v[164:167], v4, s[44:47], s63 offen offset:0 nt
    s_add_u32 s63, s63, 40960
    buffer_load_dwordx4 v[168:171], v4, s[44:47], s63 offen offset:0 nt
    s_add_u32 s63, s63, 40960
    buffer_load_dwordx4 v[172:175], v4, s[44:47], s63 offen offset:0 nt
    s_add_u32 s63, s63, 40960
    buffer_load_dwordx4 v[176:179], v4, s[44:47], s63 offen offset:0 nt
    s_add_u32 s63, s63, 40960
    buffer_load_dwordx4 v[180:183], v4, s[44:47], s63 offen offset:0 nt
    s_add_u32 s63, s63, 40960
    buffer_load_dwordx4 v[184:187], v4, s[44:47], s63 offen offset:0 nt
    s_add_u32 s63, s63, 40960
    buffer_load_dwordx4 v[188:191], v4, s[44:47], s63 offen offset:0 nt
    s_lshl_b32 s60, s57, 8
    s_lshl_b32 s61, s53, 5
    s_add_u32 s60, s60, s61
    v_lshrrev_b32 v8, 3, v1
    v_add_u32 v8, s60, v8
    v_mul_u32_u24 v8, 1152, v8
    v_and_b32 v9, 7, v1
    v_lshlrev_b32 v9, 4, v9
    s_lshl_b32 s60, s58, 7
    v_add3_u32 v8, v8, v9, s60
    s_cmp_lt_u32 s58, 9
    s_cselect_b32 s60, 0, 0x4000000
    s_add_u32 s63, s60, 0
    buffer_load_dwordx4 v[224:227], v8, s[48:51], s63 offen nt
    s_add_u32 s63, s60, 9216
    buffer_load_dwordx4 v[228:231], v8, s[48:51], s63 offen nt
    s_add_u32 s63, s60, 18432
    buffer_load_dwordx4 v[232:235], v8, s[48:51], s63 offen nt
    s_add_u32 s63, s60, 27648
    buffer_load_dwordx4 v[236:239], v8, s[48:51], s63 offen nt
    s_cmp_eq_u32 s53, 0
    s_cbranch_scc0 L_xpub_11
    s_lshl_b32 s60, s57, 7
    s_lshl_b32 s61, s58, 3
    s_add_u32 s60, s60, s61
    s_add_u32 s60, s60, 120832
    v_mov_b32 v251, s60
    v_mov_b32 v252, s52
    v_mov_b32 v253, s100
    s_mov_b32 exec_lo, 0x1
    s_mov_b32 exec_hi, 0x0
    buffer_store_dwordx2 v[252:253], v251, s[12:15], 0 offen sc0 sc1
    s_mov_b64 exec, -1
L_xpub_11:
    v_and_b32 v8, 0xe0, v0
    v_and_b32 v9, 7, v0
    v_lshlrev_b32 v9, 2, v9
    v_bfe_u32 v10, v0, 3, 2
    v_or3_b32 v8, v8, v9, v10
    v_lshlrev_b32 v56, 2, v8
    v_bfe_u32 v8, v0, 5, 3
    v_mul_u32_u24 v8, 3072, v8
    v_bfe_u32 v9, v0, 1, 4
    v_lshlrev_b32 v9, 4, v9
    s_mul_i32 s60, s57, 24576
    s_lshl_b32 s61, s58, 8
    s_add_u32 s60, s60, s61
    s_add_u32 s60, s60, 131072
    v_add3_u32 v57, v8, v9, s60
    s_lshl_b32 s60, s57, 3
    s_add_u32 s60, s60, s53
    s_mul_i32 s60, s60, 3072
    s_add_u32 s60, s60, 131072
    v_add_u32 v8, 0, v3
    v_min_u32 v8, 9, v8
    v_lshlrev_b32 v9, 8, v8
    v_lshlrev_b32 v10, 4, v2
    v_add3_u32 v58, v9, v10, s60
    v_add_u32 v8, 4, v3
    v_min_u32 v8, 9, v8
    v_lshlrev_b32 v9, 8, v8
    v_lshlrev_b32 v10, 4, v2
    v_add3_u32 v59, v9, v10, s60
    v_add_u32 v8, 8, v3
    v_min_u32 v8, 9, v8
    v_lshlrev_b32 v9, 8, v8
    v_lshlrev_b32 v10, 4, v2
    v_add3_u32 v60, v9, v10, s60
    v_and_b32 v8, 1, v2
    v_lshlrev_b32 v9, 9, v8
    v_lshlrev_b32 v10, 7, v3
    s_lshl_b32 s60, s53, 10
    v_add3_u32 v240, v9, v10, s60
    v_lshlrev_b32 v10, 6, v8
    s_lshl_b32 s60, s53, 3
    v_add_u32 v241, s60, v10
    v_lshlrev_b32 v242, 2, v3
    v_bfe_u32 v8, v1, 3, 1
    v_mul_u32_u24 v8, 0x202, v8
    v_add_u32 v8, 0x100, v8
    v_or_b32 v243, 0x0c0c0000, v8
    v_lshlrev_b32 v8, 16, v8
    v_or_b32 v244, 0x0c0c, v8
    v_bfe_u32 v8, v1, 3, 1
    v_cmp_eq_u32 vcc, 1, v8
    v_mov_b32 v8, s65
    v_mov_b32 v9, s66
    v_cndmask_b32 v243, v8, v9, vcc
    v_and_b32 v245, 7, v1
    v_lshlrev_b32 v245, 5, v245
    v_lshlrev_b32 v9, 3, v3
    v_add_u32 v245, v245, v9
    s_lshl_b32 s60, s53, 8
    v_add_u32 v245, s60, v245
    v_lshlrev_b32 v246, 2, v1
    s_lshl_b32 s60, s58, 2
    v_add_u32 v8, s60, v3
    v_mul_u32_u24 v8, 6144, v8
    v_lshlrev_b32 v9, 3, v2
    s_add_u32 s60, s57, 32
    s_lshl_b32 s60, s60, 7
    s_add_u32 s60, s60, 524288
    v_add3_u32 v247, v8, v9, s60
    s_waitcnt lgkmcnt(0)
    s_cmp_ge_u32 s53, 4
    s_cbranch_scc1 L_blate_13
    s_waitcnt vmcnt(28)
    v_dot2_f32_bf16 v16, v64, v44, 0
    v_dot2_f32_bf16 v24, v64, v48, 0
    v_dot2_f32_bf16 v17, v68, v44, 0
    v_dot2_f32_bf16 v25, v68, v48, 0
    v_dot2_f32_bf16 v18, v72, v44, 0
    v_dot2_f32_bf16 v26, v72, v48, 0
    v_dot2_f32_bf16 v19, v76, v44, 0
    v_dot2_f32_bf16 v27, v76, v48, 0
    v_dot2_f32_bf16 v20, v80, v44, 0
    v_dot2_f32_bf16 v28, v80, v48, 0
    v_dot2_f32_bf16 v21, v84, v44, 0
    v_dot2_f32_bf16 v29, v84, v48, 0
    v_dot2_f32_bf16 v22, v88, v44, 0
    v_dot2_f32_bf16 v30, v88, v48, 0
    v_dot2_f32_bf16 v23, v92, v44, 0
    v_dot2_f32_bf16 v31, v92, v48, 0
    v_dot2_f32_bf16 v16, v65, v45, v16
    v_dot2_f32_bf16 v24, v65, v49, v24
    v_dot2_f32_bf16 v17, v69, v45, v17
    v_dot2_f32_bf16 v25, v69, v49, v25
    v_dot2_f32_bf16 v18, v73, v45, v18
    v_dot2_f32_bf16 v26, v73, v49, v26
    v_dot2_f32_bf16 v19, v77, v45, v19
    v_dot2_f32_bf16 v27, v77, v49, v27
    v_dot2_f32_bf16 v20, v81, v45, v20
    v_dot2_f32_bf16 v28, v81, v49, v28
    v_dot2_f32_bf16 v21, v85, v45, v21
    v_dot2_f32_bf16 v29, v85, v49, v29
    v_dot2_f32_bf16 v22, v89, v45, v22
    v_dot2_f32_bf16 v30, v89, v49, v30
    v_dot2_f32_bf16 v23, v93, v45, v23
    v_dot2_f32_bf16 v31, v93, v49, v31
    v_dot2_f32_bf16 v16, v66, v46, v16
    v_dot2_f32_bf16 v24, v66, v50, v24
    v_dot2_f32_bf16 v17, v70, v46, v17
    v_dot2_f32_bf16 v25, v70, v50, v25
    v_dot2_f32_bf16 v18, v74, v46, v18
    v_dot2_f32_bf16 v26, v74, v50, v26
    v_dot2_f32_bf16 v19, v78, v46, v19
    v_dot2_f32_bf16 v27, v78, v50, v27
    v_dot2_f32_bf16 v20, v82, v46, v20
    v_dot2_f32_bf16 v28, v82, v50, v28
    v_dot2_f32_bf16 v21, v86, v46, v21
    v_dot2_f32_bf16 v29, v86, v50, v29
    v_dot2_f32_bf16 v22, v90, v46, v22
    v_dot2_f32_bf16 v30, v90, v50, v30
    v_dot2_f32_bf16 v23, v94, v46, v23
    v_dot2_f32_bf16 v31, v94, v50, v31
    v_dot2_f32_bf16 v16, v67, v47, v16
    v_dot2_f32_bf16 v24, v67, v51, v24
    v_dot2_f32_bf16 v17, v71, v47, v17
    v_dot2_f32_bf16 v25, v71, v51, v25
    v_dot2_f32_bf16 v18, v75, v47, v18
    v_dot2_f32_bf16 v26, v75, v51, v26
    v_dot2_f32_bf16 v19, v79, v47, v19
    v_dot2_f32_bf16 v27, v79, v51, v27
    v_dot2_f32_bf16 v20, v83, v47, v20
    v_dot2_f32_bf16 v28, v83, v51, v28
    v_dot2_f32_bf16 v21, v87, v47, v21
    v_dot2_f32_bf16 v29, v87, v51, v29
    v_dot2_f32_bf16 v22, v91, v47, v22
    v_dot2_f32_bf16 v30, v91, v51, v30
    v_dot2_f32_bf16 v23, v95, v47, v23
    v_dot2_f32_bf16 v31, v95, v51, v31
    s_add_u32 s63, s71, 655360
    buffer_load_dwordx4 v[64:67], v4, s[40:43], s63 offen offset:0 nt
    s_add_u32 s63, s63, 40960
    buffer_load_dwordx4 v[68:71], v4, s[40:43], s63 offen offset:0 nt
    s_add_u32 s63, s63, 40960
    buffer_load_dwordx4 v[72:75], v4, s[40:43], s63 offen offset:0 nt
    s_add_u32 s63, s63, 40960
    buffer_load_dwordx4 v[76:79], v4, s[40:43], s63 offen offset:0 nt
    s_add_u32 s63, s63, 40960
    buffer_load_dwordx4 v[80:83], v4, s[40:43], s63 offen offset:0 nt
    s_add_u32 s63, s63, 40960
    buffer_load_dwordx4 v[84:87], v4, s[40:43], s63 offen offset:0 nt
    s_add_u32 s63, s63, 40960
    buffer_load_dwordx4 v[88:91], v4, s[40:43], s63 offen offset:0 nt
    s_add_u32 s63, s63, 40960
    buffer_load_dwordx4 v[92:95], v4, s[40:43], s63 offen offset:0 nt
    v_add_f32_dpp v16, v24, v16 quad_perm:[1,0,3,2] row_mask:0xf bank_mask:0xf
    v_add_f32_dpp v17, v25, v17 quad_perm:[1,0,3,2] row_mask:0xf bank_mask:0xf
    v_add_f32_dpp v18, v26, v18 quad_perm:[1,0,3,2] row_mask:0xf bank_mask:0xf
    v_add_f32_dpp v19, v27, v19 quad_perm:[1,0,3,2] row_mask:0xf bank_mask:0xf
    v_add_f32_dpp v20, v28, v20 quad_perm:[1,0,3,2] row_mask:0xf bank_mask:0xf
    v_add_f32_dpp v21, v29, v21 quad_perm:[1,0,3,2] row_mask:0xf bank_mask:0xf
    v_add_f32_dpp v22, v30, v22 quad_perm:[1,0,3,2] row_mask:0xf bank_mask:0xf
    v_add_f32_dpp v23, v31, v23 quad_perm:[1,0,3,2] row_mask:0xf bank_mask:0xf
    v_add_f32_dpp v16, v16, v16 quad_perm:[2,3,0,1] row_mask:0xf bank_mask:0xf
    v_add_f32_dpp v17, v17, v17 quad_perm:[2,3,0,1] row_mask:0xf bank_mask:0xf
    v_add_f32_dpp v18, v18, v18 quad_perm:[2,3,0,1] row_mask:0xf bank_mask:0xf
    v_add_f32_dpp v19, v19, v19 quad_perm:[2,3,0,1] row_mask:0xf bank_mask:0xf
    v_add_f32_dpp v20, v20, v20 quad_perm:[2,3,0,1] row_mask:0xf bank_mask:0xf
    v_add_f32_dpp v21, v21, v21 quad_perm:[2,3,0,1] row_mask:0xf bank_mask:0xf
    v_add_f32_dpp v22, v22, v22 quad_perm:[2,3,0,1] row_mask:0xf bank_mask:0xf
    v_add_f32_dpp v23, v23, v23 quad_perm:[2,3,0,1] row_mask:0xf bank_mask:0xf
    v_add_f32_dpp v16, v16, v16 row_ror:4 row_mask:0xf bank_mask:0xf
    v_add_f32_dpp v17, v17, v17 row_ror:4 row_mask:0xf bank_mask:0xf
    v_add_f32_dpp v18, v18, v18 row_ror:4 row_mask:0xf bank_mask:0xf
    v_add_f32_dpp v19, v19, v19 row_ror:4 row_mask:0xf bank_mask:0xf
    v_add_f32_dpp v20, v20, v20 row_ror:4 row_mask:0xf bank_mask:0xf
    v_add_f32_dpp v21, v21, v21 row_ror:4 row_mask:0xf bank_mask:0xf
    v_add_f32_dpp v22, v22, v22 row_ror:4 row_mask:0xf bank_mask:0xf
    v_add_f32_dpp v23, v23, v23 row_ror:4 row_mask:0xf bank_mask:0xf
    v_add_f32_dpp v16, v16, v16 row_ror:8 row_mask:0xf bank_mask:0xf
    v_add_f32_dpp v17, v17, v17 row_ror:8 row_mask:0xf bank_mask:0xf
    v_add_f32_dpp v18, v18, v18 row_ror:8 row_mask:0xf bank_mask:0xf
    v_add_f32_dpp v19, v19, v19 row_ror:8 row_mask:0xf bank_mask:0xf
    v_add_f32_dpp v20, v20, v20 row_ror:8 row_mask:0xf bank_mask:0xf
    v_add_f32_dpp v21, v21, v21 row_ror:8 row_mask:0xf bank_mask:0xf
    v_add_f32_dpp v22, v22, v22 row_ror:8 row_mask:0xf bank_mask:0xf
    v_add_f32_dpp v23, v23, v23 row_ror:8 row_mask:0xf bank_mask:0xf
    v_max3_f32 v8, v16, v17, v18
    v_max3_f32 v9, v19, v20, v21
    v_max3_f32 v8, v8, v22, v23
    v_max_f32 v8, v8, v9
    v_mov_b32 v9, v8
    s_nop 1
    v_permlane16_swap_b32 v8, v9
    v_max_f32 v8, v8, v9
    v_mov_b32 v9, v8
    s_nop 1
    v_permlane32_swap_b32 v8, v9
    v_max_f32 v8, v8, v9
    v_mov_b32 v6, v8
    v_mul_f32 v8, s64, v6
    v_fma_f32 v16, v16, s64, -v8
    v_fma_f32 v17, v17, s64, -v8
    v_fma_f32 v18, v18, s64, -v8
    v_fma_f32 v19, v19, s64, -v8
    v_fma_f32 v20, v20, s64, -v8
    v_fma_f32 v21, v21, s64, -v8
    v_fma_f32 v22, v22, s64, -v8
    v_fma_f32 v23, v23, s64, -v8
    v_exp_f32 v16, v16
    v_exp_f32 v17, v17
    v_exp_f32 v18, v18
    v_exp_f32 v19, v19
    v_exp_f32 v20, v20
    v_exp_f32 v21, v21
    v_exp_f32 v22, v22
    v_exp_f32 v23, v23
    v_cvt_pk_bf16_f32 v24, v16, v17
    v_cvt_pk_bf16_f32 v25, v18, v19
    v_cvt_pk_bf16_f32 v26, v20, v21
    v_cvt_pk_bf16_f32 v27, v22, v23
    v_add_f32 v16, v16, v20
    v_add_f32 v17, v17, v21
    v_add_f32 v18, v18, v22
    v_add_f32 v19, v19, v23
    v_add_f32 v16, v16, v18
    v_add_f32 v17, v17, v19
    v_add_f32 v16, v16, v17
    v_mov_b32 v7, v16
    s_waitcnt vmcnt(28)
    v_perm_b32 v32, v132, v128, s65
    v_perm_b32 v33, v140, v136, s65
    v_perm_b32 v34, v148, v144, s65
    v_perm_b32 v35, v156, v152, s65
    s_nop 1
    v_mfma_f32_16x16x32_bf16 v[192:195], v[32:35], v[24:27], 0
    v_perm_b32 v36, v132, v128, s66
    v_perm_b32 v37, v140, v136, s66
    v_perm_b32 v38, v148, v144, s66
    v_perm_b32 v39, v156, v152, s66
    s_nop 1
    v_mfma_f32_16x16x32_bf16 v[196:199], v[36:39], v[24:27], 0
    v_perm_b32 v40, v133, v129, s65
    v_perm_b32 v41, v141, v137, s65
    v_perm_b32 v42, v149, v145, s65
    v_perm_b32 v43, v157, v153, s65
    s_nop 1
    v_mfma_f32_16x16x32_bf16 v[200:203], v[40:43], v[24:27], 0
    v_perm_b32 v32, v133, v129, s66
    v_perm_b32 v33, v141, v137, s66
    v_perm_b32 v34, v149, v145, s66
    v_perm_b32 v35, v157, v153, s66
    s_nop 1
    v_mfma_f32_16x16x32_bf16 v[204:207], v[32:35], v[24:27], 0
    v_perm_b32 v36, v134, v130, s65
    v_perm_b32 v37, v142, v138, s65
    v_perm_b32 v38, v150, v146, s65
    v_perm_b32 v39, v158, v154, s65
    s_nop 1
    v_mfma_f32_16x16x32_bf16 v[208:211], v[36:39], v[24:27], 0
    v_perm_b32 v40, v134, v130, s66
    v_perm_b32 v41, v142, v138, s66
    v_perm_b32 v42, v150, v146, s66
    v_perm_b32 v43, v158, v154, s66
    s_nop 1
    v_mfma_f32_16x16x32_bf16 v[212:215], v[40:43], v[24:27], 0
    v_perm_b32 v32, v135, v131, s65
    v_perm_b32 v33, v143, v139, s65
    v_perm_b32 v34, v151, v147, s65
    v_perm_b32 v35, v159, v155, s65
    s_nop 1
    v_mfma_f32_16x16x32_bf16 v[216:219], v[32:35], v[24:27], 0
    v_perm_b32 v36, v135, v131, s66
    v_perm_b32 v37, v143, v139, s66
    v_perm_b32 v38, v151, v147, s66
    v_perm_b32 v39, v159, v155, s66
    s_nop 1
    v_mfma_f32_16x16x32_bf16 v[220:223], v[36:39], v[24:27], 0
    s_add_u32 s63, s71, 655360
    buffer_load_dwordx4 v[128:131], v4, s[44:47], s63 offen offset:0 nt
    s_add_u32 s63, s63, 40960
    buffer_load_dwordx4 v[132:135], v4, s[44:47], s63 offen offset:0 nt
    s_add_u32 s63, s63, 40960
    buffer_load_dwordx4 v[136:139], v4, s[44:47], s63 offen offset:0 nt
    s_add_u32 s63, s63, 40960
    buffer_load_dwordx4 v[140:143], v4, s[44:47], s63 offen offset:0 nt
    s_add_u32 s63, s63, 40960
    buffer_load_dwordx4 v[144:147], v4, s[44:47], s63 offen offset:0 nt
    s_add_u32 s63, s63, 40960
    buffer_load_dwordx4 v[148:151], v4, s[44:47], s63 offen offset:0 nt
    s_add_u32 s63, s63, 40960
    buffer_load_dwordx4 v[152:155], v4, s[44:47], s63 offen offset:0 nt
    s_add_u32 s63, s63, 40960
    buffer_load_dwordx4 v[156:159], v4, s[44:47], s63 offen offset:0 nt
    s_waitcnt vmcnt(28)
    v_dot2_f32_bf16 v16, v96, v44, 0
    v_dot2_f32_bf16 v24, v96, v48, 0
    v_dot2_f32_bf16 v17, v100, v44, 0
    v_dot2_f32_bf16 v25, v100, v48, 0
    v_dot2_f32_bf16 v18, v104, v44, 0
    v_dot2_f32_bf16 v26, v104, v48, 0
    v_dot2_f32_bf16 v19, v108, v44, 0
    v_dot2_f32_bf16 v27, v108, v48, 0
    v_dot2_f32_bf16 v20, v112, v44, 0
    v_dot2_f32_bf16 v28, v112, v48, 0
    v_dot2_f32_bf16 v21, v116, v44, 0
    v_dot2_f32_bf16 v29, v116, v48, 0
    v_dot2_f32_bf16 v22, v120, v44, 0
    v_dot2_f32_bf16 v30, v120, v48, 0
    v_dot2_f32_bf16 v23, v124, v44, 0
    v_dot2_f32_bf16 v31, v124, v48, 0
    v_dot2_f32_bf16 v16, v97, v45, v16
    v_dot2_f32_bf16 v24, v97, v49, v24
    v_dot2_f32_bf16 v17, v101, v45, v17
    v_dot2_f32_bf16 v25, v101, v49, v25
    v_dot2_f32_bf16 v18, v105, v45, v18
    v_dot2_f32_bf16 v26, v105, v49, v26
    v_dot2_f32_bf16 v19, v109, v45, v19
    v_dot2_f32_bf16 v27, v109, v49, v27
    v_dot2_f32_bf16 v20, v113, v45, v20
    v_dot2_f32_bf16 v28, v113, v49, v28
    v_dot2_f32_bf16 v21, v117, v45, v21
    v_dot2_f32_bf16 v29, v117, v49, v29
    v_dot2_f32_bf16 v22, v121, v45, v22
    v_dot2_f32_bf16 v30, v121, v49, v30
    v_dot2_f32_bf16 v23, v125, v45, v23
    v_dot2_f32_bf16 v31, v125, v49, v31
    v_dot2_f32_bf16 v16, v98, v46, v16
    v_dot2_f32_bf16 v24, v98, v50, v24
    v_dot2_f32_bf16 v17, v102, v46, v17
    v_dot2_f32_bf16 v25, v102, v50, v25
    v_dot2_f32_bf16 v18, v106, v46, v18
    v_dot2_f32_bf16 v26, v106, v50, v26
    v_dot2_f32_bf16 v19, v110, v46, v19
    v_dot2_f32_bf16 v27, v110, v50, v27
    v_dot2_f32_bf16 v20, v114, v46, v20
    v_dot2_f32_bf16 v28, v114, v50, v28
    v_dot2_f32_bf16 v21, v118, v46, v21
    v_dot2_f32_bf16 v29, v118, v50, v29
    v_dot2_f32_bf16 v22, v122, v46, v22
    v_dot2_f32_bf16 v30, v122, v50, v30
    v_dot2_f32_bf16 v23, v126, v46, v23
    v_dot2_f32_bf16 v31, v126, v50, v31
    v_dot2_f32_bf16 v16, v99, v47, v16
    v_dot2_f32_bf16 v24, v99, v51, v24
    v_dot2_f32_bf16 v17, v103, v47, v17
    v_dot2_f32_bf16 v25, v103, v51, v25
    v_dot2_f32_bf16 v18, v107, v47, v18
    v_dot2_f32_bf16 v26, v107, v51, v26
    v_dot2_f32_bf16 v19, v111, v47, v19
    v_dot2_f32_bf16 v27, v111, v51, v27
    v_dot2_f32_bf16 v20, v115, v47, v20
    v_dot2_f32_bf16 v28, v115, v51, v28
    v_dot2_f32_bf16 v21, v119, v47, v21
    v_dot2_f32_bf16 v29, v119, v51, v29
    v_dot2_f32_bf16 v22, v123, v47, v22
    v_dot2_f32_bf16 v30, v123, v51, v30
    v_dot2_f32_bf16 v23, v127, v47, v23
    v_dot2_f32_bf16 v31, v127, v51, v31
    s_add_u32 s63, s71, 983040
    buffer_load_dwordx4 v[96:99], v4, s[40:43], s63 offen offset:0 nt
    s_add_u32 s63, s63, 40960
    buffer_load_dwordx4 v[100:103], v4, s[40:43], s63 offen offset:0 nt
    s_add_u32 s63, s63, 40960
    buffer_load_dwordx4 v[104:107], v4, s[40:43], s63 offen offset:0 nt
    s_add_u32 s63, s63, 40960
    buffer_load_dwordx4 v[108:111], v4, s[40:43], s63 offen offset:0 nt
    s_add_u32 s63, s63, 40960
    buffer_load_dwordx4 v[112:115], v4, s[40:43], s63 offen offset:0 nt
    s_add_u32 s63, s63, 40960
    buffer_load_dwordx4 v[116:119], v4, s[40:43], s63 offen offset:0 nt
    s_add_u32 s63, s63, 40960
    buffer_load_dwordx4 v[120:123], v4, s[40:43], s63 offen offset:0 nt
    s_add_u32 s63, s63, 40960
    buffer_load_dwordx4 v[124:127], v4, s[40:43], s63 offen offset:0 nt
    v_add_f32_dpp v16, v24, v16 quad_perm:[1,0,3,2] row_mask:0xf bank_mask:0xf
    v_add_f32_dpp v17, v25, v17 quad_perm:[1,0,3,2] row_mask:0xf bank_mask:0xf
    v_add_f32_dpp v18, v26, v18 quad_perm:[1,0,3,2] row_mask:0xf bank_mask:0xf
    v_add_f32_dpp v19, v27, v19 quad_perm:[1,0,3,2] row_mask:0xf bank_mask:0xf
    v_add_f32_dpp v20, v28, v20 quad_perm:[1,0,3,2] row_mask:0xf bank_mask:0xf
    v_add_f32_dpp v21, v29, v21 quad_perm:[1,0,3,2] row_mask:0xf bank_mask:0xf
    v_add_f32_dpp v22, v30, v22 quad_perm:[1,0,3,2] row_mask:0xf bank_mask:0xf
    v_add_f32_dpp v23, v31, v23 quad_perm:[1,0,3,2] row_mask:0xf bank_mask:0xf
    v_add_f32_dpp v16, v16, v16 quad_perm:[2,3,0,1] row_mask:0xf bank_mask:0xf
    v_add_f32_dpp v17, v17, v17 quad_perm:[2,3,0,1] row_mask:0xf bank_mask:0xf
    v_add_f32_dpp v18, v18, v18 quad_perm:[2,3,0,1] row_mask:0xf bank_mask:0xf
    v_add_f32_dpp v19, v19, v19 quad_perm:[2,3,0,1] row_mask:0xf bank_mask:0xf
    v_add_f32_dpp v20, v20, v20 quad_perm:[2,3,0,1] row_mask:0xf bank_mask:0xf
    v_add_f32_dpp v21, v21, v21 quad_perm:[2,3,0,1] row_mask:0xf bank_mask:0xf
    v_add_f32_dpp v22, v22, v22 quad_perm:[2,3,0,1] row_mask:0xf bank_mask:0xf
    v_add_f32_dpp v23, v23, v23 quad_perm:[2,3,0,1] row_mask:0xf bank_mask:0xf
    v_add_f32_dpp v16, v16, v16 row_ror:4 row_mask:0xf bank_mask:0xf
    v_add_f32_dpp v17, v17, v17 row_ror:4 row_mask:0xf bank_mask:0xf
    v_add_f32_dpp v18, v18, v18 row_ror:4 row_mask:0xf bank_mask:0xf
    v_add_f32_dpp v19, v19, v19 row_ror:4 row_mask:0xf bank_mask:0xf
    v_add_f32_dpp v20, v20, v20 row_ror:4 row_mask:0xf bank_mask:0xf
    v_add_f32_dpp v21, v21, v21 row_ror:4 row_mask:0xf bank_mask:0xf
    v_add_f32_dpp v22, v22, v22 row_ror:4 row_mask:0xf bank_mask:0xf
    v_add_f32_dpp v23, v23, v23 row_ror:4 row_mask:0xf bank_mask:0xf
    v_add_f32_dpp v16, v16, v16 row_ror:8 row_mask:0xf bank_mask:0xf
    v_add_f32_dpp v17, v17, v17 row_ror:8 row_mask:0xf bank_mask:0xf
    v_add_f32_dpp v18, v18, v18 row_ror:8 row_mask:0xf bank_mask:0xf
    v_add_f32_dpp v19, v19, v19 row_ror:8 row_mask:0xf bank_mask:0xf
    v_add_f32_dpp v20, v20, v20 row_ror:8 row_mask:0xf bank_mask:0xf
    v_add_f32_dpp v21, v21, v21 row_ror:8 row_mask:0xf bank_mask:0xf
    v_add_f32_dpp v22, v22, v22 row_ror:8 row_mask:0xf bank_mask:0xf
    v_add_f32_dpp v23, v23, v23 row_ror:8 row_mask:0xf bank_mask:0xf
    v_max3_f32 v8, v16, v17, v18
    v_max3_f32 v9, v19, v20, v21
    v_max3_f32 v8, v8, v22, v23
    v_max_f32 v8, v8, v9
    v_mov_b32 v9, v8
    s_nop 1
    v_permlane16_swap_b32 v8, v9
    v_max_f32 v8, v8, v9
    v_mov_b32 v9, v8
    s_nop 1
    v_permlane32_swap_b32 v8, v9
    v_max_f32 v8, v8, v9
    v_cmp_gt_f32 vcc, v8, v6
    s_cmp_eq_u64 vcc, 0
    s_cbranch_scc1 L_nors_14
    v_max_f32 v8, v8, v6
    v_sub_f32 v10, v6, v8
    v_mul_f32 v10, s64, v10
    v_exp_f32 v10, v10
    v_mov_b32 v6, v8
    v_mul_f32 v7, v7, v10
    v_mul_f32 v192, v192, v10
    v_mul_f32 v193, v193, v10
    v_mul_f32 v194, v194, v10
    v_mul_f32 v195, v195, v10
    v_mul_f32 v196, v196, v10
    v_mul_f32 v197, v197, v10
    v_mul_f32 v198, v198, v10
    v_mul_f32 v199, v199, v10
    v_mul_f32 v200, v200, v10
    v_mul_f32 v201, v201, v10
    v_mul_f32 v202, v202, v10
    v_mul_f32 v203, v203, v10
    v_mul_f32 v204, v204, v10
    v_mul_f32 v205, v205, v10
    v_mul_f32 v206, v206, v10
    v_mul_f32 v207, v207, v10
    v_mul_f32 v208, v208, v10
    v_mul_f32 v209, v209, v10
    v_mul_f32 v210, v210, v10
    v_mul_f32 v211, v211, v10
    v_mul_f32 v212, v212, v10
    v_mul_f32 v213, v213, v10
    v_mul_f32 v214, v214, v10
    v_mul_f32 v215, v215, v10
    v_mul_f32 v216, v216, v10
    v_mul_f32 v217, v217, v10
    v_mul_f32 v218, v218, v10
    v_mul_f32 v219, v219, v10
    v_mul_f32 v220, v220, v10
    v_mul_f32 v221, v221, v10
    v_mul_f32 v222, v222, v10
    v_mul_f32 v223, v223, v10
L_nors_14:
    v_mul_f32 v8, s64, v6
    v_fma_f32 v16, v16, s64, -v8
    v_fma_f32 v17, v17, s64, -v8
    v_fma_f32 v18, v18, s64, -v8
    v_fma_f32 v19, v19, s64, -v8
    v_fma_f32 v20, v20, s64, -v8
    v_fma_f32 v21, v21, s64, -v8
    v_fma_f32 v22, v22, s64, -v8
    v_fma_f32 v23, v23, s64, -v8
    v_exp_f32 v16, v16
    v_exp_f32 v17, v17
    v_exp_f32 v18, v18
    v_exp_f32 v19, v19
    v_exp_f32 v20, v20
    v_exp_f32 v21, v21
    v_exp_f32 v22, v22
    v_exp_f32 v23, v23
    v_cvt_pk_bf16_f32 v24, v16, v17
    v_cvt_pk_bf16_f32 v25, v18, v19
    v_cvt_pk_bf16_f32 v26, v20, v21
    v_cvt_pk_bf16_f32 v27, v22, v23
    v_add_f32 v16, v16, v20
    v_add_f32 v17, v17, v21
    v_add_f32 v18, v18, v22
    v_add_f32 v19, v19, v23
    v_add_f32 v16, v16, v18
    v_add_f32 v17, v17, v19
    v_add_f32 v16, v16, v17
    v_add_f32 v7, v7, v16
    s_waitcnt vmcnt(28)
    v_perm_b32 v32, v164, v160, s65
    v_perm_b32 v33, v172, v168, s65
    v_perm_b32 v34, v180, v176, s65
    v_perm_b32 v35, v188, v184, s65
    s_nop 1
    v_mfma_f32_16x16x32_bf16 v[192:195], v[32:35], v[24:27], v[192:195]
    v_perm_b32 v36, v164, v160, s66
    v_perm_b32 v37, v172, v168, s66
    v_perm_b32 v38, v180, v176, s66
    v_perm_b32 v39, v188, v184, s66
    s_nop 1
    v_mfma_f32_16x16x32_bf16 v[196:199], v[36:39], v[24:27], v[196:199]
    v_perm_b32 v40, v165, v161, s65
    v_perm_b32 v41, v173, v169, s65
    v_perm_b32 v42, v181, v177, s65
    v_perm_b32 v43, v189, v185, s65
    s_nop 1
    v_mfma_f32_16x16x32_bf16 v[200:203], v[40:43], v[24:27], v[200:203]
    v_perm_b32 v32, v165, v161, s66
    v_perm_b32 v33, v173, v169, s66
    v_perm_b32 v34, v181, v177, s66
    v_perm_b32 v35, v189, v185, s66
    s_nop 1
    v_mfma_f32_16x16x32_bf16 v[204:207], v[32:35], v[24:27], v[204:207]
    v_perm_b32 v36, v166, v162, s65
    v_perm_b32 v37, v174, v170, s65
    v_perm_b32 v38, v182, v178, s65
    v_perm_b32 v39, v190, v186, s65
    s_nop 1
    v_mfma_f32_16x16x32_bf16 v[208:211], v[36:39], v[24:27], v[208:211]
    v_perm_b32 v40, v166, v162, s66
    v_perm_b32 v41, v174, v170, s66
    v_perm_b32 v42, v182, v178, s66
    v_perm_b32 v43, v190, v186, s66
    s_nop 1
    v_mfma_f32_16x16x32_bf16 v[212:215], v[40:43], v[24:27], v[212:215]
    v_perm_b32 v32, v167, v163, s65
    v_perm_b32 v33, v175, v171, s65
    v_perm_b32 v34, v183, v179, s65
    v_perm_b32 v35, v191, v187, s65
    s_nop 1
    v_mfma_f32_16x16x32_bf16 v[216:219], v[32:35], v[24:27], v[216:219]
    v_perm_b32 v36, v167, v163, s66
    v_perm_b32 v37, v175, v171, s66
    v_perm_b32 v38, v183, v179, s66
    v_perm_b32 v39, v191, v187, s66
    s_nop 1
    v_mfma_f32_16x16x32_bf16 v[220:223], v[36:39], v[24:27], v[220:223]
    s_add_u32 s63, s71, 983040
    buffer_load_dwordx4 v[160:163], v4, s[44:47], s63 offen offset:0 nt
    s_add_u32 s63, s63, 40960
    buffer_load_dwordx4 v[164:167], v4, s[44:47], s63 offen offset:0 nt
    s_add_u32 s63, s63, 40960
    buffer_load_dwordx4 v[168:171], v4, s[44:47], s63 offen offset:0 nt
    s_add_u32 s63, s63, 40960
    buffer_load_dwordx4 v[172:175], v4, s[44:47], s63 offen offset:0 nt
    s_add_u32 s63, s63, 40960
    buffer_load_dwordx4 v[176:179], v4, s[44:47], s63 offen offset:0 nt
    s_add_u32 s63, s63, 40960
    buffer_load_dwordx4 v[180:183], v4, s[44:47], s63 offen offset:0 nt
    s_add_u32 s63, s63, 40960
    buffer_load_dwordx4 v[184:187], v4, s[44:47], s63 offen offset:0 nt
    s_add_u32 s63, s63, 40960
    buffer_load_dwordx4 v[188:191], v4, s[44:47], s63 offen offset:0 nt
    s_waitcnt vmcnt(24)
    v_dot2_f32_bf16 v16, v64, v44, 0
    v_dot2_f32_bf16 v24, v64, v48, 0
    v_dot2_f32_bf16 v17, v68, v44, 0
    v_dot2_f32_bf16 v25, v68, v48, 0
    v_dot2_f32_bf16 v18, v72, v44, 0
    v_dot2_f32_bf16 v26, v72, v48, 0
    v_dot2_f32_bf16 v19, v76, v44, 0
    v_dot2_f32_bf16 v27, v76, v48, 0
    v_dot2_f32_bf16 v20, v80, v44, 0
    v_dot2_f32_bf16 v28, v80, v48, 0
    v_dot2_f32_bf16 v21, v84, v44, 0
    v_dot2_f32_bf16 v29, v84, v48, 0
    v_dot2_f32_bf16 v22, v88, v44, 0
    v_dot2_f32_bf16 v30, v88, v48, 0
    v_dot2_f32_bf16 v23, v92, v44, 0
    v_dot2_f32_bf16 v31, v92, v48, 0
    v_dot2_f32_bf16 v16, v65, v45, v16
    v_dot2_f32_bf16 v24, v65, v49, v24
    v_dot2_f32_bf16 v17, v69, v45, v17
    v_dot2_f32_bf16 v25, v69, v49, v25
    v_dot2_f32_bf16 v18, v73, v45, v18
    v_dot2_f32_bf16 v26, v73, v49, v26
    v_dot2_f32_bf16 v19, v77, v45, v19
    v_dot2_f32_bf16 v27, v77, v49, v27
    v_dot2_f32_bf16 v20, v81, v45, v20
    v_dot2_f32_bf16 v28, v81, v49, v28
    v_dot2_f32_bf16 v21, v85, v45, v21
    v_dot2_f32_bf16 v29, v85, v49, v29
    v_dot2_f32_bf16 v22, v89, v45, v22
    v_dot2_f32_bf16 v30, v89, v49, v30
    v_dot2_f32_bf16 v23, v93, v45, v23
    v_dot2_f32_bf16 v31, v93, v49, v31
    v_dot2_f32_bf16 v16, v66, v46, v16
    v_dot2_f32_bf16 v24, v66, v50, v24
    v_dot2_f32_bf16 v17, v70, v46, v17
    v_dot2_f32_bf16 v25, v70, v50, v25
    v_dot2_f32_bf16 v18, v74, v46, v18
    v_dot2_f32_bf16 v26, v74, v50, v26
    v_dot2_f32_bf16 v19, v78, v46, v19
    v_dot2_f32_bf16 v27, v78, v50, v27
    v_dot2_f32_bf16 v20, v82, v46, v20
    v_dot2_f32_bf16 v28, v82, v50, v28
    v_dot2_f32_bf16 v21, v86, v46, v21
    v_dot2_f32_bf16 v29, v86, v50, v29
    v_dot2_f32_bf16 v22, v90, v46, v22
    v_dot2_f32_bf16 v30, v90, v50, v30
    v_dot2_f32_bf16 v23, v94, v46, v23
    v_dot2_f32_bf16 v31, v94, v50, v31
    v_dot2_f32_bf16 v16, v67, v47, v16
    v_dot2_f32_bf16 v24, v67, v51, v24
    v_dot2_f32_bf16 v17, v71, v47, v17
    v_dot2_f32_bf16 v25, v71, v51, v25
    v_dot2_f32_bf16 v18, v75, v47, v18
    v_dot2_f32_bf16 v26, v75, v51, v26
    v_dot2_f32_bf16 v19, v79, v47, v19
    v_dot2_f32_bf16 v27, v79, v51, v27
    v_dot2_f32_bf16 v20, v83, v47, v20
    v_dot2_f32_bf16 v28, v83, v51, v28
    v_dot2_f32_bf16 v21, v87, v47, v21
    v_dot2_f32_bf16 v29, v87, v51, v29
    v_dot2_f32_bf16 v22, v91, v47, v22
    v_dot2_f32_bf16 v30, v91, v51, v30
    v_dot2_f32_bf16 v23, v95, v47, v23
    v_dot2_f32_bf16 v31, v95, v51, v31
    s_add_u32 s63, s71, 1310720
    buffer_load_dwordx4 v[64:67], v4, s[40:43], s63 offen offset:0 nt
    s_add_u32 s63, s63, 40960
    buffer_load_dwordx4 v[68:71], v4, s[40:43], s63 offen offset:0 nt
    s_add_u32 s63, s63, 40960
    buffer_load_dwordx4 v[72:75], v4, s[40:43], s63 offen offset:0 nt
    s_add_u32 s63, s63, 40960
    buffer_load_dwordx4 v[76:79], v4, s[40:43], s63 offen offset:0 nt
    s_add_u32 s63, s63, 40960
    buffer_load_dwordx4 v[80:83], v4, s[40:43], s63 offen offset:0 nt
    s_add_u32 s63, s63, 40960
    buffer_load_dwordx4 v[84:87], v4, s[40:43], s63 offen offset:0 nt
    s_add_u32 s63, s63, 40960
    buffer_load_dwordx4 v[88:91], v4, s[40:43], s63 offen offset:0 nt
    s_add_u32 s63, s63, 40960
    buffer_load_dwordx4 v[92:95], v4, s[40:43], s63 offen offset:0 nt
    v_add_f32_dpp v16, v24, v16 quad_perm:[1,0,3,2] row_mask:0xf bank_mask:0xf
    v_add_f32_dpp v17, v25, v17 quad_perm:[1,0,3,2] row_mask:0xf bank_mask:0xf
    v_add_f32_dpp v18, v26, v18 quad_perm:[1,0,3,2] row_mask:0xf bank_mask:0xf
    v_add_f32_dpp v19, v27, v19 quad_perm:[1,0,3,2] row_mask:0xf bank_mask:0xf
    v_add_f32_dpp v20, v28, v20 quad_perm:[1,0,3,2] row_mask:0xf bank_mask:0xf
    v_add_f32_dpp v21, v29, v21 quad_perm:[1,0,3,2] row_mask:0xf bank_mask:0xf
    v_add_f32_dpp v22, v30, v22 quad_perm:[1,0,3,2] row_mask:0xf bank_mask:0xf
    v_add_f32_dpp v23, v31, v23 quad_perm:[1,0,3,2] row_mask:0xf bank_mask:0xf
    v_add_f32_dpp v16, v16, v16 quad_perm:[2,3,0,1] row_mask:0xf bank_mask:0xf
    v_add_f32_dpp v17, v17, v17 quad_perm:[2,3,0,1] row_mask:0xf bank_mask:0xf
    v_add_f32_dpp v18, v18, v18 quad_perm:[2,3,0,1] row_mask:0xf bank_mask:0xf
    v_add_f32_dpp v19, v19, v19 quad_perm:[2,3,0,1] row_mask:0xf bank_mask:0xf
    v_add_f32_dpp v20, v20, v20 quad_perm:[2,3,0,1] row_mask:0xf bank_mask:0xf
    v_add_f32_dpp v21, v21, v21 quad_perm:[2,3,0,1] row_mask:0xf bank_mask:0xf
    v_add_f32_dpp v22, v22, v22 quad_perm:[2,3,0,1] row_mask:0xf bank_mask:0xf
    v_add_f32_dpp v23, v23, v23 quad_perm:[2,3,0,1] row_mask:0xf bank_mask:0xf
    v_add_f32_dpp v16, v16, v16 row_ror:4 row_mask:0xf bank_mask:0xf
    v_add_f32_dpp v17, v17, v17 row_ror:4 row_mask:0xf bank_mask:0xf
    v_add_f32_dpp v18, v18, v18 row_ror:4 row_mask:0xf bank_mask:0xf
    v_add_f32_dpp v19, v19, v19 row_ror:4 row_mask:0xf bank_mask:0xf
    v_add_f32_dpp v20, v20, v20 row_ror:4 row_mask:0xf bank_mask:0xf
    v_add_f32_dpp v21, v21, v21 row_ror:4 row_mask:0xf bank_mask:0xf
    v_add_f32_dpp v22, v22, v22 row_ror:4 row_mask:0xf bank_mask:0xf
    v_add_f32_dpp v23, v23, v23 row_ror:4 row_mask:0xf bank_mask:0xf
    v_add_f32_dpp v16, v16, v16 row_ror:8 row_mask:0xf bank_mask:0xf
    v_add_f32_dpp v17, v17, v17 row_ror:8 row_mask:0xf bank_mask:0xf
    v_add_f32_dpp v18, v18, v18 row_ror:8 row_mask:0xf bank_mask:0xf
    v_add_f32_dpp v19, v19, v19 row_ror:8 row_mask:0xf bank_mask:0xf
    v_add_f32_dpp v20, v20, v20 row_ror:8 row_mask:0xf bank_mask:0xf
    v_add_f32_dpp v21, v21, v21 row_ror:8 row_mask:0xf bank_mask:0xf
    v_add_f32_dpp v22, v22, v22 row_ror:8 row_mask:0xf bank_mask:0xf
    v_add_f32_dpp v23, v23, v23 row_ror:8 row_mask:0xf bank_mask:0xf
    v_max3_f32 v8, v16, v17, v18
    v_max3_f32 v9, v19, v20, v21
    v_max3_f32 v8, v8, v22, v23
    v_max_f32 v8, v8, v9
    v_mov_b32 v9, v8
    s_nop 1
    v_permlane16_swap_b32 v8, v9
    v_max_f32 v8, v8, v9
    v_mov_b32 v9, v8
    s_nop 1
    v_permlane32_swap_b32 v8, v9
    v_max_f32 v8, v8, v9
    v_cmp_gt_f32 vcc, v8, v6
    s_cmp_eq_u64 vcc, 0
    s_cbranch_scc1 L_nors_15
    v_max_f32 v8, v8, v6
    v_sub_f32 v10, v6, v8
    v_mul_f32 v10, s64, v10
    v_exp_f32 v10, v10
    v_mov_b32 v6, v8
    v_mul_f32 v7, v7, v10
    v_mul_f32 v192, v192, v10
    v_mul_f32 v193, v193, v10
    v_mul_f32 v194, v194, v10
    v_mul_f32 v195, v195, v10
    v_mul_f32 v196, v196, v10
    v_mul_f32 v197, v197, v10
    v_mul_f32 v198, v198, v10
    v_mul_f32 v199, v199, v10
    v_mul_f32 v200, v200, v10
    v_mul_f32 v201, v201, v10
    v_mul_f32 v202, v202, v10
    v_mul_f32 v203, v203, v10
    v_mul_f32 v204, v204, v10
    v_mul_f32 v205, v205, v10
    v_mul_f32 v206, v206, v10
    v_mul_f32 v207, v207, v10
    v_mul_f32 v208, v208, v10
    v_mul_f32 v209, v209, v10
    v_mul_f32 v210, v210, v10
    v_mul_f32 v211, v211, v10
    v_mul_f32 v212, v212, v10
    v_mul_f32 v213, v213, v10
    v_mul_f32 v214, v214, v10
    v_mul_f32 v215, v215, v10
    v_mul_f32 v216, v216, v10
    v_mul_f32 v217, v217, v10
    v_mul_f32 v218, v218, v10
    v_mul_f32 v219, v219, v10
    v_mul_f32 v220, v220, v10
    v_mul_f32 v221, v221, v10
    v_mul_f32 v222, v222, v10
    v_mul_f32 v223, v223, v10
L_nors_15:
    v_mul_f32 v8, s64, v6
    v_fma_f32 v16, v16, s64, -v8
    v_fma_f32 v17, v17, s64, -v8
    v_fma_f32 v18, v18, s64, -v8
    v_fma_f32 v19, v19, s64, -v8
    v_fma_f32 v20, v20, s64, -v8
    v_fma_f32 v21, v21, s64, -v8
    v_fma_f32 v22, v22, s64, -v8
    v_fma_f32 v23, v23, s64, -v8
    v_exp_f32 v16, v16
    v_exp_f32 v17, v17
    v_exp_f32 v18, v18
    v_exp_f32 v19, v19
    v_exp_f32 v20, v20
    v_exp_f32 v21, v21
    v_exp_f32 v22, v22
    v_exp_f32 v23, v23
    v_cvt_pk_bf16_f32 v24, v16, v17
    v_cvt_pk_bf16_f32 v25, v18, v19
    v_cvt_pk_bf16_f32 v26, v20, v21
    v_cvt_pk_bf16_f32 v27, v22, v23
    v_add_f32 v16, v16, v20
    v_add_f32 v17, v17, v21
    v_add_f32 v18, v18, v22
    v_add_f32 v19, v19, v23
    v_add_f32 v16, v16, v18
    v_add_f32 v17, v17, v19
    v_add_f32 v16, v16, v17
    v_add_f32 v7, v7, v16
    s_waitcnt vmcnt(24)
    v_perm_b32 v32, v132, v128, s65
    v_perm_b32 v33, v140, v136, s65
    v_perm_b32 v34, v148, v144, s65
    v_perm_b32 v35, v156, v152, s65
    s_nop 1
    v_mfma_f32_16x16x32_bf16 v[192:195], v[32:35], v[24:27], v[192:195]
    v_perm_b32 v36, v132, v128, s66
    v_perm_b32 v37, v140, v136, s66
    v_perm_b32 v38, v148, v144, s66
    v_perm_b32 v39, v156, v152, s66
    s_nop 1
    v_mfma_f32_16x16x32_bf16 v[196:199], v[36:39], v[24:27], v[196:199]
    v_perm_b32 v40, v133, v129, s65
    v_perm_b32 v41, v141, v137, s65
    v_perm_b32 v42, v149, v145, s65
    v_perm_b32 v43, v157, v153, s65
    s_nop 1
    v_mfma_f32_16x16x32_bf16 v[200:203], v[40:43], v[24:27], v[200:203]
    v_perm_b32 v32, v133, v129, s66
    v_perm_b32 v33, v141, v137, s66
    v_perm_b32 v34, v149, v145, s66
    v_perm_b32 v35, v157, v153, s66
    s_nop 1
    v_mfma_f32_16x16x32_bf16 v[204:207], v[32:35], v[24:27], v[204:207]
    v_perm_b32 v36, v134, v130, s65
    v_perm_b32 v37, v142, v138, s65
    v_perm_b32 v38, v150, v146, s65
    v_perm_b32 v39, v158, v154, s65
    s_nop 1
    v_mfma_f32_16x16x32_bf16 v[208:211], v[36:39], v[24:27], v[208:211]
    v_perm_b32 v40, v134, v130, s66
    v_perm_b32 v41, v142, v138, s66
    v_perm_b32 v42, v150, v146, s66
    v_perm_b32 v43, v158, v154, s66
    s_nop 1
    v_mfma_f32_16x16x32_bf16 v[212:215], v[40:43], v[24:27], v[212:215]
    v_perm_b32 v32, v135, v131, s65
    v_perm_b32 v33, v143, v139, s65
    v_perm_b32 v34, v151, v147, s65
    v_perm_b32 v35, v159, v155, s65
    s_nop 1
    v_mfma_f32_16x16x32_bf16 v[216:219], v[32:35], v[24:27], v[216:219]
    v_perm_b32 v36, v135, v131, s66
    v_perm_b32 v37, v143, v139, s66
    v_perm_b32 v38, v151, v147, s66
    v_perm_b32 v39, v159, v155, s66
    s_nop 1
    v_mfma_f32_16x16x32_bf16 v[220:223], v[36:39], v[24:27], v[220:223]
    s_add_u32 s63, s71, 1310720
    buffer_load_dwordx4 v[128:131], v4, s[44:47], s63 offen offset:0 nt
    s_add_u32 s63, s63, 40960
    buffer_load_dwordx4 v[132:135], v4, s[44:47], s63 offen offset:0 nt
    s_add_u32 s63, s63, 40960
    buffer_load_dwordx4 v[136:139], v4, s[44:47], s63 offen offset:0 nt
    s_add_u32 s63, s63, 40960
    buffer_load_dwordx4 v[140:143], v4, s[44:47], s63 offen offset:0 nt
    s_add_u32 s63, s63, 40960
    buffer_load_dwordx4 v[144:147], v4, s[44:47], s63 offen offset:0 nt
    s_add_u32 s63, s63, 40960
    buffer_load_dwordx4 v[148:151], v4, s[44:47], s63 offen offset:0 nt
    s_add_u32 s63, s63, 40960
    buffer_load_dwordx4 v[152:155], v4, s[44:47], s63 offen offset:0 nt
    s_add_u32 s63, s63, 40960
    buffer_load_dwordx4 v[156:159], v4, s[44:47], s63 offen offset:0 nt
    s_waitcnt vmcnt(24)
    v_dot2_f32_bf16 v16, v96, v44, 0
    v_dot2_f32_bf16 v24, v96, v48, 0
    v_dot2_f32_bf16 v17, v100, v44, 0
    v_dot2_f32_bf16 v25, v100, v48, 0
    v_dot2_f32_bf16 v18, v104, v44, 0
    v_dot2_f32_bf16 v26, v104, v48, 0
    v_dot2_f32_bf16 v19, v108, v44, 0
    v_dot2_f32_bf16 v27, v108, v48, 0
    v_dot2_f32_bf16 v20, v112, v44, 0
    v_dot2_f32_bf16 v28, v112, v48, 0
    v_dot2_f32_bf16 v21, v116, v44, 0
    v_dot2_f32_bf16 v29, v116, v48, 0
    v_dot2_f32_bf16 v22, v120, v44, 0
    v_dot2_f32_bf16 v30, v120, v48, 0
    v_dot2_f32_bf16 v23, v124, v44, 0
    v_dot2_f32_bf16 v31, v124, v48, 0
    v_dot2_f32_bf16 v16, v97, v45, v16
    v_dot2_f32_bf16 v24, v97, v49, v24
    v_dot2_f32_bf16 v17, v101, v45, v17
    v_dot2_f32_bf16 v25, v101, v49, v25
    v_dot2_f32_bf16 v18, v105, v45, v18
    v_dot2_f32_bf16 v26, v105, v49, v26
    v_dot2_f32_bf16 v19, v109, v45, v19
    v_dot2_f32_bf16 v27, v109, v49, v27
    v_dot2_f32_bf16 v20, v113, v45, v20
    v_dot2_f32_bf16 v28, v113, v49, v28
    v_dot2_f32_bf16 v21, v117, v45, v21
    v_dot2_f32_bf16 v29, v117, v49, v29
    v_dot2_f32_bf16 v22, v121, v45, v22
    v_dot2_f32_bf16 v30, v121, v49, v30
    v_dot2_f32_bf16 v23, v125, v45, v23
    v_dot2_f32_bf16 v31, v125, v49, v31
    v_dot2_f32_bf16 v16, v98, v46, v16
    v_dot2_f32_bf16 v24, v98, v50, v24
    v_dot2_f32_bf16 v17, v102, v46, v17
    v_dot2_f32_bf16 v25, v102, v50, v25
    v_dot2_f32_bf16 v18, v106, v46, v18
    v_dot2_f32_bf16 v26, v106, v50, v26
    v_dot2_f32_bf16 v19, v110, v46, v19
    v_dot2_f32_bf16 v27, v110, v50, v27
    v_dot2_f32_bf16 v20, v114, v46, v20
    v_dot2_f32_bf16 v28, v114, v50, v28
    v_dot2_f32_bf16 v21, v118, v46, v21
    v_dot2_f32_bf16 v29, v118, v50, v29
    v_dot2_f32_bf16 v22, v122, v46, v22
    v_dot2_f32_bf16 v30, v122, v50, v30
    v_dot2_f32_bf16 v23, v126, v46, v23
    v_dot2_f32_bf16 v31, v126, v50, v31
    v_dot2_f32_bf16 v16, v99, v47, v16
    v_dot2_f32_bf16 v24, v99, v51, v24
    v_dot2_f32_bf16 v17, v103, v47, v17
    v_dot2_f32_bf16 v25, v103, v51, v25
    v_dot2_f32_bf16 v18, v107, v47, v18
    v_dot2_f32_bf16 v26, v107, v51, v26
    v_dot2_f32_bf16 v19, v111, v47, v19
    v_dot2_f32_bf16 v27, v111, v51, v27
    v_dot2_f32_bf16 v20, v115, v47, v20
    v_dot2_f32_bf16 v28, v115, v51, v28
    v_dot2_f32_bf16 v21, v119, v47, v21
    v_dot2_f32_bf16 v29, v119, v51, v29
    v_dot2_f32_bf16 v22, v123, v47, v22
    v_dot2_f32_bf16 v30, v123, v51, v30
    v_dot2_f32_bf16 v23, v127, v47, v23
    v_dot2_f32_bf16 v31, v127, v51, v31
    s_add_u32 s63, s71, 1638400
    buffer_load_dwordx4 v[96:99], v4, s[40:43], s63 offen offset:0 nt
    s_add_u32 s63, s63, 40960
    buffer_load_dwordx4 v[100:103], v4, s[40:43], s63 offen offset:0 nt
    s_add_u32 s63, s63, 40960
    buffer_load_dwordx4 v[104:107], v4, s[40:43], s63 offen offset:0 nt
    s_add_u32 s63, s63, 40960
    buffer_load_dwordx4 v[108:111], v4, s[40:43], s63 offen offset:0 nt
    s_add_u32 s63, s63, 40960
    buffer_load_dwordx4 v[112:115], v4, s[40:43], s63 offen offset:0 nt
    s_add_u32 s63, s63, 40960
    buffer_load_dwordx4 v[116:119], v4, s[40:43], s63 offen offset:0 nt
    s_add_u32 s63, s63, 40960
    buffer_load_dwordx4 v[120:123], v4, s[40:43], s63 offen offset:0 nt
    s_add_u32 s63, s63, 40960
    buffer_load_dwordx4 v[124:127], v4, s[40:43], s63 offen offset:0 nt
    v_add_f32_dpp v16, v24, v16 quad_perm:[1,0,3,2] row_mask:0xf bank_mask:0xf
    v_add_f32_dpp v17, v25, v17 quad_perm:[1,0,3,2] row_mask:0xf bank_mask:0xf
    v_add_f32_dpp v18, v26, v18 quad_perm:[1,0,3,2] row_mask:0xf bank_mask:0xf
    v_add_f32_dpp v19, v27, v19 quad_perm:[1,0,3,2] row_mask:0xf bank_mask:0xf
    v_add_f32_dpp v20, v28, v20 quad_perm:[1,0,3,2] row_mask:0xf bank_mask:0xf
    v_add_f32_dpp v21, v29, v21 quad_perm:[1,0,3,2] row_mask:0xf bank_mask:0xf
    v_add_f32_dpp v22, v30, v22 quad_perm:[1,0,3,2] row_mask:0xf bank_mask:0xf
    v_add_f32_dpp v23, v31, v23 quad_perm:[1,0,3,2] row_mask:0xf bank_mask:0xf
    v_add_f32_dpp v16, v16, v16 quad_perm:[2,3,0,1] row_mask:0xf bank_mask:0xf
    v_add_f32_dpp v17, v17, v17 quad_perm:[2,3,0,1] row_mask:0xf bank_mask:0xf
    v_add_f32_dpp v18, v18, v18 quad_perm:[2,3,0,1] row_mask:0xf bank_mask:0xf
    v_add_f32_dpp v19, v19, v19 quad_perm:[2,3,0,1] row_mask:0xf bank_mask:0xf
    v_add_f32_dpp v20, v20, v20 quad_perm:[2,3,0,1] row_mask:0xf bank_mask:0xf
    v_add_f32_dpp v21, v21, v21 quad_perm:[2,3,0,1] row_mask:0xf bank_mask:0xf
    v_add_f32_dpp v22, v22, v22 quad_perm:[2,3,0,1] row_mask:0xf bank_mask:0xf
    v_add_f32_dpp v23, v23, v23 quad_perm:[2,3,0,1] row_mask:0xf bank_mask:0xf
    v_add_f32_dpp v16, v16, v16 row_ror:4 row_mask:0xf bank_mask:0xf
    v_add_f32_dpp v17, v17, v17 row_ror:4 row_mask:0xf bank_mask:0xf
    v_add_f32_dpp v18, v18, v18 row_ror:4 row_mask:0xf bank_mask:0xf
    v_add_f32_dpp v19, v19, v19 row_ror:4 row_mask:0xf bank_mask:0xf
    v_add_f32_dpp v20, v20, v20 row_ror:4 row_mask:0xf bank_mask:0xf
    v_add_f32_dpp v21, v21, v21 row_ror:4 row_mask:0xf bank_mask:0xf
    v_add_f32_dpp v22, v22, v22 row_ror:4 row_mask:0xf bank_mask:0xf
    v_add_f32_dpp v23, v23, v23 row_ror:4 row_mask:0xf bank_mask:0xf
    v_add_f32_dpp v16, v16, v16 row_ror:8 row_mask:0xf bank_mask:0xf
    v_add_f32_dpp v17, v17, v17 row_ror:8 row_mask:0xf bank_mask:0xf
    v_add_f32_dpp v18, v18, v18 row_ror:8 row_mask:0xf bank_mask:0xf
    v_add_f32_dpp v19, v19, v19 row_ror:8 row_mask:0xf bank_mask:0xf
    v_add_f32_dpp v20, v20, v20 row_ror:8 row_mask:0xf bank_mask:0xf
    v_add_f32_dpp v21, v21, v21 row_ror:8 row_mask:0xf bank_mask:0xf
    v_add_f32_dpp v22, v22, v22 row_ror:8 row_mask:0xf bank_mask:0xf
    v_add_f32_dpp v23, v23, v23 row_ror:8 row_mask:0xf bank_mask:0xf
    v_max3_f32 v8, v16, v17, v18
    v_max3_f32 v9, v19, v20, v21
    v_max3_f32 v8, v8, v22, v23
    v_max_f32 v8, v8, v9
    v_mov_b32 v9, v8
    s_nop 1
    v_permlane16_swap_b32 v8, v9
    v_max_f32 v8, v8, v9
    v_mov_b32 v9, v8
    s_nop 1
    v_permlane32_swap_b32 v8, v9
    v_max_f32 v8, v8, v9
    v_cmp_gt_f32 vcc, v8, v6
    s_cmp_eq_u64 vcc, 0
    s_cbranch_scc1 L_nors_16
    v_max_f32 v8, v8, v6
    v_sub_f32 v10, v6, v8
    v_mul_f32 v10, s64, v10
    v_exp_f32 v10, v10
    v_mov_b32 v6, v8
    v_mul_f32 v7, v7, v10
    v_mul_f32 v192, v192, v10
    v_mul_f32 v193, v193, v10
    v_mul_f32 v194, v194, v10
    v_mul_f32 v195, v195, v10
    v_mul_f32 v196, v196, v10
    v_mul_f32 v197, v197, v10
    v_mul_f32 v198, v198, v10
    v_mul_f32 v199, v199, v10
    v_mul_f32 v200, v200, v10
    v_mul_f32 v201, v201, v10
    v_mul_f32 v202, v202, v10
    v_mul_f32 v203, v203, v10
    v_mul_f32 v204, v204, v10
    v_mul_f32 v205, v205, v10
    v_mul_f32 v206, v206, v10
    v_mul_f32 v207, v207, v10
    v_mul_f32 v208, v208, v10
    v_mul_f32 v209, v209, v10
    v_mul_f32 v210, v210, v10
    v_mul_f32 v211, v211, v10
    v_mul_f32 v212, v212, v10
    v_mul_f32 v213, v213, v10
    v_mul_f32 v214, v214, v10
    v_mul_f32 v215, v215, v10
    v_mul_f32 v216, v216, v10
    v_mul_f32 v217, v217, v10
    v_mul_f32 v218, v218, v10
    v_mul_f32 v219, v219, v10
    v_mul_f32 v220, v220, v10
    v_mul_f32 v221, v221, v10
    v_mul_f32 v222, v222, v10
    v_mul_f32 v223, v223, v10
L_nors_16:
    v_mul_f32 v8, s64, v6
    v_fma_f32 v16, v16, s64, -v8
    v_fma_f32 v17, v17, s64, -v8
    v_fma_f32 v18, v18, s64, -v8
    v_fma_f32 v19, v19, s64, -v8
    v_fma_f32 v20, v20, s64, -v8
    v_fma_f32 v21, v21, s64, -v8
    v_fma_f32 v22, v22, s64, -v8
    v_fma_f32 v23, v23, s64, -v8
    v_exp_f32 v16, v16
    v_exp_f32 v17, v17
    v_exp_f32 v18, v18
    v_exp_f32 v19, v19
    v_exp_f32 v20, v20
    v_exp_f32 v21, v21
    v_exp_f32 v22, v22
    v_exp_f32 v23, v23
    v_cvt_pk_bf16_f32 v24, v16, v17
    v_cvt_pk_bf16_f32 v25, v18, v19
    v_cvt_pk_bf16_f32 v26, v20, v21
    v_cvt_pk_bf16_f32 v27, v22, v23
    v_add_f32 v16, v16, v20
    v_add_f32 v17, v17, v21
    v_add_f32 v18, v18, v22
    v_add_f32 v19, v19, v23
    v_add_f32 v16, v16, v18
    v_add_f32 v17, v17, v19
    v_add_f32 v16, v16, v17
    v_add_f32 v7, v7, v16
    s_waitcnt vmcnt(24)
    v_perm_b32 v32, v164, v160, s65
    v_perm_b32 v33, v172, v168, s65
    v_perm_b32 v34, v180, v176, s65
    v_perm_b32 v35, v188, v184, s65
    s_nop 1
    v_mfma_f32_16x16x32_bf16 v[192:195], v[32:35], v[24:27], v[192:195]
    v_perm_b32 v36, v164, v160, s66
    v_perm_b32 v37, v172, v168, s66
    v_perm_b32 v38, v180, v176, s66
    v_perm_b32 v39, v188, v184, s66
    s_nop 1
    v_mfma_f32_16x16x32_bf16 v[196:199], v[36:39], v[24:27], v[196:199]
    v_perm_b32 v40, v165, v161, s65
    v_perm_b32 v41, v173, v169, s65
    v_perm_b32 v42, v181, v177, s65
    v_perm_b32 v43, v189, v185, s65
    s_nop 1
    v_mfma_f32_16x16x32_bf16 v[200:203], v[40:43], v[24:27], v[200:203]
    v_perm_b32 v32, v165, v161, s66
    v_perm_b32 v33, v173, v169, s66
    v_perm_b32 v34, v181, v177, s66
    v_perm_b32 v35, v189, v185, s66
    s_nop 1
    v_mfma_f32_16x16x32_bf16 v[204:207], v[32:35], v[24:27], v[204:207]
    v_perm_b32 v36, v166, v162, s65
    v_perm_b32 v37, v174, v170, s65
    v_perm_b32 v38, v182, v178, s65
    v_perm_b32 v39, v190, v186, s65
    s_nop 1
    v_mfma_f32_16x16x32_bf16 v[208:211], v[36:39], v[24:27], v[208:211]
    v_perm_b32 v40, v166, v162, s66
    v_perm_b32 v41, v174, v170, s66
    v_perm_b32 v42, v182, v178, s66
    v_perm_b32 v43, v190, v186, s66
    s_nop 1
    v_mfma_f32_16x16x32_bf16 v[212:215], v[40:43], v[24:27], v[212:215]
    v_perm_b32 v32, v167, v163, s65
    v_perm_b32 v33, v175, v171, s65
    v_perm_b32 v34, v183, v179, s65
    v_perm_b32 v35, v191, v187, s65
    s_nop 1
    v_mfma_f32_16x16x32_bf16 v[216:219], v[32:35], v[24:27], v[216:219]
    v_perm_b32 v36, v167, v163, s66
    v_perm_b32 v37, v175, v171, s66
    v_perm_b32 v38, v183, v179, s66
    v_perm_b32 v39, v191, v187, s66
    s_nop 1
    v_mfma_f32_16x16x32_bf16 v[220:223], v[36:39], v[24:27], v[220:223]
    s_add_u32 s63, s71, 1638400
    buffer_load_dwordx4 v[160:163], v4, s[44:47], s63 offen offset:0 nt
    s_add_u32 s63, s63, 40960
    buffer_load_dwordx4 v[164:167], v4, s[44:47], s63 offen offset:0 nt
    s_add_u32 s63, s63, 40960
    buffer_load_dwordx4 v[168:171], v4, s[44:47], s63 offen offset:0 nt
    s_add_u32 s63, s63, 40960
    buffer_load_dwordx4 v[172:175], v4, s[44:47], s63 offen offset:0 nt
    s_add_u32 s63, s63, 40960
    buffer_load_dwordx4 v[176:179], v4, s[44:47], s63 offen offset:0 nt
    s_add_u32 s63, s63, 40960
    buffer_load_dwordx4 v[180:183], v4, s[44:47], s63 offen offset:0 nt
    s_add_u32 s63, s63, 40960
    buffer_load_dwordx4 v[184:187], v4, s[44:47], s63 offen offset:0 nt
    s_add_u32 s63, s63, 40960
    buffer_load_dwordx4 v[188:191], v4, s[44:47], s63 offen offset:0 nt
    s_waitcnt vmcnt(24)
    v_dot2_f32_bf16 v16, v64, v44, 0
    v_dot2_f32_bf16 v24, v64, v48, 0
    v_dot2_f32_bf16 v17, v68, v44, 0
    v_dot2_f32_bf16 v25, v68, v48, 0
    v_dot2_f32_bf16 v18, v72, v44, 0
    v_dot2_f32_bf16 v26, v72, v48, 0
    v_dot2_f32_bf16 v19, v76, v44, 0
    v_dot2_f32_bf16 v27, v76, v48, 0
    v_dot2_f32_bf16 v20, v80, v44, 0
    v_dot2_f32_bf16 v28, v80, v48, 0
    v_dot2_f32_bf16 v21, v84, v44, 0
    v_dot2_f32_bf16 v29, v84, v48, 0
    v_dot2_f32_bf16 v22, v88, v44, 0
    v_dot2_f32_bf16 v30, v88, v48, 0
    v_dot2_f32_bf16 v23, v92, v44, 0
    v_dot2_f32_bf16 v31, v92, v48, 0
    v_dot2_f32_bf16 v16, v65, v45, v16
    v_dot2_f32_bf16 v24, v65, v49, v24
    v_dot2_f32_bf16 v17, v69, v45, v17
    v_dot2_f32_bf16 v25, v69, v49, v25
    v_dot2_f32_bf16 v18, v73, v45, v18
    v_dot2_f32_bf16 v26, v73, v49, v26
    v_dot2_f32_bf16 v19, v77, v45, v19
    v_dot2_f32_bf16 v27, v77, v49, v27
    v_dot2_f32_bf16 v20, v81, v45, v20
    v_dot2_f32_bf16 v28, v81, v49, v28
    v_dot2_f32_bf16 v21, v85, v45, v21
    v_dot2_f32_bf16 v29, v85, v49, v29
    v_dot2_f32_bf16 v22, v89, v45, v22
    v_dot2_f32_bf16 v30, v89, v49, v30
    v_dot2_f32_bf16 v23, v93, v45, v23
    v_dot2_f32_bf16 v31, v93, v49, v31
    v_dot2_f32_bf16 v16, v66, v46, v16
    v_dot2_f32_bf16 v24, v66, v50, v24
    v_dot2_f32_bf16 v17, v70, v46, v17
    v_dot2_f32_bf16 v25, v70, v50, v25
    v_dot2_f32_bf16 v18, v74, v46, v18
    v_dot2_f32_bf16 v26, v74, v50, v26
    v_dot2_f32_bf16 v19, v78, v46, v19
    v_dot2_f32_bf16 v27, v78, v50, v27
    v_dot2_f32_bf16 v20, v82, v46, v20
    v_dot2_f32_bf16 v28, v82, v50, v28
    v_dot2_f32_bf16 v21, v86, v46, v21
    v_dot2_f32_bf16 v29, v86, v50, v29
    v_dot2_f32_bf16 v22, v90, v46, v22
    v_dot2_f32_bf16 v30, v90, v50, v30
    v_dot2_f32_bf16 v23, v94, v46, v23
    v_dot2_f32_bf16 v31, v94, v50, v31
    v_dot2_f32_bf16 v16, v67, v47, v16
    v_dot2_f32_bf16 v24, v67, v51, v24
    v_dot2_f32_bf16 v17, v71, v47, v17
    v_dot2_f32_bf16 v25, v71, v51, v25
    v_dot2_f32_bf16 v18, v75, v47, v18
    v_dot2_f32_bf16 v26, v75, v51, v26
    v_dot2_f32_bf16 v19, v79, v47, v19
    v_dot2_f32_bf16 v27, v79, v51, v27
    v_dot2_f32_bf16 v20, v83, v47, v20
    v_dot2_f32_bf16 v28, v83, v51, v28
    v_dot2_f32_bf16 v21, v87, v47, v21
    v_dot2_f32_bf16 v29, v87, v51, v29
    v_dot2_f32_bf16 v22, v91, v47, v22
    v_dot2_f32_bf16 v30, v91, v51, v30
    v_dot2_f32_bf16 v23, v95, v47, v23
    v_dot2_f32_bf16 v31, v95, v51, v31
    s_add_u32 s63, s71, 1966080
    buffer_load_dwordx4 v[64:67], v4, s[40:43], s63 offen offset:0 nt
    s_add_u32 s63, s63, 40960
    buffer_load_dwordx4 v[68:71], v4, s[40:43], s63 offen offset:0 nt
    s_add_u32 s63, s63, 40960
    buffer_load_dwordx4 v[72:75], v4, s[40:43], s63 offen offset:0 nt
    s_add_u32 s63, s63, 40960
    buffer_load_dwordx4 v[76:79], v4, s[40:43], s63 offen offset:0 nt
    s_add_u32 s63, s63, 40960
    buffer_load_dwordx4 v[80:83], v4, s[40:43], s63 offen offset:0 nt
    s_add_u32 s63, s63, 40960
    buffer_load_dwordx4 v[84:87], v4, s[40:43], s63 offen offset:0 nt
    s_add_u32 s63, s63, 40960
    buffer_load_dwordx4 v[88:91], v4, s[40:43], s63 offen offset:0 nt
    s_add_u32 s63, s63, 40960
    buffer_load_dwordx4 v[92:95], v4, s[40:43], s63 offen offset:0 nt
    v_add_f32_dpp v16, v24, v16 quad_perm:[1,0,3,2] row_mask:0xf bank_mask:0xf
    v_add_f32_dpp v17, v25, v17 quad_perm:[1,0,3,2] row_mask:0xf bank_mask:0xf
    v_add_f32_dpp v18, v26, v18 quad_perm:[1,0,3,2] row_mask:0xf bank_mask:0xf
    v_add_f32_dpp v19, v27, v19 quad_perm:[1,0,3,2] row_mask:0xf bank_mask:0xf
    v_add_f32_dpp v20, v28, v20 quad_perm:[1,0,3,2] row_mask:0xf bank_mask:0xf
    v_add_f32_dpp v21, v29, v21 quad_perm:[1,0,3,2] row_mask:0xf bank_mask:0xf
    v_add_f32_dpp v22, v30, v22 quad_perm:[1,0,3,2] row_mask:0xf bank_mask:0xf
    v_add_f32_dpp v23, v31, v23 quad_perm:[1,0,3,2] row_mask:0xf bank_mask:0xf
    v_add_f32_dpp v16, v16, v16 quad_perm:[2,3,0,1] row_mask:0xf bank_mask:0xf
    v_add_f32_dpp v17, v17, v17 quad_perm:[2,3,0,1] row_mask:0xf bank_mask:0xf
    v_add_f32_dpp v18, v18, v18 quad_perm:[2,3,0,1] row_mask:0xf bank_mask:0xf
    v_add_f32_dpp v19, v19, v19 quad_perm:[2,3,0,1] row_mask:0xf bank_mask:0xf
    v_add_f32_dpp v20, v20, v20 quad_perm:[2,3,0,1] row_mask:0xf bank_mask:0xf
    v_add_f32_dpp v21, v21, v21 quad_perm:[2,3,0,1] row_mask:0xf bank_mask:0xf
    v_add_f32_dpp v22, v22, v22 quad_perm:[2,3,0,1] row_mask:0xf bank_mask:0xf
    v_add_f32_dpp v23, v23, v23 quad_perm:[2,3,0,1] row_mask:0xf bank_mask:0xf
    v_add_f32_dpp v16, v16, v16 row_ror:4 row_mask:0xf bank_mask:0xf
    v_add_f32_dpp v17, v17, v17 row_ror:4 row_mask:0xf bank_mask:0xf
    v_add_f32_dpp v18, v18, v18 row_ror:4 row_mask:0xf bank_mask:0xf
    v_add_f32_dpp v19, v19, v19 row_ror:4 row_mask:0xf bank_mask:0xf
    v_add_f32_dpp v20, v20, v20 row_ror:4 row_mask:0xf bank_mask:0xf
    v_add_f32_dpp v21, v21, v21 row_ror:4 row_mask:0xf bank_mask:0xf
    v_add_f32_dpp v22, v22, v22 row_ror:4 row_mask:0xf bank_mask:0xf
    v_add_f32_dpp v23, v23, v23 row_ror:4 row_mask:0xf bank_mask:0xf
    v_add_f32_dpp v16, v16, v16 row_ror:8 row_mask:0xf bank_mask:0xf
    v_add_f32_dpp v17, v17, v17 row_ror:8 row_mask:0xf bank_mask:0xf
    v_add_f32_dpp v18, v18, v18 row_ror:8 row_mask:0xf bank_mask:0xf
    v_add_f32_dpp v19, v19, v19 row_ror:8 row_mask:0xf bank_mask:0xf
    v_add_f32_dpp v20, v20, v20 row_ror:8 row_mask:0xf bank_mask:0xf
    v_add_f32_dpp v21, v21, v21 row_ror:8 row_mask:0xf bank_mask:0xf
    v_add_f32_dpp v22, v22, v22 row_ror:8 row_mask:0xf bank_mask:0xf
    v_add_f32_dpp v23, v23, v23 row_ror:8 row_mask:0xf bank_mask:0xf
    v_max3_f32 v8, v16, v17, v18
    v_max3_f32 v9, v19, v20, v21
    v_max3_f32 v8, v8, v22, v23
    v_max_f32 v8, v8, v9
    v_mov_b32 v9, v8
    s_nop 1
    v_permlane16_swap_b32 v8, v9
    v_max_f32 v8, v8, v9
    v_mov_b32 v9, v8
    s_nop 1
    v_permlane32_swap_b32 v8, v9
    v_max_f32 v8, v8, v9
    v_cmp_gt_f32 vcc, v8, v6
    s_cmp_eq_u64 vcc, 0
    s_cbranch_scc1 L_nors_17
    v_max_f32 v8, v8, v6
    v_sub_f32 v10, v6, v8
    v_mul_f32 v10, s64, v10
    v_exp_f32 v10, v10
    v_mov_b32 v6, v8
    v_mul_f32 v7, v7, v10
    v_mul_f32 v192, v192, v10
    v_mul_f32 v193, v193, v10
    v_mul_f32 v194, v194, v10
    v_mul_f32 v195, v195, v10
    v_mul_f32 v196, v196, v10
    v_mul_f32 v197, v197, v10
    v_mul_f32 v198, v198, v10
    v_mul_f32 v199, v199, v10
    v_mul_f32 v200, v200, v10
    v_mul_f32 v201, v201, v10
    v_mul_f32 v202, v202, v10
    v_mul_f32 v203, v203, v10
    v_mul_f32 v204, v204, v10
    v_mul_f32 v205, v205, v10
    v_mul_f32 v206, v206, v10
    v_mul_f32 v207, v207, v10
    v_mul_f32 v208, v208, v10
    v_mul_f32 v209, v209, v10
    v_mul_f32 v210, v210, v10
    v_mul_f32 v211, v211, v10
    v_mul_f32 v212, v212, v10
    v_mul_f32 v213, v213, v10
    v_mul_f32 v214, v214, v10
    v_mul_f32 v215, v215, v10
    v_mul_f32 v216, v216, v10
    v_mul_f32 v217, v217, v10
    v_mul_f32 v218, v218, v10
    v_mul_f32 v219, v219, v10
    v_mul_f32 v220, v220, v10
    v_mul_f32 v221, v221, v10
    v_mul_f32 v222, v222, v10
    v_mul_f32 v223, v223, v10
L_nors_17:
    v_mul_f32 v8, s64, v6
    v_fma_f32 v16, v16, s64, -v8
    v_fma_f32 v17, v17, s64, -v8
    v_fma_f32 v18, v18, s64, -v8
    v_fma_f32 v19, v19, s64, -v8
    v_fma_f32 v20, v20, s64, -v8
    v_fma_f32 v21, v21, s64, -v8
    v_fma_f32 v22, v22, s64, -v8
    v_fma_f32 v23, v23, s64, -v8
    v_exp_f32 v16, v16
    v_exp_f32 v17, v17
    v_exp_f32 v18, v18
    v_exp_f32 v19, v19
    v_exp_f32 v20, v20
    v_exp_f32 v21, v21
    v_exp_f32 v22, v22
    v_exp_f32 v23, v23
    v_cvt_pk_bf16_f32 v24, v16, v17
    v_cvt_pk_bf16_f32 v25, v18, v19
    v_cvt_pk_bf16_f32 v26, v20, v21
    v_cvt_pk_bf16_f32 v27, v22, v23
    v_add_f32 v16, v16, v20
    v_add_f32 v17, v17, v21
    v_add_f32 v18, v18, v22
    v_add_f32 v19, v19, v23
    v_add_f32 v16, v16, v18
    v_add_f32 v17, v17, v19
    v_add_f32 v16, v16, v17
    v_add_f32 v7, v7, v16
    s_waitcnt vmcnt(24)
    v_perm_b32 v32, v132, v128, s65
    v_perm_b32 v33, v140, v136, s65
    v_perm_b32 v34, v148, v144, s65
    v_perm_b32 v35, v156, v152, s65
    s_nop 1
    v_mfma_f32_16x16x32_bf16 v[192:195], v[32:35], v[24:27], v[192:195]
    v_perm_b32 v36, v132, v128, s66
    v_perm_b32 v37, v140, v136, s66
    v_perm_b32 v38, v148, v144, s66
    v_perm_b32 v39, v156, v152, s66
    s_nop 1
    v_mfma_f32_16x16x32_bf16 v[196:199], v[36:39], v[24:27], v[196:199]
    v_perm_b32 v40, v133, v129, s65
    v_perm_b32 v41, v141, v137, s65
    v_perm_b32 v42, v149, v145, s65
    v_perm_b32 v43, v157, v153, s65
    s_nop 1
    v_mfma_f32_16x16x32_bf16 v[200:203], v[40:43], v[24:27], v[200:203]
    v_perm_b32 v32, v133, v129, s66
    v_perm_b32 v33, v141, v137, s66
    v_perm_b32 v34, v149, v145, s66
    v_perm_b32 v35, v157, v153, s66
    s_nop 1
    v_mfma_f32_16x16x32_bf16 v[204:207], v[32:35], v[24:27], v[204:207]
    v_perm_b32 v36, v134, v130, s65
    v_perm_b32 v37, v142, v138, s65
    v_perm_b32 v38, v150, v146, s65
    v_perm_b32 v39, v158, v154, s65
    s_nop 1
    v_mfma_f32_16x16x32_bf16 v[208:211], v[36:39], v[24:27], v[208:211]
    v_perm_b32 v40, v134, v130, s66
    v_perm_b32 v41, v142, v138, s66
    v_perm_b32 v42, v150, v146, s66
    v_perm_b32 v43, v158, v154, s66
    s_nop 1
    v_mfma_f32_16x16x32_bf16 v[212:215], v[40:43], v[24:27], v[212:215]
    v_perm_b32 v32, v135, v131, s65
    v_perm_b32 v33, v143, v139, s65
    v_perm_b32 v34, v151, v147, s65
    v_perm_b32 v35, v159, v155, s65
    s_nop 1
    v_mfma_f32_16x16x32_bf16 v[216:219], v[32:35], v[24:27], v[216:219]
    v_perm_b32 v36, v135, v131, s66
    v_perm_b32 v37, v143, v139, s66
    v_perm_b32 v38, v151, v147, s66
    v_perm_b32 v39, v159, v155, s66
    s_nop 1
    v_mfma_f32_16x16x32_bf16 v[220:223], v[36:39], v[24:27], v[220:223]
    s_add_u32 s63, s71, 1966080
    buffer_load_dwordx4 v[128:131], v4, s[44:47], s63 offen offset:0 nt
    s_add_u32 s63, s63, 40960
    buffer_load_dwordx4 v[132:135], v4, s[44:47], s63 offen offset:0 nt
    s_add_u32 s63, s63, 40960
    buffer_load_dwordx4 v[136:139], v4, s[44:47], s63 offen offset:0 nt
    s_add_u32 s63, s63, 40960
    buffer_load_dwordx4 v[140:143], v4, s[44:47], s63 offen offset:0 nt
    s_add_u32 s63, s63, 40960
    buffer_load_dwordx4 v[144:147], v4, s[44:47], s63 offen offset:0 nt
    s_add_u32 s63, s63, 40960
    buffer_load_dwordx4 v[148:151], v4, s[44:47], s63 offen offset:0 nt
    s_add_u32 s63, s63, 40960
    buffer_load_dwordx4 v[152:155], v4, s[44:47], s63 offen offset:0 nt
    s_add_u32 s63, s63, 40960
    buffer_load_dwordx4 v[156:159], v4, s[44:47], s63 offen offset:0 nt
    s_waitcnt vmcnt(24)
    v_dot2_f32_bf16 v16, v96, v44, 0
    v_dot2_f32_bf16 v24, v96, v48, 0
    v_dot2_f32_bf16 v17, v100, v44, 0
    v_dot2_f32_bf16 v25, v100, v48, 0
    v_dot2_f32_bf16 v18, v104, v44, 0
    v_dot2_f32_bf16 v26, v104, v48, 0
    v_dot2_f32_bf16 v19, v108, v44, 0
    v_dot2_f32_bf16 v27, v108, v48, 0
    v_dot2_f32_bf16 v20, v112, v44, 0
    v_dot2_f32_bf16 v28, v112, v48, 0
    v_dot2_f32_bf16 v21, v116, v44, 0
    v_dot2_f32_bf16 v29, v116, v48, 0
    v_dot2_f32_bf16 v22, v120, v44, 0
    v_dot2_f32_bf16 v30, v120, v48, 0
    v_dot2_f32_bf16 v23, v124, v44, 0
    v_dot2_f32_bf16 v31, v124, v48, 0
    v_dot2_f32_bf16 v16, v97, v45, v16
    v_dot2_f32_bf16 v24, v97, v49, v24
    v_dot2_f32_bf16 v17, v101, v45, v17
    v_dot2_f32_bf16 v25, v101, v49, v25
    v_dot2_f32_bf16 v18, v105, v45, v18
    v_dot2_f32_bf16 v26, v105, v49, v26
    v_dot2_f32_bf16 v19, v109, v45, v19
    v_dot2_f32_bf16 v27, v109, v49, v27
    v_dot2_f32_bf16 v20, v113, v45, v20
    v_dot2_f32_bf16 v28, v113, v49, v28
    v_dot2_f32_bf16 v21, v117, v45, v21
    v_dot2_f32_bf16 v29, v117, v49, v29
    v_dot2_f32_bf16 v22, v121, v45, v22
    v_dot2_f32_bf16 v30, v121, v49, v30
    v_dot2_f32_bf16 v23, v125, v45, v23
    v_dot2_f32_bf16 v31, v125, v49, v31
    v_dot2_f32_bf16 v16, v98, v46, v16
    v_dot2_f32_bf16 v24, v98, v50, v24
    v_dot2_f32_bf16 v17, v102, v46, v17
    v_dot2_f32_bf16 v25, v102, v50, v25
    v_dot2_f32_bf16 v18, v106, v46, v18
    v_dot2_f32_bf16 v26, v106, v50, v26
    v_dot2_f32_bf16 v19, v110, v46, v19
    v_dot2_f32_bf16 v27, v110, v50, v27
    v_dot2_f32_bf16 v20, v114, v46, v20
    v_dot2_f32_bf16 v28, v114, v50, v28
    v_dot2_f32_bf16 v21, v118, v46, v21
    v_dot2_f32_bf16 v29, v118, v50, v29
    v_dot2_f32_bf16 v22, v122, v46, v22
    v_dot2_f32_bf16 v30, v122, v50, v30
    v_dot2_f32_bf16 v23, v126, v46, v23
    v_dot2_f32_bf16 v31, v126, v50, v31
    v_dot2_f32_bf16 v16, v99, v47, v16
    v_dot2_f32_bf16 v24, v99, v51, v24
    v_dot2_f32_bf16 v17, v103, v47, v17
    v_dot2_f32_bf16 v25, v103, v51, v25
    v_dot2_f32_bf16 v18, v107, v47, v18
    v_dot2_f32_bf16 v26, v107, v51, v26
    v_dot2_f32_bf16 v19, v111, v47, v19
    v_dot2_f32_bf16 v27, v111, v51, v27
    v_dot2_f32_bf16 v20, v115, v47, v20
    v_dot2_f32_bf16 v28, v115, v51, v28
    v_dot2_f32_bf16 v21, v119, v47, v21
    v_dot2_f32_bf16 v29, v119, v51, v29
    v_dot2_f32_bf16 v22, v123, v47, v22
    v_dot2_f32_bf16 v30, v123, v51, v30
    v_dot2_f32_bf16 v23, v127, v47, v23
    v_dot2_f32_bf16 v31, v127, v51, v31
    v_add_f32_dpp v16, v24, v16 quad_perm:[1,0,3,2] row_mask:0xf bank_mask:0xf
    v_add_f32_dpp v17, v25, v17 quad_perm:[1,0,3,2] row_mask:0xf bank_mask:0xf
    v_add_f32_dpp v18, v26, v18 quad_perm:[1,0,3,2] row_mask:0xf bank_mask:0xf
    v_add_f32_dpp v19, v27, v19 quad_perm:[1,0,3,2] row_mask:0xf bank_mask:0xf
    v_add_f32_dpp v20, v28, v20 quad_perm:[1,0,3,2] row_mask:0xf bank_mask:0xf
    v_add_f32_dpp v21, v29, v21 quad_perm:[1,0,3,2] row_mask:0xf bank_mask:0xf
    v_add_f32_dpp v22, v30, v22 quad_perm:[1,0,3,2] row_mask:0xf bank_mask:0xf
    v_add_f32_dpp v23, v31, v23 quad_perm:[1,0,3,2] row_mask:0xf bank_mask:0xf
    v_add_f32_dpp v16, v16, v16 quad_perm:[2,3,0,1] row_mask:0xf bank_mask:0xf
    v_add_f32_dpp v17, v17, v17 quad_perm:[2,3,0,1] row_mask:0xf bank_mask:0xf
    v_add_f32_dpp v18, v18, v18 quad_perm:[2,3,0,1] row_mask:0xf bank_mask:0xf
    v_add_f32_dpp v19, v19, v19 quad_perm:[2,3,0,1] row_mask:0xf bank_mask:0xf
    v_add_f32_dpp v20, v20, v20 quad_perm:[2,3,0,1] row_mask:0xf bank_mask:0xf
    v_add_f32_dpp v21, v21, v21 quad_perm:[2,3,0,1] row_mask:0xf bank_mask:0xf
    v_add_f32_dpp v22, v22, v22 quad_perm:[2,3,0,1] row_mask:0xf bank_mask:0xf
    v_add_f32_dpp v23, v23, v23 quad_perm:[2,3,0,1] row_mask:0xf bank_mask:0xf
    v_add_f32_dpp v16, v16, v16 row_ror:4 row_mask:0xf bank_mask:0xf
    v_add_f32_dpp v17, v17, v17 row_ror:4 row_mask:0xf bank_mask:0xf
    v_add_f32_dpp v18, v18, v18 row_ror:4 row_mask:0xf bank_mask:0xf
    v_add_f32_dpp v19, v19, v19 row_ror:4 row_mask:0xf bank_mask:0xf
    v_add_f32_dpp v20, v20, v20 row_ror:4 row_mask:0xf bank_mask:0xf
    v_add_f32_dpp v21, v21, v21 row_ror:4 row_mask:0xf bank_mask:0xf
    v_add_f32_dpp v22, v22, v22 row_ror:4 row_mask:0xf bank_mask:0xf
    v_add_f32_dpp v23, v23, v23 row_ror:4 row_mask:0xf bank_mask:0xf
    v_add_f32_dpp v16, v16, v16 row_ror:8 row_mask:0xf bank_mask:0xf
    v_add_f32_dpp v17, v17, v17 row_ror:8 row_mask:0xf bank_mask:0xf
    v_add_f32_dpp v18, v18, v18 row_ror:8 row_mask:0xf bank_mask:0xf
    v_add_f32_dpp v19, v19, v19 row_ror:8 row_mask:0xf bank_mask:0xf
    v_add_f32_dpp v20, v20, v20 row_ror:8 row_mask:0xf bank_mask:0xf
    v_add_f32_dpp v21, v21, v21 row_ror:8 row_mask:0xf bank_mask:0xf
    v_add_f32_dpp v22, v22, v22 row_ror:8 row_mask:0xf bank_mask:0xf
    v_add_f32_dpp v23, v23, v23 row_ror:8 row_mask:0xf bank_mask:0xf
    v_max3_f32 v8, v16, v17, v18
    v_max3_f32 v9, v19, v20, v21
    v_max3_f32 v8, v8, v22, v23
    v_max_f32 v8, v8, v9
    v_mov_b32 v9, v8
    s_nop 1
    v_permlane16_swap_b32 v8, v9
    v_max_f32 v8, v8, v9
    v_mov_b32 v9, v8
    s_nop 1
    v_permlane32_swap_b32 v8, v9
    v_max_f32 v8, v8, v9
    v_cmp_gt_f32 vcc, v8, v6
    s_cmp_eq_u64 vcc, 0
    s_cbranch_scc1 L_nors_18
    v_max_f32 v8, v8, v6
    v_sub_f32 v10, v6, v8
    v_mul_f32 v10, s64, v10
    v_exp_f32 v10, v10
    v_mov_b32 v6, v8
    v_mul_f32 v7, v7, v10
    v_mul_f32 v192, v192, v10
    v_mul_f32 v193, v193, v10
    v_mul_f32 v194, v194, v10
    v_mul_f32 v195, v195, v10
    v_mul_f32 v196, v196, v10
    v_mul_f32 v197, v197, v10
    v_mul_f32 v198, v198, v10
    v_mul_f32 v199, v199, v10
    v_mul_f32 v200, v200, v10
    v_mul_f32 v201, v201, v10
    v_mul_f32 v202, v202, v10
    v_mul_f32 v203, v203, v10
    v_mul_f32 v204, v204, v10
    v_mul_f32 v205, v205, v10
    v_mul_f32 v206, v206, v10
    v_mul_f32 v207, v207, v10
    v_mul_f32 v208, v208, v10
    v_mul_f32 v209, v209, v10
    v_mul_f32 v210, v210, v10
    v_mul_f32 v211, v211, v10
    v_mul_f32 v212, v212, v10
    v_mul_f32 v213, v213, v10
    v_mul_f32 v214, v214, v10
    v_mul_f32 v215, v215, v10
    v_mul_f32 v216, v216, v10
    v_mul_f32 v217, v217, v10
    v_mul_f32 v218, v218, v10
    v_mul_f32 v219, v219, v10
    v_mul_f32 v220, v220, v10
    v_mul_f32 v221, v221, v10
    v_mul_f32 v222, v222, v10
    v_mul_f32 v223, v223, v10
L_nors_18:
    v_mul_f32 v8, s64, v6
    v_fma_f32 v16, v16, s64, -v8
    v_fma_f32 v17, v17, s64, -v8
    v_fma_f32 v18, v18, s64, -v8
    v_fma_f32 v19, v19, s64, -v8
    v_fma_f32 v20, v20, s64, -v8
    v_fma_f32 v21, v21, s64, -v8
    v_fma_f32 v22, v22, s64, -v8
    v_fma_f32 v23, v23, s64, -v8
    v_exp_f32 v16, v16
    v_exp_f32 v17, v17
    v_exp_f32 v18, v18
    v_exp_f32 v19, v19
    v_exp_f32 v20, v20
    v_exp_f32 v21, v21
    v_exp_f32 v22, v22
    v_exp_f32 v23, v23
    v_cvt_pk_bf16_f32 v24, v16, v17
    v_cvt_pk_bf16_f32 v25, v18, v19
    v_cvt_pk_bf16_f32 v26, v20, v21
    v_cvt_pk_bf16_f32 v27, v22, v23
    v_add_f32 v16, v16, v20
    v_add_f32 v17, v17, v21
    v_add_f32 v18, v18, v22
    v_add_f32 v19, v19, v23
    v_add_f32 v16, v16, v18
    v_add_f32 v17, v17, v19
    v_add_f32 v16, v16, v17
    v_add_f32 v7, v7, v16
    s_waitcnt vmcnt(16)
    v_perm_b32 v32, v164, v160, s65
    v_perm_b32 v33, v172, v168, s65
    v_perm_b32 v34, v180, v176, s65
    v_perm_b32 v35, v188, v184, s65
    s_nop 1
    v_mfma_f32_16x16x32_bf16 v[192:195], v[32:35], v[24:27], v[192:195]
    v_perm_b32 v36, v164, v160, s66
    v_perm_b32 v37, v172, v168, s66
    v_perm_b32 v38, v180, v176, s66
    v_perm_b32 v39, v188, v184, s66
    s_nop 1
    v_mfma_f32_16x16x32_bf16 v[196:199], v[36:39], v[24:27], v[196:199]
    v_perm_b32 v40, v165, v161, s65
    v_perm_b32 v41, v173, v169, s65
    v_perm_b32 v42, v181, v177, s65
    v_perm_b32 v43, v189, v185, s65
    s_nop 1
    v_mfma_f32_16x16x32_bf16 v[200:203], v[40:43], v[24:27], v[200:203]
    v_perm_b32 v32, v165, v161, s66
    v_perm_b32 v33, v173, v169, s66
    v_perm_b32 v34, v181, v177, s66
    v_perm_b32 v35, v189, v185, s66
    s_nop 1
    v_mfma_f32_16x16x32_bf16 v[204:207], v[32:35], v[24:27], v[204:207]
    v_perm_b32 v36, v166, v162, s65
    v_perm_b32 v37, v174, v170, s65
    v_perm_b32 v38, v182, v178, s65
    v_perm_b32 v39, v190, v186, s65
    s_nop 1
    v_mfma_f32_16x16x32_bf16 v[208:211], v[36:39], v[24:27], v[208:211]
    v_perm_b32 v40, v166, v162, s66
    v_perm_b32 v41, v174, v170, s66
    v_perm_b32 v42, v182, v178, s66
    v_perm_b32 v43, v190, v186, s66
    s_nop 1
    v_mfma_f32_16x16x32_bf16 v[212:215], v[40:43], v[24:27], v[212:215]
    v_perm_b32 v32, v167, v163, s65
    v_perm_b32 v33, v175, v171, s65
    v_perm_b32 v34, v183, v179, s65
    v_perm_b32 v35, v191, v187, s65
    s_nop 1
    v_mfma_f32_16x16x32_bf16 v[216:219], v[32:35], v[24:27], v[216:219]
    v_perm_b32 v36, v167, v163, s66
    v_perm_b32 v37, v175, v171, s66
    v_perm_b32 v38, v183, v179, s66
    v_perm_b32 v39, v191, v187, s66
    s_nop 1
    v_mfma_f32_16x16x32_bf16 v[220:223], v[36:39], v[24:27], v[220:223]
    s_lshl_b32 s60, s57, 7
    s_add_u32 s60, s60, 120832
    v_min_u32 v251, 9, v1
    v_lshlrev_b32 v251, 3, v251
    v_add_u32 v251, s60, v251
    buffer_load_dwordx2 v[252:253], v251, s[12:15], 0 offen sc1
    s_waitcnt vmcnt(9)
    v_dot2_f32_bf16 v16, v64, v44, 0
    v_dot2_f32_bf16 v24, v64, v48, 0
    v_dot2_f32_bf16 v17, v68, v44, 0
    v_dot2_f32_bf16 v25, v68, v48, 0
    v_dot2_f32_bf16 v18, v72, v44, 0
    v_dot2_f32_bf16 v26, v72, v48, 0
    v_dot2_f32_bf16 v19, v76, v44, 0
    v_dot2_f32_bf16 v27, v76, v48, 0
    v_dot2_f32_bf16 v20, v80, v44, 0
    v_dot2_f32_bf16 v28, v80, v48, 0
    v_dot2_f32_bf16 v21, v84, v44, 0
    v_dot2_f32_bf16 v29, v84, v48, 0
    v_dot2_f32_bf16 v22, v88, v44, 0
    v_dot2_f32_bf16 v30, v88, v48, 0
    v_dot2_f32_bf16 v23, v92, v44, 0
    v_dot2_f32_bf16 v31, v92, v48, 0
    v_dot2_f32_bf16 v16, v65, v45, v16
    v_dot2_f32_bf16 v24, v65, v49, v24
    v_dot2_f32_bf16 v17, v69, v45, v17
    v_dot2_f32_bf16 v25, v69, v49, v25
    v_dot2_f32_bf16 v18, v73, v45, v18
    v_dot2_f32_bf16 v26, v73, v49, v26
    v_dot2_f32_bf16 v19, v77, v45, v19
    v_dot2_f32_bf16 v27, v77, v49, v27
    v_dot2_f32_bf16 v20, v81, v45, v20
    v_dot2_f32_bf16 v28, v81, v49, v28
    v_dot2_f32_bf16 v21, v85, v45, v21
    v_dot2_f32_bf16 v29, v85, v49, v29
    v_dot2_f32_bf16 v22, v89, v45, v22
    v_dot2_f32_bf16 v30, v89, v49, v30
    v_dot2_f32_bf16 v23, v93, v45, v23
    v_dot2_f32_bf16 v31, v93, v49, v31
    v_dot2_f32_bf16 v16, v66, v46, v16
    v_dot2_f32_bf16 v24, v66, v50, v24
    v_dot2_f32_bf16 v17, v70, v46, v17
    v_dot2_f32_bf16 v25, v70, v50, v25
    v_dot2_f32_bf16 v18, v74, v46, v18
    v_dot2_f32_bf16 v26, v74, v50, v26
    v_dot2_f32_bf16 v19, v78, v46, v19
    v_dot2_f32_bf16 v27, v78, v50, v27
    v_dot2_f32_bf16 v20, v82, v46, v20
    v_dot2_f32_bf16 v28, v82, v50, v28
    v_dot2_f32_bf16 v21, v86, v46, v21
    v_dot2_f32_bf16 v29, v86, v50, v29
    v_dot2_f32_bf16 v22, v90, v46, v22
    v_dot2_f32_bf16 v30, v90, v50, v30
    v_dot2_f32_bf16 v23, v94, v46, v23
    v_dot2_f32_bf16 v31, v94, v50, v31
    v_dot2_f32_bf16 v16, v67, v47, v16
    v_dot2_f32_bf16 v24, v67, v51, v24
    v_dot2_f32_bf16 v17, v71, v47, v17
    v_dot2_f32_bf16 v25, v71, v51, v25
    v_dot2_f32_bf16 v18, v75, v47, v18
    v_dot2_f32_bf16 v26, v75, v51, v26
    v_dot2_f32_bf16 v19, v79, v47, v19
    v_dot2_f32_bf16 v27, v79, v51, v27
    v_dot2_f32_bf16 v20, v83, v47, v20
    v_dot2_f32_bf16 v28, v83, v51, v28
    v_dot2_f32_bf16 v21, v87, v47, v21
    v_dot2_f32_bf16 v29, v87, v51, v29
    v_dot2_f32_bf16 v22, v91, v47, v22
    v_dot2_f32_bf16 v30, v91, v51, v30
    v_dot2_f32_bf16 v23, v95, v47, v23
    v_dot2_f32_bf16 v31, v95, v51, v31
    v_add_f32_dpp v16, v24, v16 quad_perm:[1,0,3,2] row_mask:0xf bank_mask:0xf
    v_add_f32_dpp v17, v25, v17 quad_perm:[1,0,3,2] row_mask:0xf bank_mask:0xf
    v_add_f32_dpp v18, v26, v18 quad_perm:[1,0,3,2] row_mask:0xf bank_mask:0xf
    v_add_f32_dpp v19, v27, v19 quad_perm:[1,0,3,2] row_mask:0xf bank_mask:0xf
    v_add_f32_dpp v20, v28, v20 quad_perm:[1,0,3,2] row_mask:0xf bank_mask:0xf
    v_add_f32_dpp v21, v29, v21 quad_perm:[1,0,3,2] row_mask:0xf bank_mask:0xf
    v_add_f32_dpp v22, v30, v22 quad_perm:[1,0,3,2] row_mask:0xf bank_mask:0xf
    v_add_f32_dpp v23, v31, v23 quad_perm:[1,0,3,2] row_mask:0xf bank_mask:0xf
    v_add_f32_dpp v16, v16, v16 quad_perm:[2,3,0,1] row_mask:0xf bank_mask:0xf
    v_add_f32_dpp v17, v17, v17 quad_perm:[2,3,0,1] row_mask:0xf bank_mask:0xf
    v_add_f32_dpp v18, v18, v18 quad_perm:[2,3,0,1] row_mask:0xf bank_mask:0xf
    v_add_f32_dpp v19, v19, v19 quad_perm:[2,3,0,1] row_mask:0xf bank_mask:0xf
    v_add_f32_dpp v20, v20, v20 quad_perm:[2,3,0,1] row_mask:0xf bank_mask:0xf
    v_add_f32_dpp v21, v21, v21 quad_perm:[2,3,0,1] row_mask:0xf bank_mask:0xf
    v_add_f32_dpp v22, v22, v22 quad_perm:[2,3,0,1] row_mask:0xf bank_mask:0xf
    v_add_f32_dpp v23, v23, v23 quad_perm:[2,3,0,1] row_mask:0xf bank_mask:0xf
    v_add_f32_dpp v16, v16, v16 row_ror:4 row_mask:0xf bank_mask:0xf
    v_add_f32_dpp v17, v17, v17 row_ror:4 row_mask:0xf bank_mask:0xf
    v_add_f32_dpp v18, v18, v18 row_ror:4 row_mask:0xf bank_mask:0xf
    v_add_f32_dpp v19, v19, v19 row_ror:4 row_mask:0xf bank_mask:0xf
    v_add_f32_dpp v20, v20, v20 row_ror:4 row_mask:0xf bank_mask:0xf
    v_add_f32_dpp v21, v21, v21 row_ror:4 row_mask:0xf bank_mask:0xf
    v_add_f32_dpp v22, v22, v22 row_ror:4 row_mask:0xf bank_mask:0xf
    v_add_f32_dpp v23, v23, v23 row_ror:4 row_mask:0xf bank_mask:0xf
    v_add_f32_dpp v16, v16, v16 row_ror:8 row_mask:0xf bank_mask:0xf
    v_add_f32_dpp v17, v17, v17 row_ror:8 row_mask:0xf bank_mask:0xf
    v_add_f32_dpp v18, v18, v18 row_ror:8 row_mask:0xf bank_mask:0xf
    v_add_f32_dpp v19, v19, v19 row_ror:8 row_mask:0xf bank_mask:0xf
    v_add_f32_dpp v20, v20, v20 row_ror:8 row_mask:0xf bank_mask:0xf
    v_add_f32_dpp v21, v21, v21 row_ror:8 row_mask:0xf bank_mask:0xf
    v_add_f32_dpp v22, v22, v22 row_ror:8 row_mask:0xf bank_mask:0xf
    v_add_f32_dpp v23, v23, v23 row_ror:8 row_mask:0xf bank_mask:0xf
    v_max3_f32 v8, v16, v17, v18
    v_max3_f32 v9, v19, v20, v21
    v_max3_f32 v8, v8, v22, v23
    v_max_f32 v8, v8, v9
    v_mov_b32 v9, v8
    s_nop 1
    v_permlane16_swap_b32 v8, v9
    v_max_f32 v8, v8, v9
    v_mov_b32 v9, v8
    s_nop 1
    v_permlane32_swap_b32 v8, v9
    v_max_f32 v8, v8, v9
    v_cmp_gt_f32 vcc, v8, v6
    s_cmp_eq_u64 vcc, 0
    s_cbranch_scc1 L_nors_19
    v_max_f32 v8, v8, v6
    v_sub_f32 v10, v6, v8
    v_mul_f32 v10, s64, v10
    v_exp_f32 v10, v10
    v_mov_b32 v6, v8
    v_mul_f32 v7, v7, v10
    v_mul_f32 v192, v192, v10
    v_mul_f32 v193, v193, v10
    v_mul_f32 v194, v194, v10
    v_mul_f32 v195, v195, v10
    v_mul_f32 v196, v196, v10
    v_mul_f32 v197, v197, v10
    v_mul_f32 v198, v198, v10
    v_mul_f32 v199, v199, v10
    v_mul_f32 v200, v200, v10
    v_mul_f32 v201, v201, v10
    v_mul_f32 v202, v202, v10
    v_mul_f32 v203, v203, v10
    v_mul_f32 v204, v204, v10
    v_mul_f32 v205, v205, v10
    v_mul_f32 v206, v206, v10
    v_mul_f32 v207, v207, v10
    v_mul_f32 v208, v208, v10
    v_mul_f32 v209, v209, v10
    v_mul_f32 v210, v210, v10
    v_mul_f32 v211, v211, v10
    v_mul_f32 v212, v212, v10
    v_mul_f32 v213, v213, v10
    v_mul_f32 v214, v214, v10
    v_mul_f32 v215, v215, v10
    v_mul_f32 v216, v216, v10
    v_mul_f32 v217, v217, v10
    v_mul_f32 v218, v218, v10
    v_mul_f32 v219, v219, v10
    v_mul_f32 v220, v220, v10
    v_mul_f32 v221, v221, v10
    v_mul_f32 v222, v222, v10
    v_mul_f32 v223, v223, v10
L_nors_19:
    v_mul_f32 v8, s64, v6
    v_fma_f32 v16, v16, s64, -v8
    v_fma_f32 v17, v17, s64, -v8
    v_fma_f32 v18, v18, s64, -v8
    v_fma_f32 v19, v19, s64, -v8
    v_fma_f32 v20, v20, s64, -v8
    v_fma_f32 v21, v21, s64, -v8
    v_fma_f32 v22, v22, s64, -v8
    v_fma_f32 v23, v23, s64, -v8
    v_exp_f32 v16, v16
    v_exp_f32 v17, v17
    v_exp_f32 v18, v18
    v_exp_f32 v19, v19
    v_exp_f32 v20, v20
    v_exp_f32 v21, v21
    v_exp_f32 v22, v22
    v_exp_f32 v23, v23
    v_cvt_pk_bf16_f32 v24, v16, v17
    v_cvt_pk_bf16_f32 v25, v18, v19
    v_cvt_pk_bf16_f32 v26, v20, v21
    v_cvt_pk_bf16_f32 v27, v22, v23
    v_add_f32 v16, v16, v20
    v_add_f32 v17, v17, v21
    v_add_f32 v18, v18, v22
    v_add_f32 v19, v19, v23
    v_add_f32 v16, v16, v18
    v_add_f32 v17, v17, v19
    v_add_f32 v16, v16, v17
    v_add_f32 v7, v7, v16
    s_waitcnt vmcnt(1)
    v_perm_b32 v32, v132, v128, s65
    v_perm_b32 v33, v140, v136, s65
    v_perm_b32 v34, v148, v144, s65
    v_perm_b32 v35, v156, v152, s65
    s_nop 1
    v_mfma_f32_16x16x32_bf16 v[192:195], v[32:35], v[24:27], v[192:195]
    v_perm_b32 v36, v132, v128, s66
    v_perm_b32 v37, v140, v136, s66
    v_perm_b32 v38, v148, v144, s66
    v_perm_b32 v39, v156, v152, s66
    s_nop 1
    v_mfma_f32_16x16x32_bf16 v[196:199], v[36:39], v[24:27], v[196:199]
    v_perm_b32 v40, v133, v129, s65
    v_perm_b32 v41, v141, v137, s65
    v_perm_b32 v42, v149, v145, s65
    v_perm_b32 v43, v157, v153, s65
    s_nop 1
    v_mfma_f32_16x16x32_bf16 v[200:203], v[40:43], v[24:27], v[200:203]
    v_perm_b32 v32, v133, v129, s66
    v_perm_b32 v33, v141, v137, s66
    v_perm_b32 v34, v149, v145, s66
    v_perm_b32 v35, v157, v153, s66
    s_nop 1
    v_mfma_f32_16x16x32_bf16 v[204:207], v[32:35], v[24:27], v[204:207]
    v_perm_b32 v36, v134, v130, s65
    v_perm_b32 v37, v142, v138, s65
    v_perm_b32 v38, v150, v146, s65
    v_perm_b32 v39, v158, v154, s65
    s_nop 1
    v_mfma_f32_16x16x32_bf16 v[208:211], v[36:39], v[24:27], v[208:211]
    v_perm_b32 v40, v134, v130, s66
    v_perm_b32 v41, v142, v138, s66
    v_perm_b32 v42, v150, v146, s66
    v_perm_b32 v43, v158, v154, s66
    s_nop 1
    v_mfma_f32_16x16x32_bf16 v[212:215], v[40:43], v[24:27], v[212:215]
    v_perm_b32 v32, v135, v131, s65
    v_perm_b32 v33, v143, v139, s65
    v_perm_b32 v34, v151, v147, s65
    v_perm_b32 v35, v159, v155, s65
    s_nop 1
    v_mfma_f32_16x16x32_bf16 v[216:219], v[32:35], v[24:27], v[216:219]
    v_perm_b32 v36, v135, v131, s66
    v_perm_b32 v37, v143, v139, s66
    v_perm_b32 v38, v151, v147, s66
    v_perm_b32 v39, v159, v155, s66
    s_nop 1
    v_mfma_f32_16x16x32_bf16 v[220:223], v[36:39], v[24:27], v[220:223]
    s_branch L_nolast_12
L_blate_13:
    s_waitcnt vmcnt(28)
    v_dot2_f32_bf16 v16, v64, v44, 0
    v_dot2_f32_bf16 v24, v64, v48, 0
    v_dot2_f32_bf16 v17, v68, v44, 0
    v_dot2_f32_bf16 v25, v68, v48, 0
    v_dot2_f32_bf16 v18, v72, v44, 0
    v_dot2_f32_bf16 v26, v72, v48, 0
    v_dot2_f32_bf16 v19, v76, v44, 0
    v_dot2_f32_bf16 v27, v76, v48, 0
    v_dot2_f32_bf16 v20, v80, v44, 0
    v_dot2_f32_bf16 v28, v80, v48, 0
    v_dot2_f32_bf16 v21, v84, v44, 0
    v_dot2_f32_bf16 v29, v84, v48, 0
    v_dot2_f32_bf16 v22, v88, v44, 0
    v_dot2_f32_bf16 v30, v88, v48, 0
    v_dot2_f32_bf16 v23, v92, v44, 0
    v_dot2_f32_bf16 v31, v92, v48, 0
    v_dot2_f32_bf16 v16, v65, v45, v16
    v_dot2_f32_bf16 v24, v65, v49, v24
    v_dot2_f32_bf16 v17, v69, v45, v17
    v_dot2_f32_bf16 v25, v69, v49, v25
    v_dot2_f32_bf16 v18, v73, v45, v18
    v_dot2_f32_bf16 v26, v73, v49, v26
    v_dot2_f32_bf16 v19, v77, v45, v19
    v_dot2_f32_bf16 v27, v77, v49, v27
    v_dot2_f32_bf16 v20, v81, v45, v20
    v_dot2_f32_bf16 v28, v81, v49, v28
    v_dot2_f32_bf16 v21, v85, v45, v21
    v_dot2_f32_bf16 v29, v85, v49, v29
    v_dot2_f32_bf16 v22, v89, v45, v22
    v_dot2_f32_bf16 v30, v89, v49, v30
    v_dot2_f32_bf16 v23, v93, v45, v23
    v_dot2_f32_bf16 v31, v93, v49, v31
    v_dot2_f32_bf16 v16, v66, v46, v16
    v_dot2_f32_bf16 v24, v66, v50, v24
    v_dot2_f32_bf16 v17, v70, v46, v17
    v_dot2_f32_bf16 v25, v70, v50, v25
    v_dot2_f32_bf16 v18, v74, v46, v18
    v_dot2_f32_bf16 v26, v74, v50, v26
    v_dot2_f32_bf16 v19, v78, v46, v19
    v_dot2_f32_bf16 v27, v78, v50, v27
    v_dot2_f32_bf16 v20, v82, v46, v20
    v_dot2_f32_bf16 v28, v82, v50, v28
    v_dot2_f32_bf16 v21, v86, v46, v21
    v_dot2_f32_bf16 v29, v86, v50, v29
    v_dot2_f32_bf16 v22, v90, v46, v22
    v_dot2_f32_bf16 v30, v90, v50, v30
    v_dot2_f32_bf16 v23, v94, v46, v23
    v_dot2_f32_bf16 v31, v94, v50, v31
    v_dot2_f32_bf16 v16, v67, v47, v16
    v_dot2_f32_bf16 v24, v67, v51, v24
    v_dot2_f32_bf16 v17, v71, v47, v17
    v_dot2_f32_bf16 v25, v71, v51, v25
    v_dot2_f32_bf16 v18, v75, v47, v18
    v_dot2_f32_bf16 v26, v75, v51, v26
    v_dot2_f32_bf16 v19, v79, v47, v19
    v_dot2_f32_bf16 v27, v79, v51, v27
    v_dot2_f32_bf16 v20, v83, v47, v20
    v_dot2_f32_bf16 v28, v83, v51, v28
    v_dot2_f32_bf16 v21, v87, v47, v21
    v_dot2_f32_bf16 v29, v87, v51, v29
    v_dot2_f32_bf16 v22, v91, v47, v22
    v_dot2_f32_bf16 v30, v91, v51, v30
    v_dot2_f32_bf16 v23, v95, v47, v23
    v_dot2_f32_bf16 v31, v95, v51, v31
    s_add_u32 s63, s71, 655360
    buffer_load_dwordx4 v[64:67], v4, s[40:43], s63 offen offset:0 nt
    s_add_u32 s63, s63, 40960
    buffer_load_dwordx4 v[68:71], v4, s[40:43], s63 offen offset:0 nt
    s_add_u32 s63, s63, 40960
    buffer_load_dwordx4 v[72:75], v4, s[40:43], s63 offen offset:0 nt
    s_add_u32 s63, s63, 40960
    buffer_load_dwordx4 v[76:79], v4, s[40:43], s63 offen offset:0 nt
    s_add_u32 s63, s63, 40960
    buffer_load_dwordx4 v[80:83], v4, s[40:43], s63 offen offset:0 nt
    s_add_u32 s63, s63, 40960
    buffer_load_dwordx4 v[84:87], v4, s[40:43], s63 offen offset:0 nt
    s_add_u32 s63, s63, 40960
    buffer_load_dwordx4 v[88:91], v4, s[40:43], s63 offen offset:0 nt
    s_add_u32 s63, s63, 40960
    buffer_load_dwordx4 v[92:95], v4, s[40:43], s63 offen offset:0 nt
    v_add_f32_dpp v16, v24, v16 quad_perm:[1,0,3,2] row_mask:0xf bank_mask:0xf
    v_add_f32_dpp v17, v25, v17 quad_perm:[1,0,3,2] row_mask:0xf bank_mask:0xf
    v_add_f32_dpp v18, v26, v18 quad_perm:[1,0,3,2] row_mask:0xf bank_mask:0xf
    v_add_f32_dpp v19, v27, v19 quad_perm:[1,0,3,2] row_mask:0xf bank_mask:0xf
    v_add_f32_dpp v20, v28, v20 quad_perm:[1,0,3,2] row_mask:0xf bank_mask:0xf
    v_add_f32_dpp v21, v29, v21 quad_perm:[1,0,3,2] row_mask:0xf bank_mask:0xf
    v_add_f32_dpp v22, v30, v22 quad_perm:[1,0,3,2] row_mask:0xf bank_mask:0xf
    v_add_f32_dpp v23, v31, v23 quad_perm:[1,0,3,2] row_mask:0xf bank_mask:0xf
    v_add_f32_dpp v16, v16, v16 quad_perm:[2,3,0,1] row_mask:0xf bank_mask:0xf
    v_add_f32_dpp v17, v17, v17 quad_perm:[2,3,0,1] row_mask:0xf bank_mask:0xf
    v_add_f32_dpp v18, v18, v18 quad_perm:[2,3,0,1] row_mask:0xf bank_mask:0xf
    v_add_f32_dpp v19, v19, v19 quad_perm:[2,3,0,1] row_mask:0xf bank_mask:0xf
    v_add_f32_dpp v20, v20, v20 quad_perm:[2,3,0,1] row_mask:0xf bank_mask:0xf
    v_add_f32_dpp v21, v21, v21 quad_perm:[2,3,0,1] row_mask:0xf bank_mask:0xf
    v_add_f32_dpp v22, v22, v22 quad_perm:[2,3,0,1] row_mask:0xf bank_mask:0xf
    v_add_f32_dpp v23, v23, v23 quad_perm:[2,3,0,1] row_mask:0xf bank_mask:0xf
    v_add_f32_dpp v16, v16, v16 row_ror:4 row_mask:0xf bank_mask:0xf
    v_add_f32_dpp v17, v17, v17 row_ror:4 row_mask:0xf bank_mask:0xf
    v_add_f32_dpp v18, v18, v18 row_ror:4 row_mask:0xf bank_mask:0xf
    v_add_f32_dpp v19, v19, v19 row_ror:4 row_mask:0xf bank_mask:0xf
    v_add_f32_dpp v20, v20, v20 row_ror:4 row_mask:0xf bank_mask:0xf
    v_add_f32_dpp v21, v21, v21 row_ror:4 row_mask:0xf bank_mask:0xf
    v_add_f32_dpp v22, v22, v22 row_ror:4 row_mask:0xf bank_mask:0xf
    v_add_f32_dpp v23, v23, v23 row_ror:4 row_mask:0xf bank_mask:0xf
    v_add_f32_dpp v16, v16, v16 row_ror:8 row_mask:0xf bank_mask:0xf
    v_add_f32_dpp v17, v17, v17 row_ror:8 row_mask:0xf bank_mask:0xf
    v_add_f32_dpp v18, v18, v18 row_ror:8 row_mask:0xf bank_mask:0xf
    v_add_f32_dpp v19, v19, v19 row_ror:8 row_mask:0xf bank_mask:0xf
    v_add_f32_dpp v20, v20, v20 row_ror:8 row_mask:0xf bank_mask:0xf
    v_add_f32_dpp v21, v21, v21 row_ror:8 row_mask:0xf bank_mask:0xf
    v_add_f32_dpp v22, v22, v22 row_ror:8 row_mask:0xf bank_mask:0xf
    v_add_f32_dpp v23, v23, v23 row_ror:8 row_mask:0xf bank_mask:0xf
    v_max3_f32 v8, v16, v17, v18
    v_max3_f32 v9, v19, v20, v21
    v_max3_f32 v8, v8, v22, v23
    v_max_f32 v8, v8, v9
    v_mov_b32 v9, v8
    s_nop 1
    v_permlane16_swap_b32 v8, v9
    v_max_f32 v8, v8, v9
    v_mov_b32 v9, v8
    s_nop 1
    v_permlane32_swap_b32 v8, v9
    v_max_f32 v8, v8, v9
    v_mov_b32 v6, v8
    v_mul_f32 v8, s64, v6
    v_fma_f32 v16, v16, s64, -v8
    v_fma_f32 v17, v17, s64, -v8
    v_fma_f32 v18, v18, s64, -v8
    v_fma_f32 v19, v19, s64, -v8
    v_fma_f32 v20, v20, s64, -v8
    v_fma_f32 v21, v21, s64, -v8
    v_fma_f32 v22, v22, s64, -v8
    v_fma_f32 v23, v23, s64, -v8
    v_exp_f32 v16, v16
    v_exp_f32 v17, v17
    v_exp_f32 v18, v18
    v_exp_f32 v19, v19
    v_exp_f32 v20, v20
    v_exp_f32 v21, v21
    v_exp_f32 v22, v22
    v_exp_f32 v23, v23
    v_cvt_pk_bf16_f32 v24, v16, v17
    v_cvt_pk_bf16_f32 v25, v18, v19
    v_cvt_pk_bf16_f32 v26, v20, v21
    v_cvt_pk_bf16_f32 v27, v22, v23
    v_add_f32 v16, v16, v20
    v_add_f32 v17, v17, v21
    v_add_f32 v18, v18, v22
    v_add_f32 v19, v19, v23
    v_add_f32 v16, v16, v18
    v_add_f32 v17, v17, v19
    v_add_f32 v16, v16, v17
    v_mov_b32 v7, v16
    s_waitcnt vmcnt(28)
    v_perm_b32 v32, v132, v128, s65
    v_perm_b32 v33, v140, v136, s65
    v_perm_b32 v34, v148, v144, s65
    v_perm_b32 v35, v156, v152, s65
    s_nop 1
    v_mfma_f32_16x16x32_bf16 v[192:195], v[32:35], v[24:27], 0
    v_perm_b32 v36, v132, v128, s66
    v_perm_b32 v37, v140, v136, s66
    v_perm_b32 v38, v148, v144, s66
    v_perm_b32 v39, v156, v152, s66
    s_nop 1
    v_mfma_f32_16x16x32_bf16 v[196:199], v[36:39], v[24:27], 0
    v_perm_b32 v40, v133, v129, s65
    v_perm_b32 v41, v141, v137, s65
    v_perm_b32 v42, v149, v145, s65
    v_perm_b32 v43, v157, v153, s65
    s_nop 1
    v_mfma_f32_16x16x32_bf16 v[200:203], v[40:43], v[24:27], 0
    v_perm_b32 v32, v133, v129, s66
    v_perm_b32 v33, v141, v137, s66
    v_perm_b32 v34, v149, v145, s66
    v_perm_b32 v35, v157, v153, s66
    s_nop 1
    v_mfma_f32_16x16x32_bf16 v[204:207], v[32:35], v[24:27], 0
    v_perm_b32 v36, v134, v130, s65
    v_perm_b32 v37, v142, v138, s65
    v_perm_b32 v38, v150, v146, s65
    v_perm_b32 v39, v158, v154, s65
    s_nop 1
    v_mfma_f32_16x16x32_bf16 v[208:211], v[36:39], v[24:27], 0
    v_perm_b32 v40, v134, v130, s66
    v_perm_b32 v41, v142, v138, s66
    v_perm_b32 v42, v150, v146, s66
    v_perm_b32 v43, v158, v154, s66
    s_nop 1
    v_mfma_f32_16x16x32_bf16 v[212:215], v[40:43], v[24:27], 0
    v_perm_b32 v32, v135, v131, s65
    v_perm_b32 v33, v143, v139, s65
    v_perm_b32 v34, v151, v147, s65
    v_perm_b32 v35, v159, v155, s65
    s_nop 1
    v_mfma_f32_16x16x32_bf16 v[216:219], v[32:35], v[24:27], 0
    v_perm_b32 v36, v135, v131, s66
    v_perm_b32 v37, v143, v139, s66
    v_perm_b32 v38, v151, v147, s66
    v_perm_b32 v39, v159, v155, s66
    s_nop 1
    v_mfma_f32_16x16x32_bf16 v[220:223], v[36:39], v[24:27], 0
    s_add_u32 s63, s71, 655360
    buffer_load_dwordx4 v[128:131], v4, s[44:47], s63 offen offset:0 nt
    s_add_u32 s63, s63, 40960
    buffer_load_dwordx4 v[132:135], v4, s[44:47], s63 offen offset:0 nt
    s_add_u32 s63, s63, 40960
    buffer_load_dwordx4 v[136:139], v4, s[44:47], s63 offen offset:0 nt
    s_add_u32 s63, s63, 40960
    buffer_load_dwordx4 v[140:143], v4, s[44:47], s63 offen offset:0 nt
    s_add_u32 s63, s63, 40960
    buffer_load_dwordx4 v[144:147], v4, s[44:47], s63 offen offset:0 nt
    s_add_u32 s63, s63, 40960
    buffer_load_dwordx4 v[148:151], v4, s[44:47], s63 offen offset:0 nt
    s_add_u32 s63, s63, 40960
    buffer_load_dwordx4 v[152:155], v4, s[44:47], s63 offen offset:0 nt
    s_add_u32 s63, s63, 40960
    buffer_load_dwordx4 v[156:159], v4, s[44:47], s63 offen offset:0 nt
    s_waitcnt vmcnt(28)
    v_dot2_f32_bf16 v16, v96, v44, 0
    v_dot2_f32_bf16 v24, v96, v48, 0
    v_dot2_f32_bf16 v17, v100, v44, 0
    v_dot2_f32_bf16 v25, v100, v48, 0
    v_dot2_f32_bf16 v18, v104, v44, 0
    v_dot2_f32_bf16 v26, v104, v48, 0
    v_dot2_f32_bf16 v19, v108, v44, 0
    v_dot2_f32_bf16 v27, v108, v48, 0
    v_dot2_f32_bf16 v20, v112, v44, 0
    v_dot2_f32_bf16 v28, v112, v48, 0
    v_dot2_f32_bf16 v21, v116, v44, 0
    v_dot2_f32_bf16 v29, v116, v48, 0
    v_dot2_f32_bf16 v22, v120, v44, 0
    v_dot2_f32_bf16 v30, v120, v48, 0
    v_dot2_f32_bf16 v23, v124, v44, 0
    v_dot2_f32_bf16 v31, v124, v48, 0
    v_dot2_f32_bf16 v16, v97, v45, v16
    v_dot2_f32_bf16 v24, v97, v49, v24
    v_dot2_f32_bf16 v17, v101, v45, v17
    v_dot2_f32_bf16 v25, v101, v49, v25
    v_dot2_f32_bf16 v18, v105, v45, v18
    v_dot2_f32_bf16 v26, v105, v49, v26
    v_dot2_f32_bf16 v19, v109, v45, v19
    v_dot2_f32_bf16 v27, v109, v49, v27
    v_dot2_f32_bf16 v20, v113, v45, v20
    v_dot2_f32_bf16 v28, v113, v49, v28
    v_dot2_f32_bf16 v21, v117, v45, v21
    v_dot2_f32_bf16 v29, v117, v49, v29
    v_dot2_f32_bf16 v22, v121, v45, v22
    v_dot2_f32_bf16 v30, v121, v49, v30
    v_dot2_f32_bf16 v23, v125, v45, v23
    v_dot2_f32_bf16 v31, v125, v49, v31
    v_dot2_f32_bf16 v16, v98, v46, v16
    v_dot2_f32_bf16 v24, v98, v50, v24
    v_dot2_f32_bf16 v17, v102, v46, v17
    v_dot2_f32_bf16 v25, v102, v50, v25
    v_dot2_f32_bf16 v18, v106, v46, v18
    v_dot2_f32_bf16 v26, v106, v50, v26
    v_dot2_f32_bf16 v19, v110, v46, v19
    v_dot2_f32_bf16 v27, v110, v50, v27
    v_dot2_f32_bf16 v20, v114, v46, v20
    v_dot2_f32_bf16 v28, v114, v50, v28
    v_dot2_f32_bf16 v21, v118, v46, v21
    v_dot2_f32_bf16 v29, v118, v50, v29
    v_dot2_f32_bf16 v22, v122, v46, v22
    v_dot2_f32_bf16 v30, v122, v50, v30
    v_dot2_f32_bf16 v23, v126, v46, v23
    v_dot2_f32_bf16 v31, v126, v50, v31
    v_dot2_f32_bf16 v16, v99, v47, v16
    v_dot2_f32_bf16 v24, v99, v51, v24
    v_dot2_f32_bf16 v17, v103, v47, v17
    v_dot2_f32_bf16 v25, v103, v51, v25
    v_dot2_f32_bf16 v18, v107, v47, v18
    v_dot2_f32_bf16 v26, v107, v51, v26
    v_dot2_f32_bf16 v19, v111, v47, v19
    v_dot2_f32_bf16 v27, v111, v51, v27
    v_dot2_f32_bf16 v20, v115, v47, v20
    v_dot2_f32_bf16 v28, v115, v51, v28
    v_dot2_f32_bf16 v21, v119, v47, v21
    v_dot2_f32_bf16 v29, v119, v51, v29
    v_dot2_f32_bf16 v22, v123, v47, v22
    v_dot2_f32_bf16 v30, v123, v51, v30
    v_dot2_f32_bf16 v23, v127, v47, v23
    v_dot2_f32_bf16 v31, v127, v51, v31
    s_add_u32 s63, s71, 983040
    buffer_load_dwordx4 v[96:99], v4, s[40:43], s63 offen offset:0 nt
    s_add_u32 s63, s63, 40960
    buffer_load_dwordx4 v[100:103], v4, s[40:43], s63 offen offset:0 nt
    s_add_u32 s63, s63, 40960
    buffer_load_dwordx4 v[104:107], v4, s[40:43], s63 offen offset:0 nt
    s_add_u32 s63, s63, 40960
    buffer_load_dwordx4 v[108:111], v4, s[40:43], s63 offen offset:0 nt
    s_add_u32 s63, s63, 40960
    buffer_load_dwordx4 v[112:115], v4, s[40:43], s63 offen offset:0 nt
    s_add_u32 s63, s63, 40960
    buffer_load_dwordx4 v[116:119], v4, s[40:43], s63 offen offset:0 nt
    s_add_u32 s63, s63, 40960
    buffer_load_dwordx4 v[120:123], v4, s[40:43], s63 offen offset:0 nt
    s_add_u32 s63, s63, 40960
    buffer_load_dwordx4 v[124:127], v4, s[40:43], s63 offen offset:0 nt
    v_add_f32_dpp v16, v24, v16 quad_perm:[1,0,3,2] row_mask:0xf bank_mask:0xf
    v_add_f32_dpp v17, v25, v17 quad_perm:[1,0,3,2] row_mask:0xf bank_mask:0xf
    v_add_f32_dpp v18, v26, v18 quad_perm:[1,0,3,2] row_mask:0xf bank_mask:0xf
    v_add_f32_dpp v19, v27, v19 quad_perm:[1,0,3,2] row_mask:0xf bank_mask:0xf
    v_add_f32_dpp v20, v28, v20 quad_perm:[1,0,3,2] row_mask:0xf bank_mask:0xf
    v_add_f32_dpp v21, v29, v21 quad_perm:[1,0,3,2] row_mask:0xf bank_mask:0xf
    v_add_f32_dpp v22, v30, v22 quad_perm:[1,0,3,2] row_mask:0xf bank_mask:0xf
    v_add_f32_dpp v23, v31, v23 quad_perm:[1,0,3,2] row_mask:0xf bank_mask:0xf
    v_add_f32_dpp v16, v16, v16 quad_perm:[2,3,0,1] row_mask:0xf bank_mask:0xf
    v_add_f32_dpp v17, v17, v17 quad_perm:[2,3,0,1] row_mask:0xf bank_mask:0xf
    v_add_f32_dpp v18, v18, v18 quad_perm:[2,3,0,1] row_mask:0xf bank_mask:0xf
    v_add_f32_dpp v19, v19, v19 quad_perm:[2,3,0,1] row_mask:0xf bank_mask:0xf
    v_add_f32_dpp v20, v20, v20 quad_perm:[2,3,0,1] row_mask:0xf bank_mask:0xf
    v_add_f32_dpp v21, v21, v21 quad_perm:[2,3,0,1] row_mask:0xf bank_mask:0xf
    v_add_f32_dpp v22, v22, v22 quad_perm:[2,3,0,1] row_mask:0xf bank_mask:0xf
    v_add_f32_dpp v23, v23, v23 quad_perm:[2,3,0,1] row_mask:0xf bank_mask:0xf
    v_add_f32_dpp v16, v16, v16 row_ror:4 row_mask:0xf bank_mask:0xf
    v_add_f32_dpp v17, v17, v17 row_ror:4 row_mask:0xf bank_mask:0xf
    v_add_f32_dpp v18, v18, v18 row_ror:4 row_mask:0xf bank_mask:0xf
    v_add_f32_dpp v19, v19, v19 row_ror:4 row_mask:0xf bank_mask:0xf
    v_add_f32_dpp v20, v20, v20 row_ror:4 row_mask:0xf bank_mask:0xf
    v_add_f32_dpp v21, v21, v21 row_ror:4 row_mask:0xf bank_mask:0xf
    v_add_f32_dpp v22, v22, v22 row_ror:4 row_mask:0xf bank_mask:0xf
    v_add_f32_dpp v23, v23, v23 row_ror:4 row_mask:0xf bank_mask:0xf
    v_add_f32_dpp v16, v16, v16 row_ror:8 row_mask:0xf bank_mask:0xf
    v_add_f32_dpp v17, v17, v17 row_ror:8 row_mask:0xf bank_mask:0xf
    v_add_f32_dpp v18, v18, v18 row_ror:8 row_mask:0xf bank_mask:0xf
    v_add_f32_dpp v19, v19, v19 row_ror:8 row_mask:0xf bank_mask:0xf
    v_add_f32_dpp v20, v20, v20 row_ror:8 row_mask:0xf bank_mask:0xf
    v_add_f32_dpp v21, v21, v21 row_ror:8 row_mask:0xf bank_mask:0xf
    v_add_f32_dpp v22, v22, v22 row_ror:8 row_mask:0xf bank_mask:0xf
    v_add_f32_dpp v23, v23, v23 row_ror:8 row_mask:0xf bank_mask:0xf
    v_max3_f32 v8, v16, v17, v18
    v_max3_f32 v9, v19, v20, v21
    v_max3_f32 v8, v8, v22, v23
    v_max_f32 v8, v8, v9
    v_mov_b32 v9, v8
    s_nop 1
    v_permlane16_swap_b32 v8, v9
    v_max_f32 v8, v8, v9
    v_mov_b32 v9, v8
    s_nop 1
    v_permlane32_swap_b32 v8, v9
    v_max_f32 v8, v8, v9
    v_cmp_gt_f32 vcc, v8, v6
    s_cmp_eq_u64 vcc, 0
    s_cbranch_scc1 L_nors_20
    v_max_f32 v8, v8, v6
    v_sub_f32 v10, v6, v8
    v_mul_f32 v10, s64, v10
    v_exp_f32 v10, v10
    v_mov_b32 v6, v8
    v_mul_f32 v7, v7, v10
    v_mul_f32 v192, v192, v10
    v_mul_f32 v193, v193, v10
    v_mul_f32 v194, v194, v10
    v_mul_f32 v195, v195, v10
    v_mul_f32 v196, v196, v10
    v_mul_f32 v197, v197, v10
    v_mul_f32 v198, v198, v10
    v_mul_f32 v199, v199, v10
    v_mul_f32 v200, v200, v10
    v_mul_f32 v201, v201, v10
    v_mul_f32 v202, v202, v10
    v_mul_f32 v203, v203, v10
    v_mul_f32 v204, v204, v10
    v_mul_f32 v205, v205, v10
    v_mul_f32 v206, v206, v10
    v_mul_f32 v207, v207, v10
    v_mul_f32 v208, v208, v10
    v_mul_f32 v209, v209, v10
    v_mul_f32 v210, v210, v10
    v_mul_f32 v211, v211, v10
    v_mul_f32 v212, v212, v10
    v_mul_f32 v213, v213, v10
    v_mul_f32 v214, v214, v10
    v_mul_f32 v215, v215, v10
    v_mul_f32 v216, v216, v10
    v_mul_f32 v217, v217, v10
    v_mul_f32 v218, v218, v10
    v_mul_f32 v219, v219, v10
    v_mul_f32 v220, v220, v10
    v_mul_f32 v221, v221, v10
    v_mul_f32 v222, v222, v10
    v_mul_f32 v223, v223, v10
L_nors_20:
    v_mul_f32 v8, s64, v6
    v_fma_f32 v16, v16, s64, -v8
    v_fma_f32 v17, v17, s64, -v8
    v_fma_f32 v18, v18, s64, -v8
    v_fma_f32 v19, v19, s64, -v8
    v_fma_f32 v20, v20, s64, -v8
    v_fma_f32 v21, v21, s64, -v8
    v_fma_f32 v22, v22, s64, -v8
    v_fma_f32 v23, v23, s64, -v8
    v_exp_f32 v16, v16
    v_exp_f32 v17, v17
    v_exp_f32 v18, v18
    v_exp_f32 v19, v19
    v_exp_f32 v20, v20
    v_exp_f32 v21, v21
    v_exp_f32 v22, v22
    v_exp_f32 v23, v23
    v_cvt_pk_bf16_f32 v24, v16, v17
    v_cvt_pk_bf16_f32 v25, v18, v19
    v_cvt_pk_bf16_f32 v26, v20, v21
    v_cvt_pk_bf16_f32 v27, v22, v23
    v_add_f32 v16, v16, v20
    v_add_f32 v17, v17, v21
    v_add_f32 v18, v18, v22
    v_add_f32 v19, v19, v23
    v_add_f32 v16, v16, v18
    v_add_f32 v17, v17, v19
    v_add_f32 v16, v16, v17
    v_add_f32 v7, v7, v16
    s_waitcnt vmcnt(28)
    v_perm_b32 v32, v164, v160, s65
    v_perm_b32 v33, v172, v168, s65
    v_perm_b32 v34, v180, v176, s65
    v_perm_b32 v35, v188, v184, s65
    s_nop 1
    v_mfma_f32_16x16x32_bf16 v[192:195], v[32:35], v[24:27], v[192:195]
    v_perm_b32 v36, v164, v160, s66
    v_perm_b32 v37, v172, v168, s66
    v_perm_b32 v38, v180, v176, s66
    v_perm_b32 v39, v188, v184, s66
    s_nop 1
    v_mfma_f32_16x16x32_bf16 v[196:199], v[36:39], v[24:27], v[196:199]
    v_perm_b32 v40, v165, v161, s65
    v_perm_b32 v41, v173, v169, s65
    v_perm_b32 v42, v181, v177, s65
    v_perm_b32 v43, v189, v185, s65
    s_nop 1
    v_mfma_f32_16x16x32_bf16 v[200:203], v[40:43], v[24:27], v[200:203]
    v_perm_b32 v32, v165, v161, s66
    v_perm_b32 v33, v173, v169, s66
    v_perm_b32 v34, v181, v177, s66
    v_perm_b32 v35, v189, v185, s66
    s_nop 1
    v_mfma_f32_16x16x32_bf16 v[204:207], v[32:35], v[24:27], v[204:207]
    v_perm_b32 v36, v166, v162, s65
    v_perm_b32 v37, v174, v170, s65
    v_perm_b32 v38, v182, v178, s65
    v_perm_b32 v39, v190, v186, s65
    s_nop 1
    v_mfma_f32_16x16x32_bf16 v[208:211], v[36:39], v[24:27], v[208:211]
    v_perm_b32 v40, v166, v162, s66
    v_perm_b32 v41, v174, v170, s66
    v_perm_b32 v42, v182, v178, s66
    v_perm_b32 v43, v190, v186, s66
    s_nop 1
    v_mfma_f32_16x16x32_bf16 v[212:215], v[40:43], v[24:27], v[212:215]
    v_perm_b32 v32, v167, v163, s65
    v_perm_b32 v33, v175, v171, s65
    v_perm_b32 v34, v183, v179, s65
    v_perm_b32 v35, v191, v187, s65
    s_nop 1
    v_mfma_f32_16x16x32_bf16 v[216:219], v[32:35], v[24:27], v[216:219]
    v_perm_b32 v36, v167, v163, s66
    v_perm_b32 v37, v175, v171, s66
    v_perm_b32 v38, v183, v179, s66
    v_perm_b32 v39, v191, v187, s66
    s_nop 1
    v_mfma_f32_16x16x32_bf16 v[220:223], v[36:39], v[24:27], v[220:223]
    s_add_u32 s63, s71, 983040
    buffer_load_dwordx4 v[160:163], v4, s[44:47], s63 offen offset:0 nt
    s_add_u32 s63, s63, 40960
    buffer_load_dwordx4 v[164:167], v4, s[44:47], s63 offen offset:0 nt
    s_add_u32 s63, s63, 40960
    buffer_load_dwordx4 v[168:171], v4, s[44:47], s63 offen offset:0 nt
    s_add_u32 s63, s63, 40960
    buffer_load_dwordx4 v[172:175], v4, s[44:47], s63 offen offset:0 nt
    s_add_u32 s63, s63, 40960
    buffer_load_dwordx4 v[176:179], v4, s[44:47], s63 offen offset:0 nt
    s_add_u32 s63, s63, 40960
    buffer_load_dwordx4 v[180:183], v4, s[44:47], s63 offen offset:0 nt
    s_add_u32 s63, s63, 40960
    buffer_load_dwordx4 v[184:187], v4, s[44:47], s63 offen offset:0 nt
    s_add_u32 s63, s63, 40960
    buffer_load_dwordx4 v[188:191], v4, s[44:47], s63 offen offset:0 nt
    s_lshl_b32 s60, s57, 7
    s_add_u32 s60, s60, 118784
    v_mov_b32 v53, s60
    v_mov_b32 v52, 1
    s_mov_b32 exec_lo, 0x1
    s_mov_b32 exec_hi, 0x0
    buffer_atomic_add v52, v53, s[12:15], 0 offen sc0 sc1
    s_mov_b64 exec, -1
    s_waitcnt vmcnt(25)
    v_dot2_f32_bf16 v16, v64, v44, 0
    v_dot2_f32_bf16 v24, v64, v48, 0
    v_dot2_f32_bf16 v17, v68, v44, 0
    v_dot2_f32_bf16 v25, v68, v48, 0
    v_dot2_f32_bf16 v18, v72, v44, 0
    v_dot2_f32_bf16 v26, v72, v48, 0
    v_dot2_f32_bf16 v19, v76, v44, 0
    v_dot2_f32_bf16 v27, v76, v48, 0
    v_dot2_f32_bf16 v20, v80, v44, 0
    v_dot2_f32_bf16 v28, v80, v48, 0
    v_dot2_f32_bf16 v21, v84, v44, 0
    v_dot2_f32_bf16 v29, v84, v48, 0
    v_dot2_f32_bf16 v22, v88, v44, 0
    v_dot2_f32_bf16 v30, v88, v48, 0
    v_dot2_f32_bf16 v23, v92, v44, 0
    v_dot2_f32_bf16 v31, v92, v48, 0
    v_dot2_f32_bf16 v16, v65, v45, v16
    v_dot2_f32_bf16 v24, v65, v49, v24
    v_dot2_f32_bf16 v17, v69, v45, v17
    v_dot2_f32_bf16 v25, v69, v49, v25
    v_dot2_f32_bf16 v18, v73, v45, v18
    v_dot2_f32_bf16 v26, v73, v49, v26
    v_dot2_f32_bf16 v19, v77, v45, v19
    v_dot2_f32_bf16 v27, v77, v49, v27
    v_dot2_f32_bf16 v20, v81, v45, v20
    v_dot2_f32_bf16 v28, v81, v49, v28
    v_dot2_f32_bf16 v21, v85, v45, v21
    v_dot2_f32_bf16 v29, v85, v49, v29
    v_dot2_f32_bf16 v22, v89, v45, v22
    v_dot2_f32_bf16 v30, v89, v49, v30
    v_dot2_f32_bf16 v23, v93, v45, v23
    v_dot2_f32_bf16 v31, v93, v49, v31
    v_dot2_f32_bf16 v16, v66, v46, v16
    v_dot2_f32_bf16 v24, v66, v50, v24
    v_dot2_f32_bf16 v17, v70, v46, v17
    v_dot2_f32_bf16 v25, v70, v50, v25
    v_dot2_f32_bf16 v18, v74, v46, v18
    v_dot2_f32_bf16 v26, v74, v50, v26
    v_dot2_f32_bf16 v19, v78, v46, v19
    v_dot2_f32_bf16 v27, v78, v50, v27
    v_dot2_f32_bf16 v20, v82, v46, v20
    v_dot2_f32_bf16 v28, v82, v50, v28
    v_dot2_f32_bf16 v21, v86, v46, v21
    v_dot2_f32_bf16 v29, v86, v50, v29
    v_dot2_f32_bf16 v22, v90, v46, v22
    v_dot2_f32_bf16 v30, v90, v50, v30
    v_dot2_f32_bf16 v23, v94, v46, v23
    v_dot2_f32_bf16 v31, v94, v50, v31
    v_dot2_f32_bf16 v16, v67, v47, v16
    v_dot2_f32_bf16 v24, v67, v51, v24
    v_dot2_f32_bf16 v17, v71, v47, v17
    v_dot2_f32_bf16 v25, v71, v51, v25
    v_dot2_f32_bf16 v18, v75, v47, v18
    v_dot2_f32_bf16 v26, v75, v51, v26
    v_dot2_f32_bf16 v19, v79, v47, v19
    v_dot2_f32_bf16 v27, v79, v51, v27
    v_dot2_f32_bf16 v20, v83, v47, v20
    v_dot2_f32_bf16 v28, v83, v51, v28
    v_dot2_f32_bf16 v21, v87, v47, v21
    v_dot2_f32_bf16 v29, v87, v51, v29
    v_dot2_f32_bf16 v22, v91, v47, v22
    v_dot2_f32_bf16 v30, v91, v51, v30
    v_dot2_f32_bf16 v23, v95, v47, v23
    v_dot2_f32_bf16 v31, v95, v51, v31
    s_add_u32 s63, s71, 1310720
    buffer_load_dwordx4 v[64:67], v4, s[40:43], s63 offen offset:0 nt
    s_add_u32 s63, s63, 40960
    buffer_load_dwordx4 v[68:71], v4, s[40:43], s63 offen offset:0 nt
    s_add_u32 s63, s63, 40960
    buffer_load_dwordx4 v[72:75], v4, s[40:43], s63 offen offset:0 nt
    s_add_u32 s63, s63, 40960
    buffer_load_dwordx4 v[76:79], v4, s[40:43], s63 offen offset:0 nt
    s_add_u32 s63, s63, 40960
    buffer_load_dwordx4 v[80:83], v4, s[40:43], s63 offen offset:0 nt
    s_add_u32 s63, s63, 40960
    buffer_load_dwordx4 v[84:87], v4, s[40:43], s63 offen offset:0 nt
    s_add_u32 s63, s63, 40960
    buffer_load_dwordx4 v[88:91], v4, s[40:43], s63 offen offset:0 nt
    s_add_u32 s63, s63, 40960
    buffer_load_dwordx4 v[92:95], v4, s[40:43], s63 offen offset:0 nt
    v_add_f32_dpp v16, v24, v16 quad_perm:[1,0,3,2] row_mask:0xf bank_mask:0xf
    v_add_f32_dpp v17, v25, v17 quad_perm:[1,0,3,2] row_mask:0xf bank_mask:0xf
    v_add_f32_dpp v18, v26, v18 quad_perm:[1,0,3,2] row_mask:0xf bank_mask:0xf
    v_add_f32_dpp v19, v27, v19 quad_perm:[1,0,3,2] row_mask:0xf bank_mask:0xf
    v_add_f32_dpp v20, v28, v20 quad_perm:[1,0,3,2] row_mask:0xf bank_mask:0xf
    v_add_f32_dpp v21, v29, v21 quad_perm:[1,0,3,2] row_mask:0xf bank_mask:0xf
    v_add_f32_dpp v22, v30, v22 quad_perm:[1,0,3,2] row_mask:0xf bank_mask:0xf
    v_add_f32_dpp v23, v31, v23 quad_perm:[1,0,3,2] row_mask:0xf bank_mask:0xf
    v_add_f32_dpp v16, v16, v16 quad_perm:[2,3,0,1] row_mask:0xf bank_mask:0xf
    v_add_f32_dpp v17, v17, v17 quad_perm:[2,3,0,1] row_mask:0xf bank_mask:0xf
    v_add_f32_dpp v18, v18, v18 quad_perm:[2,3,0,1] row_mask:0xf bank_mask:0xf
    v_add_f32_dpp v19, v19, v19 quad_perm:[2,3,0,1] row_mask:0xf bank_mask:0xf
    v_add_f32_dpp v20, v20, v20 quad_perm:[2,3,0,1] row_mask:0xf bank_mask:0xf
    v_add_f32_dpp v21, v21, v21 quad_perm:[2,3,0,1] row_mask:0xf bank_mask:0xf
    v_add_f32_dpp v22, v22, v22 quad_perm:[2,3,0,1] row_mask:0xf bank_mask:0xf
    v_add_f32_dpp v23, v23, v23 quad_perm:[2,3,0,1] row_mask:0xf bank_mask:0xf
    v_add_f32_dpp v16, v16, v16 row_ror:4 row_mask:0xf bank_mask:0xf
    v_add_f32_dpp v17, v17, v17 row_ror:4 row_mask:0xf bank_mask:0xf
    v_add_f32_dpp v18, v18, v18 row_ror:4 row_mask:0xf bank_mask:0xf
    v_add_f32_dpp v19, v19, v19 row_ror:4 row_mask:0xf bank_mask:0xf
    v_add_f32_dpp v20, v20, v20 row_ror:4 row_mask:0xf bank_mask:0xf
    v_add_f32_dpp v21, v21, v21 row_ror:4 row_mask:0xf bank_mask:0xf
    v_add_f32_dpp v22, v22, v22 row_ror:4 row_mask:0xf bank_mask:0xf
    v_add_f32_dpp v23, v23, v23 row_ror:4 row_mask:0xf bank_mask:0xf
    v_add_f32_dpp v16, v16, v16 row_ror:8 row_mask:0xf bank_mask:0xf
    v_add_f32_dpp v17, v17, v17 row_ror:8 row_mask:0xf bank_mask:0xf
    v_add_f32_dpp v18, v18, v18 row_ror:8 row_mask:0xf bank_mask:0xf
    v_add_f32_dpp v19, v19, v19 row_ror:8 row_mask:0xf bank_mask:0xf
    v_add_f32_dpp v20, v20, v20 row_ror:8 row_mask:0xf bank_mask:0xf
    v_add_f32_dpp v21, v21, v21 row_ror:8 row_mask:0xf bank_mask:0xf
    v_add_f32_dpp v22, v22, v22 row_ror:8 row_mask:0xf bank_mask:0xf
    v_add_f32_dpp v23, v23, v23 row_ror:8 row_mask:0xf bank_mask:0xf
    v_max3_f32 v8, v16, v17, v18
    v_max3_f32 v9, v19, v20, v21
    v_max3_f32 v8, v8, v22, v23
    v_max_f32 v8, v8, v9
    v_mov_b32 v9, v8
    s_nop 1
    v_permlane16_swap_b32 v8, v9
    v_max_f32 v8, v8, v9
    v_mov_b32 v9, v8
    s_nop 1
    v_permlane32_swap_b32 v8, v9
    v_max_f32 v8, v8, v9
    v_cmp_gt_f32 vcc, v8, v6
    s_cmp_eq_u64 vcc, 0
    s_cbranch_scc1 L_nors_21
    v_max_f32 v8, v8, v6
    v_sub_f32 v10, v6, v8
    v_mul_f32 v10, s64, v10
    v_exp_f32 v10, v10
    v_mov_b32 v6, v8
    v_mul_f32 v7, v7, v10
    v_mul_f32 v192, v192, v10
    v_mul_f32 v193, v193, v10
    v_mul_f32 v194, v194, v10
    v_mul_f32 v195, v195, v10
    v_mul_f32 v196, v196, v10
    v_mul_f32 v197, v197, v10
    v_mul_f32 v198, v198, v10
    v_mul_f32 v199, v199, v10
    v_mul_f32 v200, v200, v10
    v_mul_f32 v201, v201, v10
    v_mul_f32 v202, v202, v10
    v_mul_f32 v203, v203, v10
    v_mul_f32 v204, v204, v10
    v_mul_f32 v205, v205, v10
    v_mul_f32 v206, v206, v10
    v_mul_f32 v207, v207, v10
    v_mul_f32 v208, v208, v10
    v_mul_f32 v209, v209, v10
    v_mul_f32 v210, v210, v10
    v_mul_f32 v211, v211, v10
    v_mul_f32 v212, v212, v10
    v_mul_f32 v213, v213, v10
    v_mul_f32 v214, v214, v10
    v_mul_f32 v215, v215, v10
    v_mul_f32 v216, v216, v10
    v_mul_f32 v217, v217, v10
    v_mul_f32 v218, v218, v10
    v_mul_f32 v219, v219, v10
    v_mul_f32 v220, v220, v10
    v_mul_f32 v221, v221, v10
    v_mul_f32 v222, v222, v10
    v_mul_f32 v223, v223, v10
L_nors_21:
    v_mul_f32 v8, s64, v6
    v_fma_f32 v16, v16, s64, -v8
    v_fma_f32 v17, v17, s64, -v8
    v_fma_f32 v18, v18, s64, -v8
    v_fma_f32 v19, v19, s64, -v8
    v_fma_f32 v20, v20, s64, -v8
    v_fma_f32 v21, v21, s64, -v8
    v_fma_f32 v22, v22, s64, -v8
    v_fma_f32 v23, v23, s64, -v8
    v_exp_f32 v16, v16
    v_exp_f32 v17, v17
    v_exp_f32 v18, v18
    v_exp_f32 v19, v19
    v_exp_f32 v20, v20
    v_exp_f32 v21, v21
    v_exp_f32 v22, v22
    v_exp_f32 v23, v23
    v_cvt_pk_bf16_f32 v24, v16, v17
    v_cvt_pk_bf16_f32 v25, v18, v19
    v_cvt_pk_bf16_f32 v26, v20, v21
    v_cvt_pk_bf16_f32 v27, v22, v23
    v_add_f32 v16, v16, v20
    v_add_f32 v17, v17, v21
    v_add_f32 v18, v18, v22
    v_add_f32 v19, v19, v23
    v_add_f32 v16, v16, v18
    v_add_f32 v17, v17, v19
    v_add_f32 v16, v16, v17
    v_add_f32 v7, v7, v16
    s_waitcnt vmcnt(25)
    v_perm_b32 v32, v132, v128, s65
    v_perm_b32 v33, v140, v136, s65
    v_perm_b32 v34, v148, v144, s65
    v_perm_b32 v35, v156, v152, s65
    s_nop 1
    v_mfma_f32_16x16x32_bf16 v[192:195], v[32:35], v[24:27], v[192:195]
    v_perm_b32 v36, v132, v128, s66
    v_perm_b32 v37, v140, v136, s66
    v_perm_b32 v38, v148, v144, s66
    v_perm_b32 v39, v156, v152, s66
    s_nop 1
    v_mfma_f32_16x16x32_bf16 v[196:199], v[36:39], v[24:27], v[196:199]
    v_perm_b32 v40, v133, v129, s65
    v_perm_b32 v41, v141, v137, s65
    v_perm_b32 v42, v149, v145, s65
    v_perm_b32 v43, v157, v153, s65
    s_nop 1
    v_mfma_f32_16x16x32_bf16 v[200:203], v[40:43], v[24:27], v[200:203]
    v_perm_b32 v32, v133, v129, s66
    v_perm_b32 v33, v141, v137, s66
    v_perm_b32 v34, v149, v145, s66
    v_perm_b32 v35, v157, v153, s66
    s_nop 1
    v_mfma_f32_16x16x32_bf16 v[204:207], v[32:35], v[24:27], v[204:207]
    v_perm_b32 v36, v134, v130, s65
    v_perm_b32 v37, v142, v138, s65
    v_perm_b32 v38, v150, v146, s65
    v_perm_b32 v39, v158, v154, s65
    s_nop 1
    v_mfma_f32_16x16x32_bf16 v[208:211], v[36:39], v[24:27], v[208:211]
    v_perm_b32 v40, v134, v130, s66
    v_perm_b32 v41, v142, v138, s66
    v_perm_b32 v42, v150, v146, s66
    v_perm_b32 v43, v158, v154, s66
    s_nop 1
    v_mfma_f32_16x16x32_bf16 v[212:215], v[40:43], v[24:27], v[212:215]
    v_perm_b32 v32, v135, v131, s65
    v_perm_b32 v33, v143, v139, s65
    v_perm_b32 v34, v151, v147, s65
    v_perm_b32 v35, v159, v155, s65
    s_nop 1
    v_mfma_f32_16x16x32_bf16 v[216:219], v[32:35], v[24:27], v[216:219]
    v_perm_b32 v36, v135, v131, s66
    v_perm_b32 v37, v143, v139, s66
    v_perm_b32 v38, v151, v147, s66
    v_perm_b32 v39, v159, v155, s66
    s_nop 1
    v_mfma_f32_16x16x32_bf16 v[220:223], v[36:39], v[24:27], v[220:223]
    s_add_u32 s63, s71, 1310720
    buffer_load_dwordx4 v[128:131], v4, s[44:47], s63 offen offset:0 nt
    s_add_u32 s63, s63, 40960
    buffer_load_dwordx4 v[132:135], v4, s[44:47], s63 offen offset:0 nt
    s_add_u32 s63, s63, 40960
    buffer_load_dwordx4 v[136:139], v4, s[44:47], s63 offen offset:0 nt
    s_add_u32 s63, s63, 40960
    buffer_load_dwordx4 v[140:143], v4, s[44:47], s63 offen offset:0 nt
    s_add_u32 s63, s63, 40960
    buffer_load_dwordx4 v[144:147], v4, s[44:47], s63 offen offset:0 nt
    s_add_u32 s63, s63, 40960
    buffer_load_dwordx4 v[148:151], v4, s[44:47], s63 offen offset:0 nt
    s_add_u32 s63, s63, 40960
    buffer_load_dwordx4 v[152:155], v4, s[44:47], s63 offen offset:0 nt
    s_add_u32 s63, s63, 40960
    buffer_load_dwordx4 v[156:159], v4, s[44:47], s63 offen offset:0 nt
    s_waitcnt vmcnt(25)
    v_dot2_f32_bf16 v16, v96, v44, 0
    v_dot2_f32_bf16 v24, v96, v48, 0
    v_dot2_f32_bf16 v17, v100, v44, 0
    v_dot2_f32_bf16 v25, v100, v48, 0
    v_dot2_f32_bf16 v18, v104, v44, 0
    v_dot2_f32_bf16 v26, v104, v48, 0
    v_dot2_f32_bf16 v19, v108, v44, 0
    v_dot2_f32_bf16 v27, v108, v48, 0
    v_dot2_f32_bf16 v20, v112, v44, 0
    v_dot2_f32_bf16 v28, v112, v48, 0
    v_dot2_f32_bf16 v21, v116, v44, 0
    v_dot2_f32_bf16 v29, v116, v48, 0
    v_dot2_f32_bf16 v22, v120, v44, 0
    v_dot2_f32_bf16 v30, v120, v48, 0
    v_dot2_f32_bf16 v23, v124, v44, 0
    v_dot2_f32_bf16 v31, v124, v48, 0
    v_dot2_f32_bf16 v16, v97, v45, v16
    v_dot2_f32_bf16 v24, v97, v49, v24
    v_dot2_f32_bf16 v17, v101, v45, v17
    v_dot2_f32_bf16 v25, v101, v49, v25
    v_dot2_f32_bf16 v18, v105, v45, v18
    v_dot2_f32_bf16 v26, v105, v49, v26
    v_dot2_f32_bf16 v19, v109, v45, v19
    v_dot2_f32_bf16 v27, v109, v49, v27
    v_dot2_f32_bf16 v20, v113, v45, v20
    v_dot2_f32_bf16 v28, v113, v49, v28
    v_dot2_f32_bf16 v21, v117, v45, v21
    v_dot2_f32_bf16 v29, v117, v49, v29
    v_dot2_f32_bf16 v22, v121, v45, v22
    v_dot2_f32_bf16 v30, v121, v49, v30
    v_dot2_f32_bf16 v23, v125, v45, v23
    v_dot2_f32_bf16 v31, v125, v49, v31
    v_dot2_f32_bf16 v16, v98, v46, v16
    v_dot2_f32_bf16 v24, v98, v50, v24
    v_dot2_f32_bf16 v17, v102, v46, v17
    v_dot2_f32_bf16 v25, v102, v50, v25
    v_dot2_f32_bf16 v18, v106, v46, v18
    v_dot2_f32_bf16 v26, v106, v50, v26
    v_dot2_f32_bf16 v19, v110, v46, v19
    v_dot2_f32_bf16 v27, v110, v50, v27
    v_dot2_f32_bf16 v20, v114, v46, v20
    v_dot2_f32_bf16 v28, v114, v50, v28
    v_dot2_f32_bf16 v21, v118, v46, v21
    v_dot2_f32_bf16 v29, v118, v50, v29
    v_dot2_f32_bf16 v22, v122, v46, v22
    v_dot2_f32_bf16 v30, v122, v50, v30
    v_dot2_f32_bf16 v23, v126, v46, v23
    v_dot2_f32_bf16 v31, v126, v50, v31
    v_dot2_f32_bf16 v16, v99, v47, v16
    v_dot2_f32_bf16 v24, v99, v51, v24
    v_dot2_f32_bf16 v17, v103, v47, v17
    v_dot2_f32_bf16 v25, v103, v51, v25
    v_dot2_f32_bf16 v18, v107, v47, v18
    v_dot2_f32_bf16 v26, v107, v51, v26
    v_dot2_f32_bf16 v19, v111, v47, v19
    v_dot2_f32_bf16 v27, v111, v51, v27
    v_dot2_f32_bf16 v20, v115, v47, v20
    v_dot2_f32_bf16 v28, v115, v51, v28
    v_dot2_f32_bf16 v21, v119, v47, v21
    v_dot2_f32_bf16 v29, v119, v51, v29
    v_dot2_f32_bf16 v22, v123, v47, v22
    v_dot2_f32_bf16 v30, v123, v51, v30
    v_dot2_f32_bf16 v23, v127, v47, v23
    v_dot2_f32_bf16 v31, v127, v51, v31
    s_waitcnt vmcnt(16)
    v_readfirstlane_b32 s60, v52
    s_cmp_lt_u32 s60, 32
    s_cselect_b32 s72, 1, 0
    s_mov_b32 s99, s60
    s_mul_i32 s60, s60, 8192
    s_add_u32 s60, s60, 3932160
    s_lshl_b32 s61, s57, 22
    s_add_u32 s78, s60, s61
    s_cmp_eq_u32 s72, 0
    s_cselect_b32 s78, 0x4000000, s78
    s_mov_b32 s63, s78
    buffer_load_dwordx4 v[96:99], v4, s[40:43], s63 offen offset:0 nt
    s_add_u32 s63, s63, 1024
    buffer_load_dwordx4 v[100:103], v4, s[40:43], s63 offen offset:0 nt
    s_add_u32 s63, s63, 1024
    buffer_load_dwordx4 v[104:107], v4, s[40:43], s63 offen offset:0 nt
    s_add_u32 s63, s63, 1024
    buffer_load_dwordx4 v[108:111], v4, s[40:43], s63 offen offset:0 nt
    s_add_u32 s63, s63, 1024
    buffer_load_dwordx4 v[112:115], v4, s[40:43], s63 offen offset:0 nt
    s_add_u32 s63, s63, 1024
    buffer_load_dwordx4 v[116:119], v4, s[40:43], s63 offen offset:0 nt
    s_add_u32 s63, s63, 1024
    buffer_load_dwordx4 v[120:123], v4, s[40:43], s63 offen offset:0 nt
    s_add_u32 s63, s63, 1024
    buffer_load_dwordx4 v[124:127], v4, s[40:43], s63 offen offset:0 nt
    v_add_f32_dpp v16, v24, v16 quad_perm:[1,0,3,2] row_mask:0xf bank_mask:0xf
    v_add_f32_dpp v17, v25, v17 quad_perm:[1,0,3,2] row_mask:0xf bank_mask:0xf
    v_add_f32_dpp v18, v26, v18 quad_perm:[1,0,3,2] row_mask:0xf bank_mask:0xf
    v_add_f32_dpp v19, v27, v19 quad_perm:[1,0,3,2] row_mask:0xf bank_mask:0xf
    v_add_f32_dpp v20, v28, v20 quad_perm:[1,0,3,2] row_mask:0xf bank_mask:0xf
    v_add_f32_dpp v21, v29, v21 quad_perm:[1,0,3,2] row_mask:0xf bank_mask:0xf
    v_add_f32_dpp v22, v30, v22 quad_perm:[1,0,3,2] row_mask:0xf bank_mask:0xf
    v_add_f32_dpp v23, v31, v23 quad_perm:[1,0,3,2] row_mask:0xf bank_mask:0xf
    v_add_f32_dpp v16, v16, v16 quad_perm:[2,3,0,1] row_mask:0xf bank_mask:0xf
    v_add_f32_dpp v17, v17, v17 quad_perm:[2,3,0,1] row_mask:0xf bank_mask:0xf
    v_add_f32_dpp v18, v18, v18 quad_perm:[2,3,0,1] row_mask:0xf bank_mask:0xf
    v_add_f32_dpp v19, v19, v19 quad_perm:[2,3,0,1] row_mask:0xf bank_mask:0xf
    v_add_f32_dpp v20, v20, v20 quad_perm:[2,3,0,1] row_mask:0xf bank_mask:0xf
    v_add_f32_dpp v21, v21, v21 quad_perm:[2,3,0,1] row_mask:0xf bank_mask:0xf
    v_add_f32_dpp v22, v22, v22 quad_perm:[2,3,0,1] row_mask:0xf bank_mask:0xf
    v_add_f32_dpp v23, v23, v23 quad_perm:[2,3,0,1] row_mask:0xf bank_mask:0xf
    v_add_f32_dpp v16, v16, v16 row_ror:4 row_mask:0xf bank_mask:0xf
    v_add_f32_dpp v17, v17, v17 row_ror:4 row_mask:0xf bank_mask:0xf
    v_add_f32_dpp v18, v18, v18 row_ror:4 row_mask:0xf bank_mask:0xf
    v_add_f32_dpp v19, v19, v19 row_ror:4 row_mask:0xf bank_mask:0xf
    v_add_f32_dpp v20, v20, v20 row_ror:4 row_mask:0xf bank_mask:0xf
    v_add_f32_dpp v21, v21, v21 row_ror:4 row_mask:0xf bank_mask:0xf
    v_add_f32_dpp v22, v22, v22 row_ror:4 row_mask:0xf bank_mask:0xf
    v_add_f32_dpp v23, v23, v23 row_ror:4 row_mask:0xf bank_mask:0xf
    v_add_f32_dpp v16, v16, v16 row_ror:8 row_mask:0xf bank_mask:0xf
    v_add_f32_dpp v17, v17, v17 row_ror:8 row_mask:0xf bank_mask:0xf
    v_add_f32_dpp v18, v18, v18 row_ror:8 row_mask:0xf bank_mask:0xf
    v_add_f32_dpp v19, v19, v19 row_ror:8 row_mask:0xf bank_mask:0xf
    v_add_f32_dpp v20, v20, v20 row_ror:8 row_mask:0xf bank_mask:0xf
    v_add_f32_dpp v21, v21, v21 row_ror:8 row_mask:0xf bank_mask:0xf
    v_add_f32_dpp v22, v22, v22 row_ror:8 row_mask:0xf bank_mask:0xf
    v_add_f32_dpp v23, v23, v23 row_ror:8 row_mask:0xf bank_mask:0xf
    v_max3_f32 v8, v16, v17, v18
    v_max3_f32 v9, v19, v20, v21
    v_max3_f32 v8, v8, v22, v23
    v_max_f32 v8, v8, v9
    v_mov_b32 v9, v8
    s_nop 1
    v_permlane16_swap_b32 v8, v9
    v_max_f32 v8, v8, v9
    v_mov_b32 v9, v8
    s_nop 1
    v_permlane32_swap_b32 v8, v9
    v_max_f32 v8, v8, v9
    v_cmp_gt_f32 vcc, v8, v6
    s_cmp_eq_u64 vcc, 0
    s_cbranch_scc1 L_nors_22
    v_max_f32 v8, v8, v6
    v_sub_f32 v10, v6, v8
    v_mul_f32 v10, s64, v10
    v_exp_f32 v10, v10
    v_mov_b32 v6, v8
    v_mul_f32 v7, v7, v10
    v_mul_f32 v192, v192, v10
    v_mul_f32 v193, v193, v10
    v_mul_f32 v194, v194, v10
    v_mul_f32 v195, v195, v10
    v_mul_f32 v196, v196, v10
    v_mul_f32 v197, v197, v10
    v_mul_f32 v198, v198, v10
    v_mul_f32 v199, v199, v10
    v_mul_f32 v200, v200, v10
    v_mul_f32 v201, v201, v10
    v_mul_f32 v202, v202, v10
    v_mul_f32 v203, v203, v10
    v_mul_f32 v204, v204, v10
    v_mul_f32 v205, v205, v10
    v_mul_f32 v206, v206, v10
    v_mul_f32 v207, v207, v10
    v_mul_f32 v208, v208, v10
    v_mul_f32 v209, v209, v10
    v_mul_f32 v210, v210, v10
    v_mul_f32 v211, v211, v10
    v_mul_f32 v212, v212, v10
    v_mul_f32 v213, v213, v10
    v_mul_f32 v214, v214, v10
    v_mul_f32 v215, v215, v10
    v_mul_f32 v216, v216, v10
    v_mul_f32 v217, v217, v10
    v_mul_f32 v218, v218, v10
    v_mul_f32 v219, v219, v10
    v_mul_f32 v220, v220, v10
    v_mul_f32 v221, v221, v10
    v_mul_f32 v222, v222, v10
    v_mul_f32 v223, v223, v10
L_nors_22:
    v_mul_f32 v8, s64, v6
    v_fma_f32 v16, v16, s64, -v8
    v_fma_f32 v17, v17, s64, -v8
    v_fma_f32 v18, v18, s64, -v8
    v_fma_f32 v19, v19, s64, -v8
    v_fma_f32 v20, v20, s64, -v8
    v_fma_f32 v21, v21, s64, -v8
    v_fma_f32 v22, v22, s64, -v8
    v_fma_f32 v23, v23, s64, -v8
    v_exp_f32 v16, v16
    v_exp_f32 v17, v17
    v_exp_f32 v18, v18
    v_exp_f32 v19, v19
    v_exp_f32 v20, v20
    v_exp_f32 v21, v21
    v_exp_f32 v22, v22
    v_exp_f32 v23, v23
    v_cvt_pk_bf16_f32 v24, v16, v17
    v_cvt_pk_bf16_f32 v25, v18, v19
    v_cvt_pk_bf16_f32 v26, v20, v21
    v_cvt_pk_bf16_f32 v27, v22, v23
    v_add_f32 v16, v16, v20
    v_add_f32 v17, v17, v21
    v_add_f32 v18, v18, v22
    v_add_f32 v19, v19, v23
    v_add_f32 v16, v16, v18
    v_add_f32 v17, v17, v19
    v_add_f32 v16, v16, v17
    v_add_f32 v7, v7, v16
    s_waitcnt vmcnt(25)
    v_perm_b32 v32, v164, v160, s65
    v_perm_b32 v33, v172, v168, s65
    v_perm_b32 v34, v180, v176, s65
    v_perm_b32 v35, v188, v184, s65
    s_nop 1
    v_mfma_f32_16x16x32_bf16 v[192:195], v[32:35], v[24:27], v[192:195]
    v_perm_b32 v36, v164, v160, s66
    v_perm_b32 v37, v172, v168, s66
    v_perm_b32 v38, v180, v176, s66
    v_perm_b32 v39, v188, v184, s66
    s_nop 1
    v_mfma_f32_16x16x32_bf16 v[196:199], v[36:39], v[24:27], v[196:199]
    v_perm_b32 v40, v165, v161, s65
    v_perm_b32 v41, v173, v169, s65
    v_perm_b32 v42, v181, v177, s65
    v_perm_b32 v43, v189, v185, s65
    s_nop 1
    v_mfma_f32_16x16x32_bf16 v[200:203], v[40:43], v[24:27], v[200:203]
    v_perm_b32 v32, v165, v161, s66
    v_perm_b32 v33, v173, v169, s66
    v_perm_b32 v34, v181, v177, s66
    v_perm_b32 v35, v189, v185, s66
    s_nop 1
    v_mfma_f32_16x16x32_bf16 v[204:207], v[32:35], v[24:27], v[204:207]
    v_perm_b32 v36, v166, v162, s65
    v_perm_b32 v37, v174, v170, s65
    v_perm_b32 v38, v182, v178, s65
    v_perm_b32 v39, v190, v186, s65
    s_nop 1
    v_mfma_f32_16x16x32_bf16 v[208:211], v[36:39], v[24:27], v[208:211]
    v_perm_b32 v40, v166, v162, s66
    v_perm_b32 v41, v174, v170, s66
    v_perm_b32 v42, v182, v178, s66
    v_perm_b32 v43, v190, v186, s66
    s_nop 1
    v_mfma_f32_16x16x32_bf16 v[212:215], v[40:43], v[24:27], v[212:215]
    v_perm_b32 v32, v167, v163, s65
    v_perm_b32 v33, v175, v171, s65
    v_perm_b32 v34, v183, v179, s65
    v_perm_b32 v35, v191, v187, s65
    s_nop 1
    v_mfma_f32_16x16x32_bf16 v[216:219], v[32:35], v[24:27], v[216:219]
    v_perm_b32 v36, v167, v163, s66
    v_perm_b32 v37, v175, v171, s66
    v_perm_b32 v38, v183, v179, s66
    v_perm_b32 v39, v191, v187, s66
    s_nop 1
    v_mfma_f32_16x16x32_bf16 v[220:223], v[36:39], v[24:27], v[220:223]
    s_mov_b32 s63, s78
    buffer_load_dwordx4 v[160:163], v4, s[44:47], s63 offen offset:0 nt
    s_add_u32 s63, s63, 1024
    buffer_load_dwordx4 v[164:167], v4, s[44:47], s63 offen offset:0 nt
    s_add_u32 s63, s63, 1024
    buffer_load_dwordx4 v[168:171], v4, s[44:47], s63 offen offset:0 nt
    s_add_u32 s63, s63, 1024
    buffer_load_dwordx4 v[172:175], v4, s[44:47], s63 offen offset:0 nt
    s_add_u32 s63, s63, 1024
    buffer_load_dwordx4 v[176:179], v4, s[44:47], s63 offen offset:0 nt
    s_add_u32 s63, s63, 1024
    buffer_load_dwordx4 v[180:183], v4, s[44:47], s63 offen offset:0 nt
    s_add_u32 s63, s63, 1024
    buffer_load_dwordx4 v[184:187], v4, s[44:47], s63 offen offset:0 nt
    s_add_u32 s63, s63, 1024
    buffer_load_dwordx4 v[188:191], v4, s[44:47], s63 offen offset:0 nt
    s_waitcnt vmcnt(24)
    v_dot2_f32_bf16 v16, v64, v44, 0
    v_dot2_f32_bf16 v24, v64, v48, 0
    v_dot2_f32_bf16 v17, v68, v44, 0
    v_dot2_f32_bf16 v25, v68, v48, 0
    v_dot2_f32_bf16 v18, v72, v44, 0
    v_dot2_f32_bf16 v26, v72, v48, 0
    v_dot2_f32_bf16 v19, v76, v44, 0
    v_dot2_f32_bf16 v27, v76, v48, 0
    v_dot2_f32_bf16 v20, v80, v44, 0
    v_dot2_f32_bf16 v28, v80, v48, 0
    v_dot2_f32_bf16 v21, v84, v44, 0
    v_dot2_f32_bf16 v29, v84, v48, 0
    v_dot2_f32_bf16 v22, v88, v44, 0
    v_dot2_f32_bf16 v30, v88, v48, 0
    v_dot2_f32_bf16 v23, v92, v44, 0
    v_dot2_f32_bf16 v31, v92, v48, 0
    v_dot2_f32_bf16 v16, v65, v45, v16
    v_dot2_f32_bf16 v24, v65, v49, v24
    v_dot2_f32_bf16 v17, v69, v45, v17
    v_dot2_f32_bf16 v25, v69, v49, v25
    v_dot2_f32_bf16 v18, v73, v45, v18
    v_dot2_f32_bf16 v26, v73, v49, v26
    v_dot2_f32_bf16 v19, v77, v45, v19
    v_dot2_f32_bf16 v27, v77, v49, v27
    v_dot2_f32_bf16 v20, v81, v45, v20
    v_dot2_f32_bf16 v28, v81, v49, v28
    v_dot2_f32_bf16 v21, v85, v45, v21
    v_dot2_f32_bf16 v29, v85, v49, v29
    v_dot2_f32_bf16 v22, v89, v45, v22
    v_dot2_f32_bf16 v30, v89, v49, v30
    v_dot2_f32_bf16 v23, v93, v45, v23
    v_dot2_f32_bf16 v31, v93, v49, v31
    v_dot2_f32_bf16 v16, v66, v46, v16
    v_dot2_f32_bf16 v24, v66, v50, v24
    v_dot2_f32_bf16 v17, v70, v46, v17
    v_dot2_f32_bf16 v25, v70, v50, v25
    v_dot2_f32_bf16 v18, v74, v46, v18
    v_dot2_f32_bf16 v26, v74, v50, v26
    v_dot2_f32_bf16 v19, v78, v46, v19
    v_dot2_f32_bf16 v27, v78, v50, v27
    v_dot2_f32_bf16 v20, v82, v46, v20
    v_dot2_f32_bf16 v28, v82, v50, v28
    v_dot2_f32_bf16 v21, v86, v46, v21
    v_dot2_f32_bf16 v29, v86, v50, v29
    v_dot2_f32_bf16 v22, v90, v46, v22
    v_dot2_f32_bf16 v30, v90, v50, v30
    v_dot2_f32_bf16 v23, v94, v46, v23
    v_dot2_f32_bf16 v31, v94, v50, v31
    v_dot2_f32_bf16 v16, v67, v47, v16
    v_dot2_f32_bf16 v24, v67, v51, v24
    v_dot2_f32_bf16 v17, v71, v47, v17
    v_dot2_f32_bf16 v25, v71, v51, v25
    v_dot2_f32_bf16 v18, v75, v47, v18
    v_dot2_f32_bf16 v26, v75, v51, v26
    v_dot2_f32_bf16 v19, v79, v47, v19
    v_dot2_f32_bf16 v27, v79, v51, v27
    v_dot2_f32_bf16 v20, v83, v47, v20
    v_dot2_f32_bf16 v28, v83, v51, v28
    v_dot2_f32_bf16 v21, v87, v47, v21
    v_dot2_f32_bf16 v29, v87, v51, v29
    v_dot2_f32_bf16 v22, v91, v47, v22
    v_dot2_f32_bf16 v30, v91, v51, v30
    v_dot2_f32_bf16 v23, v95, v47, v23
    v_dot2_f32_bf16 v31, v95, v51, v31
    v_add_f32_dpp v16, v24, v16 quad_perm:[1,0,3,2] row_mask:0xf bank_mask:0xf
    v_add_f32_dpp v17, v25, v17 quad_perm:[1,0,3,2] row_mask:0xf bank_mask:0xf
    v_add_f32_dpp v18, v26, v18 quad_perm:[1,0,3,2] row_mask:0xf bank_mask:0xf
    v_add_f32_dpp v19, v27, v19 quad_perm:[1,0,3,2] row_mask:0xf bank_mask:0xf
    v_add_f32_dpp v20, v28, v20 quad_perm:[1,0,3,2] row_mask:0xf bank_mask:0xf
    v_add_f32_dpp v21, v29, v21 quad_perm:[1,0,3,2] row_mask:0xf bank_mask:0xf
    v_add_f32_dpp v22, v30, v22 quad_perm:[1,0,3,2] row_mask:0xf bank_mask:0xf
    v_add_f32_dpp v23, v31, v23 quad_perm:[1,0,3,2] row_mask:0xf bank_mask:0xf
    v_add_f32_dpp v16, v16, v16 quad_perm:[2,3,0,1] row_mask:0xf bank_mask:0xf
    v_add_f32_dpp v17, v17, v17 quad_perm:[2,3,0,1] row_mask:0xf bank_mask:0xf
    v_add_f32_dpp v18, v18, v18 quad_perm:[2,3,0,1] row_mask:0xf bank_mask:0xf
    v_add_f32_dpp v19, v19, v19 quad_perm:[2,3,0,1] row_mask:0xf bank_mask:0xf
    v_add_f32_dpp v20, v20, v20 quad_perm:[2,3,0,1] row_mask:0xf bank_mask:0xf
    v_add_f32_dpp v21, v21, v21 quad_perm:[2,3,0,1] row_mask:0xf bank_mask:0xf
    v_add_f32_dpp v22, v22, v22 quad_perm:[2,3,0,1] row_mask:0xf bank_mask:0xf
    v_add_f32_dpp v23, v23, v23 quad_perm:[2,3,0,1] row_mask:0xf bank_mask:0xf
    v_add_f32_dpp v16, v16, v16 row_ror:4 row_mask:0xf bank_mask:0xf
    v_add_f32_dpp v17, v17, v17 row_ror:4 row_mask:0xf bank_mask:0xf
    v_add_f32_dpp v18, v18, v18 row_ror:4 row_mask:0xf bank_mask:0xf
    v_add_f32_dpp v19, v19, v19 row_ror:4 row_mask:0xf bank_mask:0xf
    v_add_f32_dpp v20, v20, v20 row_ror:4 row_mask:0xf bank_mask:0xf
    v_add_f32_dpp v21, v21, v21 row_ror:4 row_mask:0xf bank_mask:0xf
    v_add_f32_dpp v22, v22, v22 row_ror:4 row_mask:0xf bank_mask:0xf
    v_add_f32_dpp v23, v23, v23 row_ror:4 row_mask:0xf bank_mask:0xf
    v_add_f32_dpp v16, v16, v16 row_ror:8 row_mask:0xf bank_mask:0xf
    v_add_f32_dpp v17, v17, v17 row_ror:8 row_mask:0xf bank_mask:0xf
    v_add_f32_dpp v18, v18, v18 row_ror:8 row_mask:0xf bank_mask:0xf
    v_add_f32_dpp v19, v19, v19 row_ror:8 row_mask:0xf bank_mask:0xf
    v_add_f32_dpp v20, v20, v20 row_ror:8 row_mask:0xf bank_mask:0xf
    v_add_f32_dpp v21, v21, v21 row_ror:8 row_mask:0xf bank_mask:0xf
    v_add_f32_dpp v22, v22, v22 row_ror:8 row_mask:0xf bank_mask:0xf
    v_add_f32_dpp v23, v23, v23 row_ror:8 row_mask:0xf bank_mask:0xf
    v_max3_f32 v8, v16, v17, v18
    v_max3_f32 v9, v19, v20, v21
    v_max3_f32 v8, v8, v22, v23
    v_max_f32 v8, v8, v9
    v_mov_b32 v9, v8
    s_nop 1
    v_permlane16_swap_b32 v8, v9
    v_max_f32 v8, v8, v9
    v_mov_b32 v9, v8
    s_nop 1
    v_permlane32_swap_b32 v8, v9
    v_max_f32 v8, v8, v9
    v_cmp_gt_f32 vcc, v8, v6
    s_cmp_eq_u64 vcc, 0
    s_cbranch_scc1 L_nors_23
    v_max_f32 v8, v8, v6
    v_sub_f32 v10, v6, v8
    v_mul_f32 v10, s64, v10
    v_exp_f32 v10, v10
    v_mov_b32 v6, v8
    v_mul_f32 v7, v7, v10
    v_mul_f32 v192, v192, v10
    v_mul_f32 v193, v193, v10
    v_mul_f32 v194, v194, v10
    v_mul_f32 v195, v195, v10
    v_mul_f32 v196, v196, v10
    v_mul_f32 v197, v197, v10
    v_mul_f32 v198, v198, v10
    v_mul_f32 v199, v199, v10
    v_mul_f32 v200, v200, v10
    v_mul_f32 v201, v201, v10
    v_mul_f32 v202, v202, v10
    v_mul_f32 v203, v203, v10
    v_mul_f32 v204, v204, v10
    v_mul_f32 v205, v205, v10
    v_mul_f32 v206, v206, v10
    v_mul_f32 v207, v207, v10
    v_mul_f32 v208, v208, v10
    v_mul_f32 v209, v209, v10
    v_mul_f32 v210, v210, v10
    v_mul_f32 v211, v211, v10
    v_mul_f32 v212, v212, v10
    v_mul_f32 v213, v213, v10
    v_mul_f32 v214, v214, v10
    v_mul_f32 v215, v215, v10
    v_mul_f32 v216, v216, v10
    v_mul_f32 v217, v217, v10
    v_mul_f32 v218, v218, v10
    v_mul_f32 v219, v219, v10
    v_mul_f32 v220, v220, v10
    v_mul_f32 v221, v221, v10
    v_mul_f32 v222, v222, v10
    v_mul_f32 v223, v223, v10
L_nors_23:
    v_mul_f32 v8, s64, v6
    v_fma_f32 v16, v16, s64, -v8
    v_fma_f32 v17, v17, s64, -v8
    v_fma_f32 v18, v18, s64, -v8
    v_fma_f32 v19, v19, s64, -v8
    v_fma_f32 v20, v20, s64, -v8
    v_fma_f32 v21, v21, s64, -v8
    v_fma_f32 v22, v22, s64, -v8
    v_fma_f32 v23, v23, s64, -v8
    v_exp_f32 v16, v16
    v_exp_f32 v17, v17
    v_exp_f32 v18, v18
    v_exp_f32 v19, v19
    v_exp_f32 v20, v20
    v_exp_f32 v21, v21
    v_exp_f32 v22, v22
    v_exp_f32 v23, v23
    v_cvt_pk_bf16_f32 v24, v16, v17
    v_cvt_pk_bf16_f32 v25, v18, v19
    v_cvt_pk_bf16_f32 v26, v20, v21
    v_cvt_pk_bf16_f32 v27, v22, v23
    v_add_f32 v16, v16, v20
    v_add_f32 v17, v17, v21
    v_add_f32 v18, v18, v22
    v_add_f32 v19, v19, v23
    v_add_f32 v16, v16, v18
    v_add_f32 v17, v17, v19
    v_add_f32 v16, v16, v17
    v_add_f32 v7, v7, v16
    s_waitcnt vmcnt(16)
    v_perm_b32 v32, v132, v128, s65
    v_perm_b32 v33, v140, v136, s65
    v_perm_b32 v34, v148, v144, s65
    v_perm_b32 v35, v156, v152, s65
    s_nop 1
    v_mfma_f32_16x16x32_bf16 v[192:195], v[32:35], v[24:27], v[192:195]
    v_perm_b32 v36, v132, v128, s66
    v_perm_b32 v37, v140, v136, s66
    v_perm_b32 v38, v148, v144, s66
    v_perm_b32 v39, v156, v152, s66
    s_nop 1
    v_mfma_f32_16x16x32_bf16 v[196:199], v[36:39], v[24:27], v[196:199]
    v_perm_b32 v40, v133, v129, s65
    v_perm_b32 v41, v141, v137, s65
    v_perm_b32 v42, v149, v145, s65
    v_perm_b32 v43, v157, v153, s65
    s_nop 1
    v_mfma_f32_16x16x32_bf16 v[200:203], v[40:43], v[24:27], v[200:203]
    v_perm_b32 v32, v133, v129, s66
    v_perm_b32 v33, v141, v137, s66
    v_perm_b32 v34, v149, v145, s66
    v_perm_b32 v35, v157, v153, s66
    s_nop 1
    v_mfma_f32_16x16x32_bf16 v[204:207], v[32:35], v[24:27], v[204:207]
    v_perm_b32 v36, v134, v130, s65
    v_perm_b32 v37, v142, v138, s65
    v_perm_b32 v38, v150, v146, s65
    v_perm_b32 v39, v158, v154, s65
    s_nop 1
    v_mfma_f32_16x16x32_bf16 v[208:211], v[36:39], v[24:27], v[208:211]
    v_perm_b32 v40, v134, v130, s66
    v_perm_b32 v41, v142, v138, s66
    v_perm_b32 v42, v150, v146, s66
    v_perm_b32 v43, v158, v154, s66
    s_nop 1
    v_mfma_f32_16x16x32_bf16 v[212:215], v[40:43], v[24:27], v[212:215]
    v_perm_b32 v32, v135, v131, s65
    v_perm_b32 v33, v143, v139, s65
    v_perm_b32 v34, v151, v147, s65
    v_perm_b32 v35, v159, v155, s65
    s_nop 1
    v_mfma_f32_16x16x32_bf16 v[216:219], v[32:35], v[24:27], v[216:219]
    v_perm_b32 v36, v135, v131, s66
    v_perm_b32 v37, v143, v139, s66
    v_perm_b32 v38, v151, v147, s66
    v_perm_b32 v39, v159, v155, s66
    s_nop 1
    v_mfma_f32_16x16x32_bf16 v[220:223], v[36:39], v[24:27], v[220:223]
    s_cmp_eq_u32 s72, 0
    s_cbranch_scc1 L_nolast_12
    s_waitcnt vmcnt(8)
    v_dot2_f32_bf16 v16, v96, v44, 0
    v_dot2_f32_bf16 v24, v96, v48, 0
    v_dot2_f32_bf16 v17, v100, v44, 0
    v_dot2_f32_bf16 v25, v100, v48, 0
    v_dot2_f32_bf16 v18, v104, v44, 0
    v_dot2_f32_bf16 v26, v104, v48, 0
    v_dot2_f32_bf16 v19, v108, v44, 0
    v_dot2_f32_bf16 v27, v108, v48, 0
    v_dot2_f32_bf16 v20, v112, v44, 0
    v_dot2_f32_bf16 v28, v112, v48, 0
    v_dot2_f32_bf16 v21, v116, v44, 0
    v_dot2_f32_bf16 v29, v116, v48, 0
    v_dot2_f32_bf16 v22, v120, v44, 0
    v_dot2_f32_bf16 v30, v120, v48, 0
    v_dot2_f32_bf16 v23, v124, v44, 0
    v_dot2_f32_bf16 v31, v124, v48, 0
    v_dot2_f32_bf16 v16, v97, v45, v16
    v_dot2_f32_bf16 v24, v97, v49, v24
    v_dot2_f32_bf16 v17, v101, v45, v17
    v_dot2_f32_bf16 v25, v101, v49, v25
    v_dot2_f32_bf16 v18, v105, v45, v18
    v_dot2_f32_bf16 v26, v105, v49, v26
    v_dot2_f32_bf16 v19, v109, v45, v19
    v_dot2_f32_bf16 v27, v109, v49, v27
    v_dot2_f32_bf16 v20, v113, v45, v20
    v_dot2_f32_bf16 v28, v113, v49, v28
    v_dot2_f32_bf16 v21, v117, v45, v21
    v_dot2_f32_bf16 v29, v117, v49, v29
    v_dot2_f32_bf16 v22, v121, v45, v22
    v_dot2_f32_bf16 v30, v121, v49, v30
    v_dot2_f32_bf16 v23, v125, v45, v23
    v_dot2_f32_bf16 v31, v125, v49, v31
    v_dot2_f32_bf16 v16, v98, v46, v16
    v_dot2_f32_bf16 v24, v98, v50, v24
    v_dot2_f32_bf16 v17, v102, v46, v17
    v_dot2_f32_bf16 v25, v102, v50, v25
    v_dot2_f32_bf16 v18, v106, v46, v18
    v_dot2_f32_bf16 v26, v106, v50, v26
    v_dot2_f32_bf16 v19, v110, v46, v19
    v_dot2_f32_bf16 v27, v110, v50, v27
    v_dot2_f32_bf16 v20, v114, v46, v20
    v_dot2_f32_bf16 v28, v114, v50, v28
    v_dot2_f32_bf16 v21, v118, v46, v21
    v_dot2_f32_bf16 v29, v118, v50, v29
    v_dot2_f32_bf16 v22, v122, v46, v22
    v_dot2_f32_bf16 v30, v122, v50, v30
    v_dot2_f32_bf16 v23, v126, v46, v23
    v_dot2_f32_bf16 v31, v126, v50, v31
    v_dot2_f32_bf16 v16, v99, v47, v16
    v_dot2_f32_bf16 v24, v99, v51, v24
    v_dot2_f32_bf16 v17, v103, v47, v17
    v_dot2_f32_bf16 v25, v103, v51, v25
    v_dot2_f32_bf16 v18, v107, v47, v18
    v_dot2_f32_bf16 v26, v107, v51, v26
    v_dot2_f32_bf16 v19, v111, v47, v19
    v_dot2_f32_bf16 v27, v111, v51, v27
    v_dot2_f32_bf16 v20, v115, v47, v20
    v_dot2_f32_bf16 v28, v115, v51, v28
    v_dot2_f32_bf16 v21, v119, v47, v21
    v_dot2_f32_bf16 v29, v119, v51, v29
    v_dot2_f32_bf16 v22, v123, v47, v22
    v_dot2_f32_bf16 v30, v123, v51, v30
    v_dot2_f32_bf16 v23, v127, v47, v23
    v_dot2_f32_bf16 v31, v127, v51, v31
    v_add_f32_dpp v16, v24, v16 quad_perm:[1,0,3,2] row_mask:0xf bank_mask:0xf
    v_add_f32_dpp v17, v25, v17 quad_perm:[1,0,3,2] row_mask:0xf bank_mask:0xf
    v_add_f32_dpp v18, v26, v18 quad_perm:[1,0,3,2] row_mask:0xf bank_mask:0xf
    v_add_f32_dpp v19, v27, v19 quad_perm:[1,0,3,2] row_mask:0xf bank_mask:0xf
    v_add_f32_dpp v20, v28, v20 quad_perm:[1,0,3,2] row_mask:0xf bank_mask:0xf
    v_add_f32_dpp v21, v29, v21 quad_perm:[1,0,3,2] row_mask:0xf bank_mask:0xf
    v_add_f32_dpp v22, v30, v22 quad_perm:[1,0,3,2] row_mask:0xf bank_mask:0xf
    v_add_f32_dpp v23, v31, v23 quad_perm:[1,0,3,2] row_mask:0xf bank_mask:0xf
    v_add_f32_dpp v16, v16, v16 quad_perm:[2,3,0,1] row_mask:0xf bank_mask:0xf
    v_add_f32_dpp v17, v17, v17 quad_perm:[2,3,0,1] row_mask:0xf bank_mask:0xf
    v_add_f32_dpp v18, v18, v18 quad_perm:[2,3,0,1] row_mask:0xf bank_mask:0xf
    v_add_f32_dpp v19, v19, v19 quad_perm:[2,3,0,1] row_mask:0xf bank_mask:0xf
    v_add_f32_dpp v20, v20, v20 quad_perm:[2,3,0,1] row_mask:0xf bank_mask:0xf
    v_add_f32_dpp v21, v21, v21 quad_perm:[2,3,0,1] row_mask:0xf bank_mask:0xf
    v_add_f32_dpp v22, v22, v22 quad_perm:[2,3,0,1] row_mask:0xf bank_mask:0xf
    v_add_f32_dpp v23, v23, v23 quad_perm:[2,3,0,1] row_mask:0xf bank_mask:0xf
    v_add_f32_dpp v16, v16, v16 row_ror:4 row_mask:0xf bank_mask:0xf
    v_add_f32_dpp v17, v17, v17 row_ror:4 row_mask:0xf bank_mask:0xf
    v_add_f32_dpp v18, v18, v18 row_ror:4 row_mask:0xf bank_mask:0xf
    v_add_f32_dpp v19, v19, v19 row_ror:4 row_mask:0xf bank_mask:0xf
    v_add_f32_dpp v20, v20, v20 row_ror:4 row_mask:0xf bank_mask:0xf
    v_add_f32_dpp v21, v21, v21 row_ror:4 row_mask:0xf bank_mask:0xf
    v_add_f32_dpp v22, v22, v22 row_ror:4 row_mask:0xf bank_mask:0xf
    v_add_f32_dpp v23, v23, v23 row_ror:4 row_mask:0xf bank_mask:0xf
    v_add_f32_dpp v16, v16, v16 row_ror:8 row_mask:0xf bank_mask:0xf
    v_add_f32_dpp v17, v17, v17 row_ror:8 row_mask:0xf bank_mask:0xf
    v_add_f32_dpp v18, v18, v18 row_ror:8 row_mask:0xf bank_mask:0xf
    v_add_f32_dpp v19, v19, v19 row_ror:8 row_mask:0xf bank_mask:0xf
    v_add_f32_dpp v20, v20, v20 row_ror:8 row_mask:0xf bank_mask:0xf
    v_add_f32_dpp v21, v21, v21 row_ror:8 row_mask:0xf bank_mask:0xf
    v_add_f32_dpp v22, v22, v22 row_ror:8 row_mask:0xf bank_mask:0xf
    v_add_f32_dpp v23, v23, v23 row_ror:8 row_mask:0xf bank_mask:0xf
    v_max3_f32 v8, v16, v17, v18
    v_max3_f32 v9, v19, v20, v21
    v_max3_f32 v8, v8, v22, v23
    v_max_f32 v8, v8, v9
    v_mov_b32 v9, v8
    s_nop 1
    v_permlane16_swap_b32 v8, v9
    v_max_f32 v8, v8, v9
    v_mov_b32 v9, v8
    s_nop 1
    v_permlane32_swap_b32 v8, v9
    v_max_f32 v8, v8, v9
    v_cmp_gt_f32 vcc, v8, v6
    s_cmp_eq_u64 vcc, 0
    s_cbranch_scc1 L_nors_24
    v_max_f32 v8, v8, v6
    v_sub_f32 v10, v6, v8
    v_mul_f32 v10, s64, v10
    v_exp_f32 v10, v10
    v_mov_b32 v6, v8
    v_mul_f32 v7, v7, v10
    v_mul_f32 v192, v192, v10
    v_mul_f32 v193, v193, v10
    v_mul_f32 v194, v194, v10
    v_mul_f32 v195, v195, v10
    v_mul_f32 v196, v196, v10
    v_mul_f32 v197, v197, v10
    v_mul_f32 v198, v198, v10
    v_mul_f32 v199, v199, v10
    v_mul_f32 v200, v200, v10
    v_mul_f32 v201, v201, v10
    v_mul_f32 v202, v202, v10
    v_mul_f32 v203, v203, v10
    v_mul_f32 v204, v204, v10
    v_mul_f32 v205, v205, v10
    v_mul_f32 v206, v206, v10
    v_mul_f32 v207, v207, v10
    v_mul_f32 v208, v208, v10
    v_mul_f32 v209, v209, v10
    v_mul_f32 v210, v210, v10
    v_mul_f32 v211, v211, v10
    v_mul_f32 v212, v212, v10
    v_mul_f32 v213, v213, v10
    v_mul_f32 v214, v214, v10
    v_mul_f32 v215, v215, v10
    v_mul_f32 v216, v216, v10
    v_mul_f32 v217, v217, v10
    v_mul_f32 v218, v218, v10
    v_mul_f32 v219, v219, v10
    v_mul_f32 v220, v220, v10
    v_mul_f32 v221, v221, v10
    v_mul_f32 v222, v222, v10
    v_mul_f32 v223, v223, v10
L_nors_24:
    v_mul_f32 v8, s64, v6
    v_fma_f32 v16, v16, s64, -v8
    v_fma_f32 v17, v17, s64, -v8
    v_fma_f32 v18, v18, s64, -v8
    v_fma_f32 v19, v19, s64, -v8
    v_fma_f32 v20, v20, s64, -v8
    v_fma_f32 v21, v21, s64, -v8
    v_fma_f32 v22, v22, s64, -v8
    v_fma_f32 v23, v23, s64, -v8
    v_exp_f32 v16, v16
    v_exp_f32 v17, v17
    v_exp_f32 v18, v18
    v_exp_f32 v19, v19
    v_exp_f32 v20, v20
    v_exp_f32 v21, v21
    v_exp_f32 v22, v22
    v_exp_f32 v23, v23
    v_cvt_pk_bf16_f32 v24, v16, v17
    v_cvt_pk_bf16_f32 v25, v18, v19
    v_cvt_pk_bf16_f32 v26, v20, v21
    v_cvt_pk_bf16_f32 v27, v22, v23
    v_add_f32 v16, v16, v20
    v_add_f32 v17, v17, v21
    v_add_f32 v18, v18, v22
    v_add_f32 v19, v19, v23
    v_add_f32 v16, v16, v18
    v_add_f32 v17, v17, v19
    v_add_f32 v16, v16, v17
    v_add_f32 v7, v7, v16
    s_waitcnt vmcnt(0)
    v_perm_b32 v32, v164, v160, s65
    v_perm_b32 v33, v172, v168, s65
    v_perm_b32 v34, v180, v176, s65
    v_perm_b32 v35, v188, v184, s65
    s_nop 1
    v_mfma_f32_16x16x32_bf16 v[192:195], v[32:35], v[24:27], v[192:195]
    v_perm_b32 v36, v164, v160, s66
    v_perm_b32 v37, v172, v168, s66
    v_perm_b32 v38, v180, v176, s66
    v_perm_b32 v39, v188, v184, s66
    s_nop 1
    v_mfma_f32_16x16x32_bf16 v[196:199], v[36:39], v[24:27], v[196:199]
    v_perm_b32 v40, v165, v161, s65
    v_perm_b32 v41, v173, v169, s65
    v_perm_b32 v42, v181, v177, s65
    v_perm_b32 v43, v189, v185, s65
    s_nop 1
    v_mfma_f32_16x16x32_bf16 v[200:203], v[40:43], v[24:27], v[200:203]
    v_perm_b32 v32, v165, v161, s66
    v_perm_b32 v33, v173, v169, s66
    v_perm_b32 v34, v181, v177, s66
    v_perm_b32 v35, v189, v185, s66
    s_nop 1
    v_mfma_f32_16x16x32_bf16 v[204:207], v[32:35], v[24:27], v[204:207]
    v_perm_b32 v36, v166, v162, s65
    v_perm_b32 v37, v174, v170, s65
    v_perm_b32 v38, v182, v178, s65
    v_perm_b32 v39, v190, v186, s65
    s_nop 1
    v_mfma_f32_16x16x32_bf16 v[208:211], v[36:39], v[24:27], v[208:211]
    v_perm_b32 v40, v166, v162, s66
    v_perm_b32 v41, v174, v170, s66
    v_perm_b32 v42, v182, v178, s66
    v_perm_b32 v43, v190, v186, s66
    s_nop 1
    v_mfma_f32_16x16x32_bf16 v[212:215], v[40:43], v[24:27], v[212:215]
    v_perm_b32 v32, v167, v163, s65
    v_perm_b32 v33, v175, v171, s65
    v_perm_b32 v34, v183, v179, s65
    v_perm_b32 v35, v191, v187, s65
    s_nop 1
    v_mfma_f32_16x16x32_bf16 v[216:219], v[32:35], v[24:27], v[216:219]
    v_perm_b32 v36, v167, v163, s66
    v_perm_b32 v37, v175, v171, s66
    v_perm_b32 v38, v183, v179, s66
    v_perm_b32 v39, v191, v187, s66
    s_nop 1
    v_mfma_f32_16x16x32_bf16 v[220:223], v[36:39], v[24:27], v[220:223]
L_nolast_12:
    v_mov_b32 v8, v7
    s_nop 1
    v_permlane16_swap_b32 v7, v8
    v_add_f32 v7, v7, v8
    v_mov_b32 v8, v7
    s_nop 1
    v_permlane32_swap_b32 v7, v8
    v_add_f32 v7, v7, v8
    s_mov_b32 exec_lo, 0x30003
    s_mov_b32 exec_hi, 0x30003
    ds_write_b128 v240, v[192:195] offset:0
    ds_write_b128 v240, v[196:199] offset:16
    ds_write_b128 v240, v[200:203] offset:32
    ds_write_b128 v240, v[204:207] offset:48
    ds_write_b128 v240, v[208:211] offset:64
    ds_write_b128 v240, v[212:215] offset:80
    ds_write_b128 v240, v[216:219] offset:96
    ds_write_b128 v240, v[220:223] offset:112
    s_mov_b32 exec_lo, 0x3
    s_mov_b32 exec_hi, 0x0
    ds_write_b64 v241, v[6:7] offset:8192
    s_mov_b64 exec, -1
    s_waitcnt lgkmcnt(0)
    s_barrier
    s_cmp_ge_u32 s53, 4
    s_cbranch_scc1 L_bmerge_25
    ds_read_b32 v16, v56 offset:0
    ds_read_b32 v17, v56 offset:1024
    ds_read_b32 v18, v56 offset:2048
    ds_read_b32 v19, v56 offset:3072
    ds_read_b32 v20, v56 offset:4096
    ds_read_b32 v21, v56 offset:5120
    ds_read_b32 v22, v56 offset:6144
    ds_read_b32 v23, v56 offset:7168
    s_lshr_b32 s60, s53, 1
    s_lshl_b32 s61, s60, 6
    v_mov_b32 v9, s61
    ds_read_b128 v[24:27], v9 offset:8192
    ds_read_b128 v[28:31], v9 offset:8208
    ds_read_b128 v[32:35], v9 offset:8224
    ds_read_b128 v[36:39], v9 offset:8240
    s_waitcnt vmcnt(0)
    v_cmp_ne_u32 s[74:75], s52, v252
    v_cmp_ne_u32 s[76:77], s100, v253
    s_or_b64 s[76:77], s[74:75], s[76:77]
    v_and_b32 v8, 2, v0
    v_cmp_eq_u32 vcc, 0, v8
    s_waitcnt lgkmcnt(0)
    v_max3_f32 v10, v24, v26, v28
    v_max3_f32 v10, v10, v30, v32
    v_max3_f32 v10, v10, v34, v36
    v_max_f32 v10, v10, v38
    v_sub_f32 v24, v24, v10
    v_sub_f32 v26, v26, v10
    v_sub_f32 v28, v28, v10
    v_sub_f32 v30, v30, v10
    v_sub_f32 v32, v32, v10
    v_sub_f32 v34, v34, v10
    v_sub_f32 v36, v36, v10
    v_sub_f32 v38, v38, v10
    v_mul_f32 v24, s64, v24
    v_mul_f32 v26, s64, v26
    v_mul_f32 v28, s64, v28
    v_mul_f32 v30, s64, v30
    v_mul_f32 v32, s64, v32
    v_mul_f32 v34, s64, v34
    v_mul_f32 v36, s64, v36
    v_mul_f32 v38, s64, v38
    v_exp_f32 v24, v24
    v_exp_f32 v26, v26
    v_exp_f32 v28, v28
    v_exp_f32 v30, v30
    v_exp_f32 v32, v32
    v_exp_f32 v34, v34
    v_exp_f32 v36, v36
    v_exp_f32 v38, v38
    v_mul_f32 v12, v16, v24
    v_mul_f32 v11, v25, v24
    v_fma_f32 v12, v17, v26, v12
    v_fma_f32 v11, v27, v26, v11
    v_fma_f32 v12, v18, v28, v12
    v_fma_f32 v11, v29, v28, v11
    v_fma_f32 v12, v19, v30, v12
    v_fma_f32 v11, v31, v30, v11
    v_fma_f32 v12, v20, v32, v12
    v_fma_f32 v11, v33, v32, v11
    v_fma_f32 v12, v21, v34, v12
    v_fma_f32 v11, v35, v34, v11
    v_fma_f32 v12, v22, v36, v12
    v_fma_f32 v11, v37, v36, v11
    v_fma_f32 v12, v23, v38, v12
    v_fma_f32 v11, v39, v38, v11
    v_cndmask_b32 v14, v11, v10, vcc
    v_mov_b32 v15, s52
    v_mov_b32_dpp v13, v12 quad_perm:[1,1,3,3] row_mask:0xf bank_mask:0xf
    s_mov_b32 exec_lo, 0x55555555
    s_mov_b32 exec_hi, 0x55555555
    s_cmp_eq_u64 s[76:77], 0
    s_cbranch_scc0 L_bfar_26
    buffer_store_dwordx4 v[12:15], v57, s[12:15], 0 offen sc0
    s_branch L_bpub_27
L_bfar_26:
    buffer_store_dwordx4 v[12:15], v57, s[12:15], 0 offen sc0 sc1
L_bpub_27:
    s_mov_b64 exec, -1
L_bmerge_25:
    s_cmp_ge_u32 s58, 9
    s_cbranch_scc1 L_end
    buffer_load_dwordx4 v[16:19], v58, s[12:15], 0 offen sc1
    buffer_load_dwordx4 v[20:23], v59, s[12:15], 0 offen sc1
    buffer_load_dwordx4 v[24:27], v60, s[12:15], 0 offen sc1
    v_cmp_gt_u32 s[74:75], 2, v3
    v_perm_b32 v192, v228, v224, s65
    v_perm_b32 v193, v228, v224, s66
    v_perm_b32 v194, v229, v225, s65
    v_perm_b32 v195, v229, v225, s66
    v_perm_b32 v196, v230, v226, s65
    v_perm_b32 v197, v230, v226, s66
    v_perm_b32 v198, v231, v227, s65
    v_perm_b32 v199, v231, v227, s66
    v_perm_b32 v200, v236, v232, s65
    v_perm_b32 v201, v236, v232, s66
    v_perm_b32 v202, v237, v233, s65
    v_perm_b32 v203, v237, v233, s66
    v_perm_b32 v204, v238, v234, s65
    v_perm_b32 v205, v238, v234, s66
    v_perm_b32 v206, v239, v235, s65
    v_perm_b32 v207, v239, v235, s66
    s_mov_b32 s62, 3000
L_gpoll_28:
    s_waitcnt vmcnt(0)
    v_cmp_ne_u32 s[80:81], s52, v19
    v_cmp_ne_u32 s[82:83], s52, v23
    v_cmp_ne_u32 s[84:85], s52, v27
    s_or_b64 s[76:77], s[80:81], s[82:83]
    s_or_b64 s[76:77], s[76:77], s[84:85]
    s_cbranch_scc0 L_gdone_29
    s_sub_u32 s62, s62, 1
    s_cmp_eq_u32 s62, 0
    s_cbranch_scc1 L_gdone_29
    s_cmp_eq_u64 s[80:81], 0
    s_cbranch_scc1 L_gskip_30
    s_mov_b64 exec, s[80:81]
    buffer_load_dwordx4 v[16:19], v58, s[12:15], 0 offen sc1
L_gskip_30:
    s_cmp_eq_u64 s[82:83], 0
    s_cbranch_scc1 L_gskip_31
    s_mov_b64 exec, s[82:83]
    buffer_load_dwordx4 v[20:23], v59, s[12:15], 0 offen sc1
L_gskip_31:
    s_cmp_eq_u64 s[84:85], 0
    s_cbranch_scc1 L_gskip_32
    s_mov_b64 exec, s[84:85]
    buffer_load_dwordx4 v[24:27], v60, s[12:15], 0 offen sc1
L_gskip_32:
    s_mov_b64 exec, -1
    s_branch L_gpoll_28
L_gdone_29:
    v_max3_f32 v8, v18, v22, v26
    v_mov_b32 v9, v8
    s_nop 1
    v_permlane16_swap_b32 v8, v9
    v_max_f32 v8, v8, v9
    v_mov_b32 v9, v8
    s_nop 1
    v_permlane32_swap_b32 v8, v9
    v_max_f32 v8, v8, v9
    v_mul_f32 v8, s64, v8
    v_fma_f32 v28, v18, s64, -v8
    v_fma_f32 v29, v22, s64, -v8
    v_fma_f32 v30, v26, s64, -v8
    v_exp_f32 v28, v28
    v_exp_f32 v29, v29
    v_exp_f32 v30, v30
    s_nop 0
    v_cndmask_b32 v30, 0, v30, s[74:75]
    v_mul_f32_dpp v8, v28, v18 quad_perm:[0,0,2,2] row_mask:0xf bank_mask:0xf
    v_mul_f32_dpp v9, v28, v16 quad_perm:[0,0,2,2] row_mask:0xf bank_mask:0xf
    v_mul_f32_dpp v10, v28, v17 quad_perm:[0,0,2,2] row_mask:0xf bank_mask:0xf
    v_fmac_f32_dpp v8, v29, v22 quad_perm:[0,0,2,2] row_mask:0xf bank_mask:0xf
    v_fmac_f32_dpp v9, v29, v20 quad_perm:[0,0,2,2] row_mask:0xf bank_mask:0xf
    v_fmac_f32_dpp v10, v29, v21 quad_perm:[0,0,2,2] row_mask:0xf bank_mask:0xf
    v_fmac_f32_dpp v8, v30, v26 quad_perm:[0,0,2,2] row_mask:0xf bank_mask:0xf
    v_fmac_f32_dpp v9, v30, v24 quad_perm:[0,0,2,2] row_mask:0xf bank_mask:0xf
    v_fmac_f32_dpp v10, v30, v25 quad_perm:[0,0,2,2] row_mask:0xf bank_mask:0xf
    v_mov_b32 v11, v8
    v_mov_b32 v12, v9
    v_mov_b32 v13, v10
    v_permlane16_swap_b32 v8, v11
    v_permlane16_swap_b32 v9, v12
    v_permlane16_swap_b32 v10, v13
    v_add_f32 v8, v8, v11
    v_add_f32 v9, v9, v12
    v_add_f32 v10, v10, v13
    v_mov_b32 v11, v8
    v_mov_b32 v12, v9
    v_mov_b32 v13, v10
    v_permlane32_swap_b32 v8, v11
    v_permlane32_swap_b32 v9, v12
    v_permlane32_swap_b32 v10, v13
    v_add_f32 v8, v8, v11
    v_add_f32 v9, v9, v12
    v_add_f32 v10, v10, v13
    v_rcp_f32_dpp v8, v8 quad_perm:[1,1,3,3] row_mask:0xf bank_mask:0xf
    s_nop 0
    v_mul_f32 v9, v9, v8
    v_mul_f32 v10, v10, v8
    v_cvt_pk_bf16_f32 v9, v9, v10
    ds_bpermute_b32 v24, v242, v9 offset:0
    ds_bpermute_b32 v25, v242, v9 offset:16
    ds_bpermute_b32 v26, v242, v9 offset:32
    ds_bpermute_b32 v27, v242, v9 offset:48
    s_waitcnt lgkmcnt(2)
    v_perm_b32 v16, v25, v24, v243
    s_waitcnt lgkmcnt(0)
    v_perm_b32 v17, v27, v26, v243
    v_dot2_f32_bf16 v64, v192, v16, 0
    v_dot2_f32_bf16 v65, v193, v16, 0
    v_dot2_f32_bf16 v66, v194, v16, 0
    v_dot2_f32_bf16 v67, v195, v16, 0
    v_dot2_f32_bf16 v68, v196, v16, 0
    v_dot2_f32_bf16 v69, v197, v16, 0
    v_dot2_f32_bf16 v70, v198, v16, 0
    v_dot2_f32_bf16 v71, v199, v16, 0
    v_dot2_f32_bf16 v64, v200, v17, v64
    v_dot2_f32_bf16 v65, v201, v17, v65
    v_dot2_f32_bf16 v66, v202, v17, v66
    v_dot2_f32_bf16 v67, v203, v17, v67
    v_dot2_f32_bf16 v68, v204, v17, v68
    v_dot2_f32_bf16 v69, v205, v17, v69
    v_dot2_f32_bf16 v70, v206, v17, v70
    v_dot2_f32_bf16 v71, v207, v17, v71
    v_permlane32_swap_b32 v64, v68
    v_permlane32_swap_b32 v65, v69
    v_permlane32_swap_b32 v66, v70
    v_permlane32_swap_b32 v67, v71
    v_add_f32 v64, v64, v68
    v_add_f32 v65, v65, v69
    v_add_f32 v66, v66, v70
    v_add_f32 v67, v67, v71
    s_nop 0
    v_permlane16_swap_b32 v64, v66
    v_permlane16_swap_b32 v65, v67
    v_add_f32 v64, v64, v66
    v_add_f32 v65, v65, v67
    s_nop 0
    v_add_f32_dpp v64, v64, v64 row_ror:8 row_mask:0xf bank_mask:0xf
    v_add_f32_dpp v65, v65, v65 row_ror:8 row_mask:0xf bank_mask:0xf
    ds_write_b64 v245, v[64:65] offset:12288
    v_mov_b32 v25, s52
    s_waitcnt lgkmcnt(0)
    s_barrier
    s_cmp_eq_u32 s53, 0
    s_cbranch_scc0 L_end
    ds_read_b32 v16, v246 offset:12288
    ds_read_b32 v17, v246 offset:12544
    ds_read_b32 v18, v246 offset:12800
    ds_read_b32 v19, v246 offset:13056
    ds_read_b32 v20, v246 offset:13312
    ds_read_b32 v21, v246 offset:13568
    ds_read_b32 v22, v246 offset:13824
    ds_read_b32 v23, v246 offset:14080
    s_waitcnt lgkmcnt(0)
    v_add_f32 v16, v16, v20
    v_add_f32 v17, v17, v21
    v_add_f32 v18, v18, v22
    v_add_f32 v19, v19, v23
    v_add_f32 v16, v16, v18
    v_add_f32 v17, v17, v19
    v_add_f32 v24, v16, v17
    buffer_store_dwordx2 v[24:25], v247, s[12:15], 0 offen sc0 sc1
    s_endpgm
L_wA:
    s_load_dwordx2 s[8:9], s[0:1], 16
    s_load_dwordx2 s[16:17], s[0:1], 8
    s_load_dwordx2 s[20:21], s[0:1], 24
    s_load_dwordx2 s[24:25], s[0:1], 32
    s_load_dwordx2 s[28:29], s[0:1], 40
    s_load_dwordx2 s[32:33], s[0:1], 88
    s_load_dwordx2 s[36:37], s[0:1], 96
    s_mov_b32 s6, 0x480
    s_mov_b32 s7, 0x20000
    s_mov_b32 s10, 0x480000
    s_mov_b32 s11, 0x20000
    s_mov_b32 s14, 0x10000000
    s_mov_b32 s15, 0x20000
    s_mov_b32 s18, 0x1000000
    s_mov_b32 s19, 0x20000
    s_mov_b32 s22, 0x400000
    s_mov_b32 s23, 0x20000
    s_mov_b32 s26, 0x400000
    s_mov_b32 s27, 0x20000
    s_mov_b32 s30, 0x480000
    s_mov_b32 s31, 0x20000
    s_mov_b32 s34, 0x480
    s_mov_b32 s35, 0x20000
    s_mov_b32 s38, 0x480
    s_mov_b32 s39, 0x20000
    v_and_b32 v1, 63, v0
    v_lshrrev_b32 v4, 6, v0
    v_and_b32 v2, 15, v1
    v_lshrrev_b32 v3, 4, v1
    v_readfirstlane_b32 s53, v4
    s_mov_b32 s64, 0x3e0293ee
    s_mov_b32 s65, 0x05040100
    s_mov_b32 s66, 0x07060302
    s_waitcnt lgkmcnt(0)
    s_cmp_ge_u32 s55, 8
    s_cbranch_scc1 L_roleA2
L_roleA:
    s_lshl_b32 s59, s54, 3
    s_add_u32 s59, s59, s55
    s_lshr_b32 s67, s59, 1
    s_and_b32 s68, s59, 1
    s_lshl_b32 s56, s67, 2
    s_add_u32 s56, s56, s68
    s_add_u32 s56, s56, 128
    s_load_dword s73, s[12:13], 0
    v_lshrrev_b32 v12, 2, v1
    s_mul_i32 s60, s53, 16
    v_add_u32 v12, s60, v12
    v_lshlrev_b32 v11, 13, v12
    v_lshlrev_b32 v12, 1, v12
    v_and_b32 v13, 3, v1
    v_lshlrev_b32 v13, 4, v13
    s_and_b32 s60, s56, 127
    s_lshl_b32 s60, s60, 6
    v_add3_u32 v11, v11, v13, s60
    buffer_load_ushort v212, v12, s[4:7], 0 offen offset:0
    buffer_load_ushort v213, v12, s[4:7], 0 offen offset:256
    buffer_load_ushort v214, v12, s[4:7], 0 offen offset:512
    buffer_load_ushort v215, v12, s[4:7], 0 offen offset:768
    buffer_load_ushort v216, v12, s[4:7], 0 offen offset:1024
    s_mov_b32 s63, 0x0
    buffer_load_dwordx4 v[192:195], v11, s[8:11], s63 offen nt
    s_mov_b32 s63, 0x100000
    buffer_load_dwordx4 v[196:199], v11, s[8:11], s63 offen nt
    s_mov_b32 s63, 0x200000
    buffer_load_dwordx4 v[200:203], v11, s[8:11], s63 offen nt
    s_mov_b32 s63, 0x300000
    buffer_load_dwordx4 v[204:207], v11, s[8:11], s63 offen nt
    s_mov_b32 s63, 0x400000
    buffer_load_dwordx4 v[208:211], v11, s[8:11], s63 offen nt
    s_lshl_b32 s60, s68, 8
    s_lshl_b32 s61, s53, 5
    s_add_u32 s60, s60, s61
    v_lshlrev_b32 v8, 3, v3
    v_add_u32 v8, s60, v8
    v_lshlrev_b32 v9, 13, v8
    v_lshlrev_b32 v10, 4, v2
    s_lshl_b32 s60, s67, 8
    v_add3_u32 v9, v9, v10, s60
    s_barrier
    s_mov_b32 s63, 0
    buffer_load_dwordx4 v[160:163], v9, s[20:23], s63 offen nt
    s_mov_b32 s63, 8192
    buffer_load_dwordx4 v[164:167], v9, s[20:23], s63 offen nt
    s_mov_b32 s63, 16384
    buffer_load_dwordx4 v[168:171], v9, s[20:23], s63 offen nt
    s_mov_b32 s63, 24576
    buffer_load_dwordx4 v[172:175], v9, s[20:23], s63 offen nt
    s_mov_b32 s63, 32768
    buffer_load_dwordx4 v[176:179], v9, s[20:23], s63 offen nt
    s_mov_b32 s63, 40960
    buffer_load_dwordx4 v[180:183], v9, s[20:23], s63 offen nt
    s_mov_b32 s63, 49152
    buffer_load_dwordx4 v[184:187], v9, s[20:23], s63 offen nt
    s_mov_b32 s63, 57344
    buffer_load_dwordx4 v[188:191], v9, s[20:23], s63 offen nt
    s_waitcnt lgkmcnt(0)
    s_mul_i32 s52, s73, 1664525
    s_add_u32 s52, s52, 1013904223
    s_waitcnt vmcnt(8)
    v_lshlrev_b32 v13, 16, v212
    v_dot2_f32_bf16 v16, v192, v212, 0
    v_dot2_f32_bf16 v18, v193, v212, 0
    v_dot2_f32_bf16 v20, v194, v212, 0
    v_dot2_f32_bf16 v22, v195, v212, 0
    v_dot2_f32_bf16 v17, v192, v13, 0
    v_dot2_f32_bf16 v19, v193, v13, 0
    v_dot2_f32_bf16 v21, v194, v13, 0
    v_dot2_f32_bf16 v23, v195, v13, 0
    v_lshlrev_b32 v13, 16, v213
    v_dot2_f32_bf16 v16, v196, v213, v16
    v_dot2_f32_bf16 v18, v197, v213, v18
    v_dot2_f32_bf16 v20, v198, v213, v20
    v_dot2_f32_bf16 v22, v199, v213, v22
    v_dot2_f32_bf16 v17, v196, v13, v17
    v_dot2_f32_bf16 v19, v197, v13, v19
    v_dot2_f32_bf16 v21, v198, v13, v21
    v_dot2_f32_bf16 v23, v199, v13, v23
    v_lshlrev_b32 v13, 16, v214
    v_dot2_f32_bf16 v16, v200, v214, v16
    v_dot2_f32_bf16 v18, v201, v214, v18
    v_dot2_f32_bf16 v20, v202, v214, v20
    v_dot2_f32_bf16 v22, v203, v214, v22
    v_dot2_f32_bf16 v17, v200, v13, v17
    v_dot2_f32_bf16 v19, v201, v13, v19
    v_dot2_f32_bf16 v21, v202, v13, v21
    v_dot2_f32_bf16 v23, v203, v13, v23
    v_lshlrev_b32 v13, 16, v215
    v_dot2_f32_bf16 v16, v204, v215, v16
    v_dot2_f32_bf16 v18, v205, v215, v18
    v_dot2_f32_bf16 v20, v206, v215, v20
    v_dot2_f32_bf16 v22, v207, v215, v22
    v_dot2_f32_bf16 v17, v204, v13, v17
    v_dot2_f32_bf16 v19, v205, v13, v19
    v_dot2_f32_bf16 v21, v206, v13, v21
    v_dot2_f32_bf16 v23, v207, v13, v23
    v_lshlrev_b32 v13, 16, v216
    v_dot2_f32_bf16 v16, v208, v216, v16
    v_dot2_f32_bf16 v18, v209, v216, v18
    v_dot2_f32_bf16 v20, v210, v216, v20
    v_dot2_f32_bf16 v22, v211, v216, v22
    v_dot2_f32_bf16 v17, v208, v13, v17
    v_dot2_f32_bf16 v19, v209, v13, v19
    v_dot2_f32_bf16 v21, v210, v13, v21
    v_dot2_f32_bf16 v23, v211, v13, v23
    v_add_f32_dpp v16, v16, v16 row_ror:4 row_mask:0xf bank_mask:0xf
    v_add_f32_dpp v17, v17, v17 row_ror:4 row_mask:0xf bank_mask:0xf
    v_add_f32_dpp v18, v18, v18 row_ror:4 row_mask:0xf bank_mask:0xf
    v_add_f32_dpp v19, v19, v19 row_ror:4 row_mask:0xf bank_mask:0xf
    v_add_f32_dpp v20, v20, v20 row_ror:4 row_mask:0xf bank_mask:0xf
    v_add_f32_dpp v21, v21, v21 row_ror:4 row_mask:0xf bank_mask:0xf
    v_add_f32_dpp v22, v22, v22 row_ror:4 row_mask:0xf bank_mask:0xf
    v_add_f32_dpp v23, v23, v23 row_ror:4 row_mask:0xf bank_mask:0xf
    v_add_f32_dpp v16, v16, v16 row_ror:8 row_mask:0xf bank_mask:0xf
    v_add_f32_dpp v17, v17, v17 row_ror:8 row_mask:0xf bank_mask:0xf
    v_add_f32_dpp v18, v18, v18 row_ror:8 row_mask:0xf bank_mask:0xf
    v_add_f32_dpp v19, v19, v19 row_ror:8 row_mask:0xf bank_mask:0xf
    v_add_f32_dpp v20, v20, v20 row_ror:8 row_mask:0xf bank_mask:0xf
    v_add_f32_dpp v21, v21, v21 row_ror:8 row_mask:0xf bank_mask:0xf
    v_add_f32_dpp v22, v22, v22 row_ror:8 row_mask:0xf bank_mask:0xf
    v_add_f32_dpp v23, v23, v23 row_ror:8 row_mask:0xf bank_mask:0xf
    v_and_b32 v13, 3, v1
    v_lshlrev_b32 v13, 5, v13
    v_mul_u32_u24 v12, 128, v3
    s_mul_i32 s60, s53, 512
    s_add_u32 s60, s60, 136704
    v_add3_u32 v11, v13, v12, s60
    s_mov_b32 exec_lo, 0xf000f
    s_mov_b32 exec_hi, 0xf000f
    ds_write_b128 v11, v[16:19]
    ds_write_b128 v11, v[20:23] offset:16
    s_mov_b64 exec, -1
    s_waitcnt lgkmcnt(0)
    s_barrier
    s_cmp_eq_u32 s53, 0
    s_cbranch_scc0 L_p1pub_33
    v_mul_u32_u24 v12, 1024, v3
    v_lshlrev_b32 v13, 3, v2
    v_add3_u32 v11, v12, v13, 0
    v_add_u32 v11, 136704, v11
    ds_read_b64 v[192:193], v11 offset:0
    ds_read_b64 v[194:195], v11 offset:128
    ds_read_b64 v[196:197], v11 offset:256
    ds_read_b64 v[198:199], v11 offset:384
    ds_read_b64 v[200:201], v11 offset:512
    ds_read_b64 v[202:203], v11 offset:640
    ds_read_b64 v[204:205], v11 offset:768
    ds_read_b64 v[206:207], v11 offset:896
    s_waitcnt lgkmcnt(0)
    v_add_f32 v192, v192, v200
    v_add_f32 v193, v193, v201
    v_add_f32 v194, v194, v202
    v_add_f32 v195, v195, v203
    v_add_f32 v196, v196, v204
    v_add_f32 v197, v197, v205
    v_add_f32 v198, v198, v206
    v_add_f32 v199, v199, v207
    v_add_f32 v192, v192, v196
    v_add_f32 v193, v193, v197
    v_add_f32 v194, v194, v198
    v_add_f32 v195, v195, v199
    v_add_f32 v192, v192, v194
    v_add_f32 v193, v193, v195
    v_mov_b32 v194, v192
    v_mov_b32 v195, v193
    s_nop 0
    v_permlane16_swap_b32 v192, v194
    v_permlane16_swap_b32 v193, v195
    v_add_f32 v192, v192, v194
    v_add_f32 v193, v193, v195
    v_mov_b32 v194, v192
    v_mov_b32 v195, v193
    s_nop 0
    v_permlane32_swap_b32 v192, v194
    v_permlane32_swap_b32 v193, v195
    v_add_f32 v192, v192, v194
    v_add_f32 v193, v193, v195
    v_cvt_pk_bf16_f32 v196, v192, v193
    v_mov_b32 v197, s52
    s_lshl_b32 s60, s56, 7
    s_add_u32 s60, s60, 4096
    v_add_u32 v11, s60, v13
    s_mov_b32 exec_lo, 0xffff
    s_mov_b32 exec_hi, 0x0
    buffer_store_dwordx2 v[196:197], v11, s[12:15], 0 offen sc0 sc1
    s_mov_b64 exec, -1
L_p1pub_33:
    s_cmp_eq_u32 s53, 0
    s_cbranch_scc0 L_aq_34
    v_and_b32 v11, 31, v1
    v_lshlrev_b32 v9, 4, v11
    s_lshl_b32 s60, s67, 9
    s_add_u32 s60, s60, 20480
    v_add_u32 v9, s60, v9
    s_mov_b32 s62, 3000
L_poll_35:
    buffer_load_dwordx4 v[12:15], v9, s[12:15], 0 offen sc1
    s_waitcnt vmcnt(0)
    v_xor_b32 v20, s52, v13
    v_xor_b32 v21, s52, v15
    v_or_b32 v20, v20, v21
    v_cmp_eq_u32 vcc, 0, v20
    s_cmp_eq_u64 vcc, -1
    s_cbranch_scc1 L_pdone_36
    s_sub_u32 s62, s62, 1
    s_cmp_eq_u32 s62, 0
    s_cbranch_scc0 L_poll_35
L_pdone_36:
    v_mov_b32 v13, v14
    v_lshlrev_b32 v11, 3, v11
    v_add_u32 v11, 140800, v11
    ds_write_b64 v11, v[12:13]
    s_waitcnt lgkmcnt(0)
L_aq_34:
    s_barrier
    v_add_u32 v10, 140800, v10
    ds_read_b128 v[12:15], v10
    s_waitcnt vmcnt(0) lgkmcnt(0)
    v_dot2_f32_bf16 v16, v160, v12, 0
    v_dot2_f32_bf16 v17, v164, v12, 0
    v_dot2_f32_bf16 v18, v168, v12, 0
    v_dot2_f32_bf16 v19, v172, v12, 0
    v_dot2_f32_bf16 v20, v176, v12, 0
    v_dot2_f32_bf16 v21, v180, v12, 0
    v_dot2_f32_bf16 v22, v184, v12, 0
    v_dot2_f32_bf16 v23, v188, v12, 0
    v_dot2_f32_bf16 v16, v161, v13, v16
    v_dot2_f32_bf16 v17, v165, v13, v17
    v_dot2_f32_bf16 v18, v169, v13, v18
    v_dot2_f32_bf16 v19, v173, v13, v19
    v_dot2_f32_bf16 v20, v177, v13, v20
    v_dot2_f32_bf16 v21, v181, v13, v21
    v_dot2_f32_bf16 v22, v185, v13, v22
    v_dot2_f32_bf16 v23, v189, v13, v23
    v_dot2_f32_bf16 v16, v162, v14, v16
    v_dot2_f32_bf16 v17, v166, v14, v17
    v_dot2_f32_bf16 v18, v170, v14, v18
    v_dot2_f32_bf16 v19, v174, v14, v19
    v_dot2_f32_bf16 v20, v178, v14, v20
    v_dot2_f32_bf16 v21, v182, v14, v21
    v_dot2_f32_bf16 v22, v186, v14, v22
    v_dot2_f32_bf16 v23, v190, v14, v23
    v_dot2_f32_bf16 v16, v163, v15, v16
    v_dot2_f32_bf16 v17, v167, v15, v17
    v_dot2_f32_bf16 v18, v171, v15, v18
    v_dot2_f32_bf16 v19, v175, v15, v19
    v_dot2_f32_bf16 v20, v179, v15, v20
    v_dot2_f32_bf16 v21, v183, v15, v21
    v_dot2_f32_bf16 v22, v187, v15, v22
    v_dot2_f32_bf16 v23, v191, v15, v23
    v_add_f32_dpp v16, v16, v16 quad_perm:[1,0,3,2] row_mask:0xf bank_mask:0xf
    v_add_f32_dpp v17, v17, v17 quad_perm:[1,0,3,2] row_mask:0xf bank_mask:0xf
    v_add_f32_dpp v18, v18, v18 quad_perm:[1,0,3,2] row_mask:0xf bank_mask:0xf
    v_add_f32_dpp v19, v19, v19 quad_perm:[1,0,3,2] row_mask:0xf bank_mask:0xf
    v_add_f32_dpp v20, v20, v20 quad_perm:[1,0,3,2] row_mask:0xf bank_mask:0xf
    v_add_f32_dpp v21, v21, v21 quad_perm:[1,0,3,2] row_mask:0xf bank_mask:0xf
    v_add_f32_dpp v22, v22, v22 quad_perm:[1,0,3,2] row_mask:0xf bank_mask:0xf
    v_add_f32_dpp v23, v23, v23 quad_perm:[1,0,3,2] row_mask:0xf bank_mask:0xf
    v_add_f32_dpp v16, v16, v16 quad_perm:[2,3,0,1] row_mask:0xf bank_mask:0xf
    v_add_f32_dpp v17, v17, v17 quad_perm:[2,3,0,1] row_mask:0xf bank_mask:0xf
    v_add_f32_dpp v18, v18, v18 quad_perm:[2,3,0,1] row_mask:0xf bank_mask:0xf
    v_add_f32_dpp v19, v19, v19 quad_perm:[2,3,0,1] row_mask:0xf bank_mask:0xf
    v_add_f32_dpp v20, v20, v20 quad_perm:[2,3,0,1] row_mask:0xf bank_mask:0xf
    v_add_f32_dpp v21, v21, v21 quad_perm:[2,3,0,1] row_mask:0xf bank_mask:0xf
    v_add_f32_dpp v22, v22, v22 quad_perm:[2,3,0,1] row_mask:0xf bank_mask:0xf
    v_add_f32_dpp v23, v23, v23 quad_perm:[2,3,0,1] row_mask:0xf bank_mask:0xf
    v_add_f32_dpp v16, v16, v16 row_ror:4 row_mask:0xf bank_mask:0xf
    v_add_f32_dpp v17, v17, v17 row_ror:4 row_mask:0xf bank_mask:0xf
    v_add_f32_dpp v18, v18, v18 row_ror:4 row_mask:0xf bank_mask:0xf
    v_add_f32_dpp v19, v19, v19 row_ror:4 row_mask:0xf bank_mask:0xf
    v_add_f32_dpp v20, v20, v20 row_ror:4 row_mask:0xf bank_mask:0xf
    v_add_f32_dpp v21, v21, v21 row_ror:4 row_mask:0xf bank_mask:0xf
    v_add_f32_dpp v22, v22, v22 row_ror:4 row_mask:0xf bank_mask:0xf
    v_add_f32_dpp v23, v23, v23 row_ror:4 row_mask:0xf bank_mask:0xf
    v_add_f32_dpp v16, v16, v16 row_ror:8 row_mask:0xf bank_mask:0xf
    v_add_f32_dpp v17, v17, v17 row_ror:8 row_mask:0xf bank_mask:0xf
    v_add_f32_dpp v18, v18, v18 row_ror:8 row_mask:0xf bank_mask:0xf
    v_add_f32_dpp v19, v19, v19 row_ror:8 row_mask:0xf bank_mask:0xf
    v_add_f32_dpp v20, v20, v20 row_ror:8 row_mask:0xf bank_mask:0xf
    v_add_f32_dpp v21, v21, v21 row_ror:8 row_mask:0xf bank_mask:0xf
    v_add_f32_dpp v22, v22, v22 row_ror:8 row_mask:0xf bank_mask:0xf
    v_add_f32_dpp v23, v23, v23 row_ror:8 row_mask:0xf bank_mask:0xf
    v_cvt_pk_bf16_f32 v24, v16, v17
    v_cvt_pk_bf16_f32 v25, v18, v19
    v_cvt_pk_bf16_f32 v26, v20, v21
    v_cvt_pk_bf16_f32 v27, v22, v23
    v_lshlrev_b32 v8, 1, v8
    s_lshl_b32 s60, s67, 10
    s_add_u32 s60, s60, 65536
    v_add_u32 v8, s60, v8
    s_mov_b32 exec_lo, 0x10001
    s_mov_b32 exec_hi, 0x10001
    buffer_store_dwordx4 v[24:27], v8, s[12:15], 0 offen sc0 sc1
    s_mov_b64 exec, -1
    s_waitcnt vmcnt(0)
    s_barrier
    s_cmp_eq_u32 s53, 0
    s_cbranch_scc0 L_aqf_37
    s_lshl_b32 s60, s59, 2
    s_add_u32 s60, s60, 98304
    v_mov_b32 v8, s60
    v_mov_b32 v9, s52
    s_mov_b32 exec_lo, 0x1
    s_mov_b32 exec_hi, 0x0
    buffer_store_dword v9, v8, s[12:15], 0 offen sc0 sc1
    s_mov_b64 exec, -1
L_aqf_37:
    s_and_b32 s60, s53, 1
    s_lshl_b32 s61, s60, 3
    s_or_b32 s61, s61, 0
    v_xor_b32 v224, s61, v1
    v_lshlrev_b32 v224, 4, v224
    s_lshl_b32 s61, s60, 3
    s_or_b32 s61, s61, 2
    v_xor_b32 v225, s61, v1
    v_lshlrev_b32 v225, 4, v225
    s_lshl_b32 s61, s60, 3
    s_or_b32 s61, s61, 4
    v_xor_b32 v226, s61, v1
    v_lshlrev_b32 v226, 4, v226
    s_lshl_b32 s61, s60, 3
    s_or_b32 s61, s61, 6
    v_xor_b32 v227, s61, v1
    v_lshlrev_b32 v227, 4, v227
    s_lshl_b32 s61, s60, 3
    s_or_b32 s61, s61, 1
    v_xor_b32 v228, s61, v1
    v_lshlrev_b32 v228, 4, v228
    s_lshl_b32 s61, s60, 3
    s_or_b32 s61, s61, 3
    v_xor_b32 v229, s61, v1
    v_lshlrev_b32 v229, 4, v229
    s_lshl_b32 s61, s60, 3
    s_or_b32 s61, s61, 5
    v_xor_b32 v230, s61, v1
    v_lshlrev_b32 v230, 4, v230
    s_lshl_b32 s61, s60, 3
    s_or_b32 s61, s61, 7
    v_xor_b32 v231, s61, v1
    v_lshlrev_b32 v231, 4, v231
    s_lshl_b32 s82, s59, 18
    s_lshl_b32 s61, s53, 10
    s_add_u32 s82, s82, s61
    s_lshl_b32 s83, s53, 13
    s_mov_b32 s80, s82
    s_add_u32 m0, s83, 0
    s_add_u32 s63, s80, 0
    buffer_load_dwordx4 v224, s[16:19], s63 offen nt lds
    s_add_u32 m0, s83, 1024
    s_add_u32 s63, s80, 8192
    buffer_load_dwordx4 v225, s[16:19], s63 offen nt lds
    s_add_u32 m0, s83, 2048
    s_add_u32 s63, s80, 16384
    buffer_load_dwordx4 v226, s[16:19], s63 offen nt lds
    s_add_u32 m0, s83, 3072
    s_add_u32 s63, s80, 24576
    buffer_load_dwordx4 v227, s[16:19], s63 offen nt lds
    s_add_u32 m0, s83, 4096
    s_add_u32 s63, s80, 32768
    buffer_load_dwordx4 v228, s[16:19], s63 offen nt lds
    s_add_u32 m0, s83, 5120
    s_add_u32 s63, s80, 40960
    buffer_load_dwordx4 v229, s[16:19], s63 offen nt lds
    s_add_u32 m0, s83, 6144
    s_add_u32 s63, s80, 49152
    buffer_load_dwordx4 v230, s[16:19], s63 offen nt lds
    s_add_u32 m0, s83, 7168
    s_add_u32 s63, s80, 57344
    buffer_load_dwordx4 v231, s[16:19], s63 offen nt lds
    v_and_b32 v8, 8, v2
    v_bfe_u32 v9, v2, 1, 1
    v_lshlrev_b32 v9, 2, v9
    v_and_b32 v10, 1, v2
    v_lshlrev_b32 v10, 1, v10
    v_bfe_u32 v11, v2, 2, 1
    v_or3_b32 v8, v8, v9, v10
    v_or_b32 v8, v8, v11
    s_lshr_b32 s60, s53, 1
    s_lshl_b32 s60, s60, 14
    v_lshlrev_b32 v9, 10, v2
    v_lshlrev_b32 v10, 1, v3
    v_add_u32 v232, 0, v10
    v_xor_b32 v232, v232, v8
    v_lshlrev_b32 v232, 4, v232
    v_add_u32 v232, v232, v9
    v_add_u32 v233, 1, v10
    v_xor_b32 v233, v233, v8
    v_lshlrev_b32 v233, 4, v233
    v_add_u32 v233, v233, v9
    v_add_u32 v234, 8, v10
    v_xor_b32 v234, v234, v8
    v_lshlrev_b32 v234, 4, v234
    v_add_u32 v234, v234, v9
    v_add_u32 v235, 9, v10
    v_xor_b32 v235, v235, v8
    v_lshlrev_b32 v235, 4, v235
    v_add_u32 v235, v235, v9
    s_cmp_eq_u32 s53, 0
    s_cbranch_scc0 L_aqp_38
    v_lshlrev_b32 v12, 2, v1
    v_add_u32 v12, 98304, v12
    s_mov_b32 s62, 3000
L_poll_39:
    buffer_load_dword v13, v12, s[12:15], 0 offen sc1
    s_waitcnt vmcnt(0)
    v_xor_b32 v14, s52, v13
    v_cmp_eq_u32 vcc, 0, v14
    s_cmp_eq_u64 vcc, -1
    s_cbranch_scc1 L_pdone_40
    s_sub_u32 s62, s62, 1
    s_cmp_eq_u32 s62, 0
    s_cbranch_scc0 L_poll_39
L_pdone_40:
L_aqp_38:
    s_barrier
    s_cmp_ge_u32 s53, 4
    s_cbranch_scc1 L_aqg_41
    s_mov_b32 s80, 65536
    s_lshl_b32 s61, s53, 13
    s_add_u32 s80, s80, s61
    s_add_u32 s81, s83, 65536
    s_add_u32 m0, s81, 0
    s_add_u32 s63, s80, 0
    buffer_load_dwordx4 v224, s[12:15], s63 offen sc1 lds
    s_add_u32 m0, s81, 1024
    s_add_u32 s63, s80, 1024
    buffer_load_dwordx4 v225, s[12:15], s63 offen sc1 lds
    s_add_u32 m0, s81, 2048
    s_add_u32 s63, s80, 2048
    buffer_load_dwordx4 v226, s[12:15], s63 offen sc1 lds
    s_add_u32 m0, s81, 3072
    s_add_u32 s63, s80, 3072
    buffer_load_dwordx4 v227, s[12:15], s63 offen sc1 lds
    s_add_u32 m0, s81, 4096
    s_add_u32 s63, s80, 4096
    buffer_load_dwordx4 v228, s[12:15], s63 offen sc1 lds
    s_add_u32 m0, s81, 5120
    s_add_u32 s63, s80, 5120
    buffer_load_dwordx4 v229, s[12:15], s63 offen sc1 lds
    s_add_u32 m0, s81, 6144
    s_add_u32 s63, s80, 6144
    buffer_load_dwordx4 v230, s[12:15], s63 offen sc1 lds
    s_add_u32 m0, s81, 7168
    s_add_u32 s63, s80, 7168
    buffer_load_dwordx4 v231, s[12:15], s63 offen sc1 lds
L_aqg_41:
    s_waitcnt vmcnt(0)
    s_barrier
    s_and_b32 s61, s53, 1
    s_lshl_b32 s61, s61, 14
    s_add_u32 s61, s61, 65536
    v_add_u32 v4, s61, v232
    v_add_u32 v5, s61, v233
    v_add_u32 v6, s61, v234
    v_add_u32 v7, s61, v235
    ds_read_b128 v[64:67], v4 offset:0
    ds_read_b128 v[68:71], v5 offset:0
    ds_read_b128 v[72:75], v6 offset:0
    ds_read_b128 v[76:79], v7 offset:0
    ds_read_b128 v[80:83], v4 offset:256
    ds_read_b128 v[84:87], v5 offset:256
    ds_read_b128 v[88:91], v6 offset:256
    ds_read_b128 v[92:95], v7 offset:256
    ds_read_b128 v[96:99], v4 offset:512
    ds_read_b128 v[100:103], v5 offset:512
    ds_read_b128 v[104:107], v6 offset:512
    ds_read_b128 v[108:111], v7 offset:512
    ds_read_b128 v[112:115], v4 offset:768
    ds_read_b128 v[116:119], v5 offset:768
    ds_read_b128 v[120:123], v6 offset:768
    ds_read_b128 v[124:127], v7 offset:768
    v_add_u32 v232, s60, v232
    v_add_u32 v233, s60, v233
    v_add_u32 v234, s60, v234
    v_add_u32 v235, s60, v235
    s_waitcnt lgkmcnt(0)
    s_barrier
    s_add_u32 s80, s82, 65536
    s_add_u32 s81, s83, 65536
    s_add_u32 m0, s81, 0
    s_add_u32 s63, s80, 0
    buffer_load_dwordx4 v224, s[16:19], s63 offen nt lds
    s_add_u32 m0, s81, 1024
    s_add_u32 s63, s80, 8192
    buffer_load_dwordx4 v225, s[16:19], s63 offen nt lds
    s_add_u32 m0, s81, 2048
    s_add_u32 s63, s80, 16384
    buffer_load_dwordx4 v226, s[16:19], s63 offen nt lds
    s_add_u32 m0, s81, 3072
    s_add_u32 s63, s80, 24576
    buffer_load_dwordx4 v227, s[16:19], s63 offen nt lds
    s_add_u32 m0, s81, 4096
    s_add_u32 s63, s80, 32768
    buffer_load_dwordx4 v228, s[16:19], s63 offen nt lds
    s_add_u32 m0, s81, 5120
    s_add_u32 s63, s80, 40960
    buffer_load_dwordx4 v229, s[16:19], s63 offen nt lds
    s_add_u32 m0, s81, 6144
    s_add_u32 s63, s80, 49152
    buffer_load_dwordx4 v230, s[16:19], s63 offen nt lds
    s_add_u32 m0, s81, 7168
    s_add_u32 s63, s80, 57344
    buffer_load_dwordx4 v231, s[16:19], s63 offen nt lds
    v_lshrrev_b32 v8, 2, v2
    v_and_b32 v9, 3, v2
    v_lshlrev_b32 v10, 3, v3
    v_add_u32 v10, v10, v8
    v_lshlrev_b32 v10, 10, v10
    v_and_b32 v11, 1, v3
    v_lshlrev_b32 v11, 3, v11
    v_lshrrev_b32 v12, 1, v8
    v_lshlrev_b32 v12, 2, v12
    v_and_b32 v13, 1, v8
    v_lshlrev_b32 v13, 1, v13
    v_or3_b32 v11, v11, v12, v13
    v_lshrrev_b32 v12, 1, v9
    s_lshl_b32 s60, s53, 3
    v_add_u32 v12, s60, v12
    v_xor_b32 v12, v12, v11
    v_lshlrev_b32 v12, 4, v12
    v_and_b32 v13, 1, v9
    v_lshlrev_b32 v13, 3, v13
    v_add3_u32 v12, v12, v13, v10
    v_xor_b32 v236, 0, v12
    v_xor_b32 v237, 16, v12
    v_add_u32 v237, 4096, v237
    v_xor_b32 v238, 32, v12
    v_xor_b32 v239, 48, v12
    v_add_u32 v239, 4096, v239
    v_xor_b32 v240, 64, v12
    v_xor_b32 v241, 80, v12
    v_add_u32 v241, 4096, v241
    v_xor_b32 v242, 96, v12
    v_xor_b32 v243, 112, v12
    v_add_u32 v243, 4096, v243
    v_mul_u32_u24 v8, 144, v2
    v_lshlrev_b32 v9, 4, v3
    v_add3_u32 v244, v8, v9, 0
    v_add_u32 v244, 131072, v244
    s_and_b32 s60, s53, 1
    s_cmp_eq_u32 s60, 1
    s_cselect_b64 s[76:77], -1, 0
    s_mul_i32 s61, s60, 2304
    s_lshr_b32 s63, s53, 1
    s_lshl_b32 s62, s63, 5
    s_add_u32 s61, s61, s62
    s_add_u32 s61, s61, 131072
    v_lshlrev_b32 v9, 3, v3
    v_add3_u32 v245, v8, v9, s61
    v_lshlrev_b32 v8, 4, v2
    v_add_u32 v247, 135680, v8
    s_lshl_b32 s61, s60, 8
    s_lshl_b32 s62, s63, 2
    s_add_u32 s61, s61, s62
    s_add_u32 s61, s61, 135680
    v_add_u32 v246, s61, v8
    ds_read_b128 v[160:163], v232 offset:0
    ds_read_b128 v[164:167], v233 offset:0
    ds_read_b128 v[168:171], v234 offset:0
    ds_read_b128 v[172:175], v235 offset:0
    ds_read_b128 v[176:179], v232 offset:256
    ds_read_b128 v[180:183], v233 offset:256
    ds_read_b128 v[184:187], v234 offset:256
    ds_read_b128 v[188:191], v235 offset:256
    ds_read_b128 v[192:195], v232 offset:512
    ds_read_b128 v[196:199], v233 offset:512
    ds_read_b128 v[200:203], v234 offset:512
    ds_read_b128 v[204:207], v235 offset:512
    ds_read_b128 v[208:211], v232 offset:768
    ds_read_b128 v[212:215], v233 offset:768
    ds_read_b128 v[216:219], v234 offset:768
    ds_read_b128 v[220:223], v235 offset:768
    s_waitcnt lgkmcnt(12)
    v_mfma_f32_16x16x32_bf16 v[16:19], v[160:163], v[64:67], 0
    v_mfma_f32_16x16x32_bf16 v[16:19], v[164:167], v[68:71], v[16:19]
    v_mfma_f32_16x16x32_bf16 v[16:19], v[168:171], v[72:75], v[16:19]
    v_mfma_f32_16x16x32_bf16 v[16:19], v[172:175], v[76:79], v[16:19]
    s_waitcnt lgkmcnt(8)
    v_mfma_f32_16x16x32_bf16 v[16:19], v[176:179], v[80:83], v[16:19]
    v_mfma_f32_16x16x32_bf16 v[16:19], v[180:183], v[84:87], v[16:19]
    v_mfma_f32_16x16x32_bf16 v[16:19], v[184:187], v[88:91], v[16:19]
    v_mfma_f32_16x16x32_bf16 v[16:19], v[188:191], v[92:95], v[16:19]
    s_waitcnt lgkmcnt(4)
    v_mfma_f32_16x16x32_bf16 v[16:19], v[192:195], v[96:99], v[16:19]
    v_mfma_f32_16x16x32_bf16 v[16:19], v[196:199], v[100:103], v[16:19]
    v_mfma_f32_16x16x32_bf16 v[16:19], v[200:203], v[104:107], v[16:19]
    v_mfma_f32_16x16x32_bf16 v[16:19], v[204:207], v[108:111], v[16:19]
    s_waitcnt lgkmcnt(0)
    v_mfma_f32_16x16x32_bf16 v[16:19], v[208:211], v[112:115], v[16:19]
    v_mfma_f32_16x16x32_bf16 v[16:19], v[212:215], v[116:119], v[16:19]
    v_mfma_f32_16x16x32_bf16 v[16:19], v[216:219], v[120:123], v[16:19]
    v_mfma_f32_16x16x32_bf16 v[16:19], v[220:223], v[124:127], v[16:19]
    s_nop 7
    v_max3_f32 v8, v16, v17, v18
    v_max_f32 v8, v8, v19
    v_mov_b32 v9, v8
    s_nop 1
    v_permlane16_swap_b32 v8, v9
    v_max_f32 v8, v8, v9
    v_mov_b32 v9, v8
    s_nop 1
    v_permlane32_swap_b32 v8, v9
    v_max_f32 v8, v8, v9
    ds_write_b32 v246, v8
    s_waitcnt lgkmcnt(0)
    s_barrier
    ds_read_b128 v[20:23], v247
    ds_read_b128 v[24:27], v247 offset:256
    s_waitcnt lgkmcnt(0)
    v_max3_f32 v8, v20, v21, v22
    v_max3_f32 v9, v24, v25, v26
    v_max_f32 v8, v8, v23
    v_max_f32 v9, v9, v27
    v_mov_b32 v248, v8
    v_mov_b32 v249, v9
    v_cndmask_b32 v12, v8, v9, s[76:77]
    v_mul_f32 v12, s64, v12
    v_fma_f32 v16, v16, s64, -v12
    v_fma_f32 v17, v17, s64, -v12
    v_fma_f32 v18, v18, s64, -v12
    v_fma_f32 v19, v19, s64, -v12
    v_exp_f32 v16, v16
    v_exp_f32 v17, v17
    v_exp_f32 v18, v18
    v_exp_f32 v19, v19
    v_cvt_pk_bf16_f32 v20, v16, v17
    v_cvt_pk_bf16_f32 v21, v18, v19
    ds_write_b64 v245, v[20:21]
    v_add_f32 v16, v16, v17
    v_add_f32 v18, v18, v19
    v_add_f32 v16, v16, v18
    v_mov_b32 v250, v16
    s_waitcnt lgkmcnt(0)
    s_barrier
    ds_read_b128 v[192:195], v244 offset:0
    ds_read_b128 v[196:199], v244 offset:64
    ds_read_b128 v[200:203], v244 offset:2304
    ds_read_b128 v[204:207], v244 offset:2368
    ds_read_b64_tr_b16 v[160:161], v236 offset:0
    ds_read_b64_tr_b16 v[162:163], v237 offset:0
    ds_read_b64_tr_b16 v[164:165], v236 offset:32768
    ds_read_b64_tr_b16 v[166:167], v237 offset:32768
    ds_read_b64_tr_b16 v[168:169], v238 offset:0
    ds_read_b64_tr_b16 v[170:171], v239 offset:0
    ds_read_b64_tr_b16 v[172:173], v238 offset:32768
    ds_read_b64_tr_b16 v[174:175], v239 offset:32768
    ds_read_b64_tr_b16 v[176:177], v240 offset:0
    ds_read_b64_tr_b16 v[178:179], v241 offset:0
    ds_read_b64_tr_b16 v[180:181], v240 offset:32768
    ds_read_b64_tr_b16 v[182:183], v241 offset:32768
    ds_read_b64_tr_b16 v[184:185], v242 offset:0
    ds_read_b64_tr_b16 v[186:187], v243 offset:0
    ds_read_b64_tr_b16 v[188:189], v242 offset:32768
    ds_read_b64_tr_b16 v[190:191], v243 offset:32768
    s_waitcnt lgkmcnt(12)
    v_mfma_f32_16x16x32_bf16 v[128:131], v[160:163], v[192:195], 0
    v_mfma_f32_16x16x32_bf16 v[128:131], v[164:167], v[196:199], v[128:131]
    v_mfma_f32_16x16x32_bf16 v[132:135], v[160:163], v[200:203], 0
    v_mfma_f32_16x16x32_bf16 v[132:135], v[164:167], v[204:207], v[132:135]
    s_waitcnt lgkmcnt(8)
    v_mfma_f32_16x16x32_bf16 v[136:139], v[168:171], v[192:195], 0
    v_mfma_f32_16x16x32_bf16 v[136:139], v[172:175], v[196:199], v[136:139]
    v_mfma_f32_16x16x32_bf16 v[140:143], v[168:171], v[200:203], 0
    v_mfma_f32_16x16x32_bf16 v[140:143], v[172:175], v[204:207], v[140:143]
    s_waitcnt lgkmcnt(4)
    v_mfma_f32_16x16x32_bf16 v[144:147], v[176:179], v[192:195], 0
    v_mfma_f32_16x16x32_bf16 v[144:147], v[180:183], v[196:199], v[144:147]
    v_mfma_f32_16x16x32_bf16 v[148:151], v[176:179], v[200:203], 0
    v_mfma_f32_16x16x32_bf16 v[148:151], v[180:183], v[204:207], v[148:151]
    s_waitcnt lgkmcnt(0)
    v_mfma_f32_16x16x32_bf16 v[152:155], v[184:187], v[192:195], 0
    v_mfma_f32_16x16x32_bf16 v[152:155], v[188:191], v[196:199], v[152:155]
    v_mfma_f32_16x16x32_bf16 v[156:159], v[184:187], v[200:203], 0
    v_mfma_f32_16x16x32_bf16 v[156:159], v[188:191], v[204:207], v[156:159]
    v_xor_b32 v232, 65536, v232
    v_xor_b32 v233, 65536, v233
    v_xor_b32 v234, 65536, v234
    v_xor_b32 v235, 65536, v235
    v_xor_b32 v236, 65536, v236
    v_xor_b32 v237, 65536, v237
    v_xor_b32 v238, 65536, v238
    v_xor_b32 v239, 65536, v239
    v_xor_b32 v240, 65536, v240
    v_xor_b32 v241, 65536, v241
    v_xor_b32 v242, 65536, v242
    v_xor_b32 v243, 65536, v243
    s_barrier
    s_add_u32 s80, s82, 131072
    s_add_u32 s81, s83, 0
    s_add_u32 m0, s81, 0
    s_add_u32 s63, s80, 0
    buffer_load_dwordx4 v224, s[16:19], s63 offen nt lds
    s_add_u32 m0, s81, 1024
    s_add_u32 s63, s80, 8192
    buffer_load_dwordx4 v225, s[16:19], s63 offen nt lds
    s_add_u32 m0, s81, 2048
    s_add_u32 s63, s80, 16384
    buffer_load_dwordx4 v226, s[16:19], s63 offen nt lds
    s_add_u32 m0, s81, 3072
    s_add_u32 s63, s80, 24576
    buffer_load_dwordx4 v227, s[16:19], s63 offen nt lds
    s_add_u32 m0, s81, 4096
    s_add_u32 s63, s80, 32768
    buffer_load_dwordx4 v228, s[16:19], s63 offen nt lds
    s_add_u32 m0, s81, 5120
    s_add_u32 s63, s80, 40960
    buffer_load_dwordx4 v229, s[16:19], s63 offen nt lds
    s_add_u32 m0, s81, 6144
    s_add_u32 s63, s80, 49152
    buffer_load_dwordx4 v230, s[16:19], s63 offen nt lds
    s_add_u32 m0, s81, 7168
    s_add_u32 s63, s80, 57344
    buffer_load_dwordx4 v231, s[16:19], s63 offen nt lds
    s_waitcnt vmcnt(8)
    s_barrier
    ds_read_b128 v[160:163], v232 offset:0
    ds_read_b128 v[164:167], v233 offset:0
    ds_read_b128 v[168:171], v234 offset:0
    ds_read_b128 v[172:175], v235 offset:0
    ds_read_b128 v[176:179], v232 offset:256
    ds_read_b128 v[180:183], v233 offset:256
    ds_read_b128 v[184:187], v234 offset:256
    ds_read_b128 v[188:191], v235 offset:256
    ds_read_b128 v[192:195], v232 offset:512
    ds_read_b128 v[196:199], v233 offset:512
    ds_read_b128 v[200:203], v234 offset:512
    ds_read_b128 v[204:207], v235 offset:512
    ds_read_b128 v[208:211], v232 offset:768
    ds_read_b128 v[212:215], v233 offset:768
    ds_read_b128 v[216:219], v234 offset:768
    ds_read_b128 v[220:223], v235 offset:768
    s_waitcnt lgkmcnt(12)
    v_mfma_f32_16x16x32_bf16 v[16:19], v[160:163], v[64:67], 0
    v_mfma_f32_16x16x32_bf16 v[16:19], v[164:167], v[68:71], v[16:19]
    v_mfma_f32_16x16x32_bf16 v[16:19], v[168:171], v[72:75], v[16:19]
    v_mfma_f32_16x16x32_bf16 v[16:19], v[172:175], v[76:79], v[16:19]
    s_waitcnt lgkmcnt(8)
    v_mfma_f32_16x16x32_bf16 v[16:19], v[176:179], v[80:83], v[16:19]
    v_mfma_f32_16x16x32_bf16 v[16:19], v[180:183], v[84:87], v[16:19]
    v_mfma_f32_16x16x32_bf16 v[16:19], v[184:187], v[88:91], v[16:19]
    v_mfma_f32_16x16x32_bf16 v[16:19], v[188:191], v[92:95], v[16:19]
    s_waitcnt lgkmcnt(4)
    v_mfma_f32_16x16x32_bf16 v[16:19], v[192:195], v[96:99], v[16:19]
    v_mfma_f32_16x16x32_bf16 v[16:19], v[196:199], v[100:103], v[16:19]
    v_mfma_f32_16x16x32_bf16 v[16:19], v[200:203], v[104:107], v[16:19]
    v_mfma_f32_16x16x32_bf16 v[16:19], v[204:207], v[108:111], v[16:19]
    s_waitcnt lgkmcnt(0)
    v_mfma_f32_16x16x32_bf16 v[16:19], v[208:211], v[112:115], v[16:19]
    v_mfma_f32_16x16x32_bf16 v[16:19], v[212:215], v[116:119], v[16:19]
    v_mfma_f32_16x16x32_bf16 v[16:19], v[216:219], v[120:123], v[16:19]
    v_mfma_f32_16x16x32_bf16 v[16:19], v[220:223], v[124:127], v[16:19]
    s_nop 7
    v_max3_f32 v8, v16, v17, v18
    v_max_f32 v8, v8, v19
    v_mov_b32 v9, v8
    s_nop 1
    v_permlane16_swap_b32 v8, v9
    v_max_f32 v8, v8, v9
    v_mov_b32 v9, v8
    s_nop 1
    v_permlane32_swap_b32 v8, v9
    v_max_f32 v8, v8, v9
    ds_write_b32 v246, v8
    s_waitcnt lgkmcnt(0)
    s_barrier
    ds_read_b128 v[20:23], v247
    ds_read_b128 v[24:27], v247 offset:256
    s_waitcnt lgkmcnt(0)
    v_max3_f32 v8, v20, v21, v22
    v_max3_f32 v9, v24, v25, v26
    v_max_f32 v8, v8, v23
    v_max_f32 v9, v9, v27
    v_max_f32 v8, v8, v248
    v_max_f32 v9, v9, v249
    v_sub_f32 v10, v248, v8
    v_sub_f32 v11, v249, v9
    v_mul_f32 v10, s64, v10
    v_mul_f32 v11, s64, v11
    v_exp_f32 v10, v10
    v_exp_f32 v11, v11
    v_mov_b32 v248, v8
    v_mov_b32 v249, v9
    v_cndmask_b32 v12, v8, v9, s[76:77]
    v_mul_f32 v12, s64, v12
    v_fma_f32 v16, v16, s64, -v12
    v_fma_f32 v17, v17, s64, -v12
    v_fma_f32 v18, v18, s64, -v12
    v_fma_f32 v19, v19, s64, -v12
    v_exp_f32 v16, v16
    v_exp_f32 v17, v17
    v_exp_f32 v18, v18
    v_exp_f32 v19, v19
    v_cvt_pk_bf16_f32 v20, v16, v17
    v_cvt_pk_bf16_f32 v21, v18, v19
    ds_write_b64 v245, v[20:21]
    v_add_f32 v16, v16, v17
    v_add_f32 v18, v18, v19
    v_add_f32 v16, v16, v18
    v_cndmask_b32 v13, v10, v11, s[76:77]
    v_fma_f32 v250, v250, v13, v16
    v_mul_f32 v128, v128, v10
    v_mul_f32 v129, v129, v10
    v_mul_f32 v130, v130, v10
    v_mul_f32 v131, v131, v10
    v_mul_f32 v132, v132, v11
    v_mul_f32 v133, v133, v11
    v_mul_f32 v134, v134, v11
    v_mul_f32 v135, v135, v11
    v_mul_f32 v136, v136, v10
    v_mul_f32 v137, v137, v10
    v_mul_f32 v138, v138, v10
    v_mul_f32 v139, v139, v10
    v_mul_f32 v140, v140, v11
    v_mul_f32 v141, v141, v11
    v_mul_f32 v142, v142, v11
    v_mul_f32 v143, v143, v11
    v_mul_f32 v144, v144, v10
    v_mul_f32 v145, v145, v10
    v_mul_f32 v146, v146, v10
    v_mul_f32 v147, v147, v10
    v_mul_f32 v148, v148, v11
    v_mul_f32 v149, v149, v11
    v_mul_f32 v150, v150, v11
    v_mul_f32 v151, v151, v11
    v_mul_f32 v152, v152, v10
    v_mul_f32 v153, v153, v10
    v_mul_f32 v154, v154, v10
    v_mul_f32 v155, v155, v10
    v_mul_f32 v156, v156, v11
    v_mul_f32 v157, v157, v11
    v_mul_f32 v158, v158, v11
    v_mul_f32 v159, v159, v11
    s_waitcnt lgkmcnt(0)
    s_barrier
    ds_read_b128 v[192:195], v244 offset:0
    ds_read_b128 v[196:199], v244 offset:64
    ds_read_b128 v[200:203], v244 offset:2304
    ds_read_b128 v[204:207], v244 offset:2368
    ds_read_b64_tr_b16 v[160:161], v236 offset:0
    ds_read_b64_tr_b16 v[162:163], v237 offset:0
    ds_read_b64_tr_b16 v[164:165], v236 offset:32768
    ds_read_b64_tr_b16 v[166:167], v237 offset:32768
    ds_read_b64_tr_b16 v[168:169], v238 offset:0
    ds_read_b64_tr_b16 v[170:171], v239 offset:0
    ds_read_b64_tr_b16 v[172:173], v238 offset:32768
    ds_read_b64_tr_b16 v[174:175], v239 offset:32768
    ds_read_b64_tr_b16 v[176:177], v240 offset:0
    ds_read_b64_tr_b16 v[178:179], v241 offset:0
    ds_read_b64_tr_b16 v[180:181], v240 offset:32768
    ds_read_b64_tr_b16 v[182:183], v241 offset:32768
    ds_read_b64_tr_b16 v[184:185], v242 offset:0
    ds_read_b64_tr_b16 v[186:187], v243 offset:0
    ds_read_b64_tr_b16 v[188:189], v242 offset:32768
    ds_read_b64_tr_b16 v[190:191], v243 offset:32768
    s_waitcnt lgkmcnt(12)
    v_mfma_f32_16x16x32_bf16 v[128:131], v[160:163], v[192:195], v[128:131]
    v_mfma_f32_16x16x32_bf16 v[128:131], v[164:167], v[196:199], v[128:131]
    v_mfma_f32_16x16x32_bf16 v[132:135], v[160:163], v[200:203], v[132:135]
    v_mfma_f32_16x16x32_bf16 v[132:135], v[164:167], v[204:207], v[132:135]
    s_waitcnt lgkmcnt(8)
    v_mfma_f32_16x16x32_bf16 v[136:139], v[168:171], v[192:195], v[136:139]
    v_mfma_f32_16x16x32_bf16 v[136:139], v[172:175], v[196:199], v[136:139]
    v_mfma_f32_16x16x32_bf16 v[140:143], v[168:171], v[200:203], v[140:143]
    v_mfma_f32_16x16x32_bf16 v[140:143], v[172:175], v[204:207], v[140:143]
    s_waitcnt lgkmcnt(4)
    v_mfma_f32_16x16x32_bf16 v[144:147], v[176:179], v[192:195], v[144:147]
    v_mfma_f32_16x16x32_bf16 v[144:147], v[180:183], v[196:199], v[144:147]
    v_mfma_f32_16x16x32_bf16 v[148:151], v[176:179], v[200:203], v[148:151]
    v_mfma_f32_16x16x32_bf16 v[148:151], v[180:183], v[204:207], v[148:151]
    s_waitcnt lgkmcnt(0)
    v_mfma_f32_16x16x32_bf16 v[152:155], v[184:187], v[192:195], v[152:155]
    v_mfma_f32_16x16x32_bf16 v[152:155], v[188:191], v[196:199], v[152:155]
    v_mfma_f32_16x16x32_bf16 v[156:159], v[184:187], v[200:203], v[156:159]
    v_mfma_f32_16x16x32_bf16 v[156:159], v[188:191], v[204:207], v[156:159]
    v_xor_b32 v232, 65536, v232
    v_xor_b32 v233, 65536, v233
    v_xor_b32 v234, 65536, v234
    v_xor_b32 v235, 65536, v235
    v_xor_b32 v236, 65536, v236
    v_xor_b32 v237, 65536, v237
    v_xor_b32 v238, 65536, v238
    v_xor_b32 v239, 65536, v239
    v_xor_b32 v240, 65536, v240
    v_xor_b32 v241, 65536, v241
    v_xor_b32 v242, 65536, v242
    v_xor_b32 v243, 65536, v243
    s_barrier
    s_add_u32 s80, s82, 196608
    s_add_u32 s81, s83, 65536
    s_add_u32 m0, s81, 0
    s_add_u32 s63, s80, 0
    buffer_load_dwordx4 v224, s[16:19], s63 offen nt lds
    s_add_u32 m0, s81, 1024
    s_add_u32 s63, s80, 8192
    buffer_load_dwordx4 v225, s[16:19], s63 offen nt lds
    s_add_u32 m0, s81, 2048
    s_add_u32 s63, s80, 16384
    buffer_load_dwordx4 v226, s[16:19], s63 offen nt lds
    s_add_u32 m0, s81, 3072
    s_add_u32 s63, s80, 24576
    buffer_load_dwordx4 v227, s[16:19], s63 offen nt lds
    s_add_u32 m0, s81, 4096
    s_add_u32 s63, s80, 32768
    buffer_load_dwordx4 v228, s[16:19], s63 offen nt lds
    s_add_u32 m0, s81, 5120
    s_add_u32 s63, s80, 40960
    buffer_load_dwordx4 v229, s[16:19], s63 offen nt lds
    s_add_u32 m0, s81, 6144
    s_add_u32 s63, s80, 49152
    buffer_load_dwordx4 v230, s[16:19], s63 offen nt lds
    s_add_u32 m0, s81, 7168
    s_add_u32 s63, s80, 57344
    buffer_load_dwordx4 v231, s[16:19], s63 offen nt lds
    s_waitcnt vmcnt(8)
    s_barrier
    ds_read_b128 v[160:163], v232 offset:0
    ds_read_b128 v[164:167], v233 offset:0
    ds_read_b128 v[168:171], v234 offset:0
    ds_read_b128 v[172:175], v235 offset:0
    ds_read_b128 v[176:179], v232 offset:256
    ds_read_b128 v[180:183], v233 offset:256
    ds_read_b128 v[184:187], v234 offset:256
    ds_read_b128 v[188:191], v235 offset:256
    ds_read_b128 v[192:195], v232 offset:512
    ds_read_b128 v[196:199], v233 offset:512
    ds_read_b128 v[200:203], v234 offset:512
    ds_read_b128 v[204:207], v235 offset:512
    ds_read_b128 v[208:211], v232 offset:768
    ds_read_b128 v[212:215], v233 offset:768
    ds_read_b128 v[216:219], v234 offset:768
    ds_read_b128 v[220:223], v235 offset:768
    s_waitcnt lgkmcnt(12)
    v_mfma_f32_16x16x32_bf16 v[16:19], v[160:163], v[64:67], 0
    v_mfma_f32_16x16x32_bf16 v[16:19], v[164:167], v[68:71], v[16:19]
    v_mfma_f32_16x16x32_bf16 v[16:19], v[168:171], v[72:75], v[16:19]
    v_mfma_f32_16x16x32_bf16 v[16:19], v[172:175], v[76:79], v[16:19]
    s_waitcnt lgkmcnt(8)
    v_mfma_f32_16x16x32_bf16 v[16:19], v[176:179], v[80:83], v[16:19]
    v_mfma_f32_16x16x32_bf16 v[16:19], v[180:183], v[84:87], v[16:19]
    v_mfma_f32_16x16x32_bf16 v[16:19], v[184:187], v[88:91], v[16:19]
    v_mfma_f32_16x16x32_bf16 v[16:19], v[188:191], v[92:95], v[16:19]
    s_waitcnt lgkmcnt(4)
    v_mfma_f32_16x16x32_bf16 v[16:19], v[192:195], v[96:99], v[16:19]
    v_mfma_f32_16x16x32_bf16 v[16:19], v[196:199], v[100:103], v[16:19]
    v_mfma_f32_16x16x32_bf16 v[16:19], v[200:203], v[104:107], v[16:19]
    v_mfma_f32_16x16x32_bf16 v[16:19], v[204:207], v[108:111], v[16:19]
    s_waitcnt lgkmcnt(0)
    v_mfma_f32_16x16x32_bf16 v[16:19], v[208:211], v[112:115], v[16:19]
    v_mfma_f32_16x16x32_bf16 v[16:19], v[212:215], v[116:119], v[16:19]
    v_mfma_f32_16x16x32_bf16 v[16:19], v[216:219], v[120:123], v[16:19]
    v_mfma_f32_16x16x32_bf16 v[16:19], v[220:223], v[124:127], v[16:19]
    s_nop 7
    v_max3_f32 v8, v16, v17, v18
    v_max_f32 v8, v8, v19
    v_mov_b32 v9, v8
    s_nop 1
    v_permlane16_swap_b32 v8, v9
    v_max_f32 v8, v8, v9
    v_mov_b32 v9, v8
    s_nop 1
    v_permlane32_swap_b32 v8, v9
    v_max_f32 v8, v8, v9
    ds_write_b32 v246, v8
    s_waitcnt lgkmcnt(0)
    s_barrier
    ds_read_b128 v[20:23], v247
    ds_read_b128 v[24:27], v247 offset:256
    s_waitcnt lgkmcnt(0)
    v_max3_f32 v8, v20, v21, v22
    v_max3_f32 v9, v24, v25, v26
    v_max_f32 v8, v8, v23
    v_max_f32 v9, v9, v27
    v_max_f32 v8, v8, v248
    v_max_f32 v9, v9, v249
    v_sub_f32 v10, v248, v8
    v_sub_f32 v11, v249, v9
    v_mul_f32 v10, s64, v10
    v_mul_f32 v11, s64, v11
    v_exp_f32 v10, v10
    v_exp_f32 v11, v11
    v_mov_b32 v248, v8
    v_mov_b32 v249, v9
    v_cndmask_b32 v12, v8, v9, s[76:77]
    v_mul_f32 v12, s64, v12
    v_fma_f32 v16, v16, s64, -v12
    v_fma_f32 v17, v17, s64, -v12
    v_fma_f32 v18, v18, s64, -v12
    v_fma_f32 v19, v19, s64, -v12
    v_exp_f32 v16, v16
    v_exp_f32 v17, v17
    v_exp_f32 v18, v18
    v_exp_f32 v19, v19
    v_cvt_pk_bf16_f32 v20, v16, v17
    v_cvt_pk_bf16_f32 v21, v18, v19
    ds_write_b64 v245, v[20:21]
    v_add_f32 v16, v16, v17
    v_add_f32 v18, v18, v19
    v_add_f32 v16, v16, v18
    v_cndmask_b32 v13, v10, v11, s[76:77]
    v_fma_f32 v250, v250, v13, v16
    v_mul_f32 v128, v128, v10
    v_mul_f32 v129, v129, v10
    v_mul_f32 v130, v130, v10
    v_mul_f32 v131, v131, v10
    v_mul_f32 v132, v132, v11
    v_mul_f32 v133, v133, v11
    v_mul_f32 v134, v134, v11
    v_mul_f32 v135, v135, v11
    v_mul_f32 v136, v136, v10
    v_mul_f32 v137, v137, v10
    v_mul_f32 v138, v138, v10
    v_mul_f32 v139, v139, v10
    v_mul_f32 v140, v140, v11
    v_mul_f32 v141, v141, v11
    v_mul_f32 v142, v142, v11
    v_mul_f32 v143, v143, v11
    v_mul_f32 v144, v144, v10
    v_mul_f32 v145, v145, v10
    v_mul_f32 v146, v146, v10
    v_mul_f32 v147, v147, v10
    v_mul_f32 v148, v148, v11
    v_mul_f32 v149, v149, v11
    v_mul_f32 v150, v150, v11
    v_mul_f32 v151, v151, v11
    v_mul_f32 v152, v152, v10
    v_mul_f32 v153, v153, v10
    v_mul_f32 v154, v154, v10
    v_mul_f32 v155, v155, v10
    v_mul_f32 v156, v156, v11
    v_mul_f32 v157, v157, v11
    v_mul_f32 v158, v158, v11
    v_mul_f32 v159, v159, v11
    s_waitcnt lgkmcnt(0)
    s_barrier
    ds_read_b128 v[192:195], v244 offset:0
    ds_read_b128 v[196:199], v244 offset:64
    ds_read_b128 v[200:203], v244 offset:2304
    ds_read_b128 v[204:207], v244 offset:2368
    ds_read_b64_tr_b16 v[160:161], v236 offset:0
    ds_read_b64_tr_b16 v[162:163], v237 offset:0
    ds_read_b64_tr_b16 v[164:165], v236 offset:32768
    ds_read_b64_tr_b16 v[166:167], v237 offset:32768
    ds_read_b64_tr_b16 v[168:169], v238 offset:0
    ds_read_b64_tr_b16 v[170:171], v239 offset:0
    ds_read_b64_tr_b16 v[172:173], v238 offset:32768
    ds_read_b64_tr_b16 v[174:175], v239 offset:32768
    ds_read_b64_tr_b16 v[176:177], v240 offset:0
    ds_read_b64_tr_b16 v[178:179], v241 offset:0
    ds_read_b64_tr_b16 v[180:181], v240 offset:32768
    ds_read_b64_tr_b16 v[182:183], v241 offset:32768
    ds_read_b64_tr_b16 v[184:185], v242 offset:0
    ds_read_b64_tr_b16 v[186:187], v243 offset:0
    ds_read_b64_tr_b16 v[188:189], v242 offset:32768
    ds_read_b64_tr_b16 v[190:191], v243 offset:32768
    s_waitcnt lgkmcnt(12)
    v_mfma_f32_16x16x32_bf16 v[128:131], v[160:163], v[192:195], v[128:131]
    v_mfma_f32_16x16x32_bf16 v[128:131], v[164:167], v[196:199], v[128:131]
    v_mfma_f32_16x16x32_bf16 v[132:135], v[160:163], v[200:203], v[132:135]
    v_mfma_f32_16x16x32_bf16 v[132:135], v[164:167], v[204:207], v[132:135]
    s_waitcnt lgkmcnt(8)
    v_mfma_f32_16x16x32_bf16 v[136:139], v[168:171], v[192:195], v[136:139]
    v_mfma_f32_16x16x32_bf16 v[136:139], v[172:175], v[196:199], v[136:139]
    v_mfma_f32_16x16x32_bf16 v[140:143], v[168:171], v[200:203], v[140:143]
    v_mfma_f32_16x16x32_bf16 v[140:143], v[172:175], v[204:207], v[140:143]
    s_waitcnt lgkmcnt(4)
    v_mfma_f32_16x16x32_bf16 v[144:147], v[176:179], v[192:195], v[144:147]
    v_mfma_f32_16x16x32_bf16 v[144:147], v[180:183], v[196:199], v[144:147]
    v_mfma_f32_16x16x32_bf16 v[148:151], v[176:179], v[200:203], v[148:151]
    v_mfma_f32_16x16x32_bf16 v[148:151], v[180:183], v[204:207], v[148:151]
    s_waitcnt lgkmcnt(0)
    v_mfma_f32_16x16x32_bf16 v[152:155], v[184:187], v[192:195], v[152:155]
    v_mfma_f32_16x16x32_bf16 v[152:155], v[188:191], v[196:199], v[152:155]
    v_mfma_f32_16x16x32_bf16 v[156:159], v[184:187], v[200:203], v[156:159]
    v_mfma_f32_16x16x32_bf16 v[156:159], v[188:191], v[204:207], v[156:159]
    v_xor_b32 v232, 65536, v232
    v_xor_b32 v233, 65536, v233
    v_xor_b32 v234, 65536, v234
    v_xor_b32 v235, 65536, v235
    v_xor_b32 v236, 65536, v236
    v_xor_b32 v237, 65536, v237
    v_xor_b32 v238, 65536, v238
    v_xor_b32 v239, 65536, v239
    v_xor_b32 v240, 65536, v240
    v_xor_b32 v241, 65536, v241
    v_xor_b32 v242, 65536, v242
    v_xor_b32 v243, 65536, v243
    s_waitcnt vmcnt(0)
    s_barrier
    ds_read_b128 v[160:163], v232 offset:0
    ds_read_b128 v[164:167], v233 offset:0
    ds_read_b128 v[168:171], v234 offset:0
    ds_read_b128 v[172:175], v235 offset:0
    ds_read_b128 v[176:179], v232 offset:256
    ds_read_b128 v[180:183], v233 offset:256
    ds_read_b128 v[184:187], v234 offset:256
    ds_read_b128 v[188:191], v235 offset:256
    ds_read_b128 v[192:195], v232 offset:512
    ds_read_b128 v[196:199], v233 offset:512
    ds_read_b128 v[200:203], v234 offset:512
    ds_read_b128 v[204:207], v235 offset:512
    ds_read_b128 v[208:211], v232 offset:768
    ds_read_b128 v[212:215], v233 offset:768
    ds_read_b128 v[216:219], v234 offset:768
    ds_read_b128 v[220:223], v235 offset:768
    s_waitcnt lgkmcnt(12)
    v_mfma_f32_16x16x32_bf16 v[16:19], v[160:163], v[64:67], 0
    v_mfma_f32_16x16x32_bf16 v[16:19], v[164:167], v[68:71], v[16:19]
    v_mfma_f32_16x16x32_bf16 v[16:19], v[168:171], v[72:75], v[16:19]
    v_mfma_f32_16x16x32_bf16 v[16:19], v[172:175], v[76:79], v[16:19]
    s_waitcnt lgkmcnt(8)
    v_mfma_f32_16x16x32_bf16 v[16:19], v[176:179], v[80:83], v[16:19]
    v_mfma_f32_16x16x32_bf16 v[16:19], v[180:183], v[84:87], v[16:19]
    v_mfma_f32_16x16x32_bf16 v[16:19], v[184:187], v[88:91], v[16:19]
    v_mfma_f32_16x16x32_bf16 v[16:19], v[188:191], v[92:95], v[16:19]
    s_waitcnt lgkmcnt(4)
    v_mfma_f32_16x16x32_bf16 v[16:19], v[192:195], v[96:99], v[16:19]
    v_mfma_f32_16x16x32_bf16 v[16:19], v[196:199], v[100:103], v[16:19]
    v_mfma_f32_16x16x32_bf16 v[16:19], v[200:203], v[104:107], v[16:19]
    v_mfma_f32_16x16x32_bf16 v[16:19], v[204:207], v[108:111], v[16:19]
    s_waitcnt lgkmcnt(0)
    v_mfma_f32_16x16x32_bf16 v[16:19], v[208:211], v[112:115], v[16:19]
    v_mfma_f32_16x16x32_bf16 v[16:19], v[212:215], v[116:119], v[16:19]
    v_mfma_f32_16x16x32_bf16 v[16:19], v[216:219], v[120:123], v[16:19]
    v_mfma_f32_16x16x32_bf16 v[16:19], v[220:223], v[124:127], v[16:19]
    s_nop 7
    v_max3_f32 v8, v16, v17, v18
    v_max_f32 v8, v8, v19
    v_mov_b32 v9, v8
    s_nop 1
    v_permlane16_swap_b32 v8, v9
    v_max_f32 v8, v8, v9
    v_mov_b32 v9, v8
    s_nop 1
    v_permlane32_swap_b32 v8, v9
    v_max_f32 v8, v8, v9
    ds_write_b32 v246, v8
    s_waitcnt lgkmcnt(0)
    s_barrier
    ds_read_b128 v[20:23], v247
    ds_read_b128 v[24:27], v247 offset:256
    s_waitcnt lgkmcnt(0)
    v_max3_f32 v8, v20, v21, v22
    v_max3_f32 v9, v24, v25, v26
    v_max_f32 v8, v8, v23
    v_max_f32 v9, v9, v27
    v_max_f32 v8, v8, v248
    v_max_f32 v9, v9, v249
    v_sub_f32 v10, v248, v8
    v_sub_f32 v11, v249, v9
    v_mul_f32 v10, s64, v10
    v_mul_f32 v11, s64, v11
    v_exp_f32 v10, v10
    v_exp_f32 v11, v11
    v_mov_b32 v248, v8
    v_mov_b32 v249, v9
    v_cndmask_b32 v12, v8, v9, s[76:77]
    v_mul_f32 v12, s64, v12
    v_fma_f32 v16, v16, s64, -v12
    v_fma_f32 v17, v17, s64, -v12
    v_fma_f32 v18, v18, s64, -v12
    v_fma_f32 v19, v19, s64, -v12
    v_exp_f32 v16, v16
    v_exp_f32 v17, v17
    v_exp_f32 v18, v18
    v_exp_f32 v19, v19
    v_cvt_pk_bf16_f32 v20, v16, v17
    v_cvt_pk_bf16_f32 v21, v18, v19
    ds_write_b64 v245, v[20:21]
    v_add_f32 v16, v16, v17
    v_add_f32 v18, v18, v19
    v_add_f32 v16, v16, v18
    v_cndmask_b32 v13, v10, v11, s[76:77]
    v_fma_f32 v250, v250, v13, v16
    v_mul_f32 v128, v128, v10
    v_mul_f32 v129, v129, v10
    v_mul_f32 v130, v130, v10
    v_mul_f32 v131, v131, v10
    v_mul_f32 v132, v132, v11
    v_mul_f32 v133, v133, v11
    v_mul_f32 v134, v134, v11
    v_mul_f32 v135, v135, v11
    v_mul_f32 v136, v136, v10
    v_mul_f32 v137, v137, v10
    v_mul_f32 v138, v138, v10
    v_mul_f32 v139, v139, v10
    v_mul_f32 v140, v140, v11
    v_mul_f32 v141, v141, v11
    v_mul_f32 v142, v142, v11
    v_mul_f32 v143, v143, v11
    v_mul_f32 v144, v144, v10
    v_mul_f32 v145, v145, v10
    v_mul_f32 v146, v146, v10
    v_mul_f32 v147, v147, v10
    v_mul_f32 v148, v148, v11
    v_mul_f32 v149, v149, v11
    v_mul_f32 v150, v150, v11
    v_mul_f32 v151, v151, v11
    v_mul_f32 v152, v152, v10
    v_mul_f32 v153, v153, v10
    v_mul_f32 v154, v154, v10
    v_mul_f32 v155, v155, v10
    v_mul_f32 v156, v156, v11
    v_mul_f32 v157, v157, v11
    v_mul_f32 v158, v158, v11
    v_mul_f32 v159, v159, v11
    s_waitcnt lgkmcnt(0)
    s_barrier
    ds_read_b128 v[192:195], v244 offset:0
    ds_read_b128 v[196:199], v244 offset:64
    ds_read_b128 v[200:203], v244 offset:2304
    ds_read_b128 v[204:207], v244 offset:2368
    ds_read_b64_tr_b16 v[160:161], v236 offset:0
    ds_read_b64_tr_b16 v[162:163], v237 offset:0
    ds_read_b64_tr_b16 v[164:165], v236 offset:32768
    ds_read_b64_tr_b16 v[166:167], v237 offset:32768
    ds_read_b64_tr_b16 v[168:169], v238 offset:0
    ds_read_b64_tr_b16 v[170:171], v239 offset:0
    ds_read_b64_tr_b16 v[172:173], v238 offset:32768
    ds_read_b64_tr_b16 v[174:175], v239 offset:32768
    ds_read_b64_tr_b16 v[176:177], v240 offset:0
    ds_read_b64_tr_b16 v[178:179], v241 offset:0
    ds_read_b64_tr_b16 v[180:181], v240 offset:32768
    ds_read_b64_tr_b16 v[182:183], v241 offset:32768
    ds_read_b64_tr_b16 v[184:185], v242 offset:0
    ds_read_b64_tr_b16 v[186:187], v243 offset:0
    ds_read_b64_tr_b16 v[188:189], v242 offset:32768
    ds_read_b64_tr_b16 v[190:191], v243 offset:32768
    s_waitcnt lgkmcnt(12)
    v_mfma_f32_16x16x32_bf16 v[128:131], v[160:163], v[192:195], v[128:131]
    v_mfma_f32_16x16x32_bf16 v[128:131], v[164:167], v[196:199], v[128:131]
    v_mfma_f32_16x16x32_bf16 v[132:135], v[160:163], v[200:203], v[132:135]
    v_mfma_f32_16x16x32_bf16 v[132:135], v[164:167], v[204:207], v[132:135]
    s_waitcnt lgkmcnt(8)
    v_mfma_f32_16x16x32_bf16 v[136:139], v[168:171], v[192:195], v[136:139]
    v_mfma_f32_16x16x32_bf16 v[136:139], v[172:175], v[196:199], v[136:139]
    v_mfma_f32_16x16x32_bf16 v[140:143], v[168:171], v[200:203], v[140:143]
    v_mfma_f32_16x16x32_bf16 v[140:143], v[172:175], v[204:207], v[140:143]
    s_waitcnt lgkmcnt(4)
    v_mfma_f32_16x16x32_bf16 v[144:147], v[176:179], v[192:195], v[144:147]
    v_mfma_f32_16x16x32_bf16 v[144:147], v[180:183], v[196:199], v[144:147]
    v_mfma_f32_16x16x32_bf16 v[148:151], v[176:179], v[200:203], v[148:151]
    v_mfma_f32_16x16x32_bf16 v[148:151], v[180:183], v[204:207], v[148:151]
    s_waitcnt lgkmcnt(0)
    v_mfma_f32_16x16x32_bf16 v[152:155], v[184:187], v[192:195], v[152:155]
    v_mfma_f32_16x16x32_bf16 v[152:155], v[188:191], v[196:199], v[152:155]
    v_mfma_f32_16x16x32_bf16 v[156:159], v[184:187], v[200:203], v[156:159]
    v_mfma_f32_16x16x32_bf16 v[156:159], v[188:191], v[204:207], v[156:159]
    v_mov_b32 v8, v250
    s_nop 1
    v_permlane16_swap_b32 v250, v8
    v_add_f32 v250, v250, v8
    v_mov_b32 v8, v250
    s_nop 1
    v_permlane32_swap_b32 v250, v8
    v_add_f32 v250, v250, v8
    v_add_u32 v8, 512, v246
    ds_write_b32 v8, v250
    v_and_b32 v9, 7, v2
    v_lshlrev_b32 v9, 10, v9
    v_lshlrev_b32 v10, 5, v3
    v_lshrrev_b32 v11, 3, v2
    v_lshlrev_b32 v11, 4, v11
    v_add3_u32 v9, v9, v10, v11
    s_lshl_b32 s60, s59, 15
    s_lshl_b32 s61, s53, 7
    s_add_u32 s60, s60, s61
    s_add_u32 s60, s60, 2097152
    v_add_u32 v9, s60, v9
    v_cvt_pk_bf16_f32 v16, v128, v129
    v_cvt_pk_bf16_f32 v17, v130, v131
    v_cvt_pk_bf16_f32 v18, v136, v137
    v_cvt_pk_bf16_f32 v19, v138, v139
    v_cvt_pk_bf16_f32 v20, v144, v145
    v_cvt_pk_bf16_f32 v21, v146, v147
    v_cvt_pk_bf16_f32 v22, v152, v153
    v_cvt_pk_bf16_f32 v23, v154, v155
    v_mov_b32 v24, v16
    v_mov_b32 v25, v17
    v_mov_b32 v26, v18
    v_mov_b32 v27, v19
    v_mov_b32_dpp v16, v20 row_ror:8 row_mask:0xf bank_mask:0xc
    v_mov_b32_dpp v17, v21 row_ror:8 row_mask:0xf bank_mask:0xc
    v_mov_b32_dpp v18, v22 row_ror:8 row_mask:0xf bank_mask:0xc
    v_mov_b32_dpp v19, v23 row_ror:8 row_mask:0xf bank_mask:0xc
    v_mov_b32_dpp v20, v24 row_ror:8 row_mask:0xf bank_mask:0x3
    v_mov_b32_dpp v21, v25 row_ror:8 row_mask:0xf bank_mask:0x3
    v_mov_b32_dpp v22, v26 row_ror:8 row_mask:0xf bank_mask:0x3
    v_mov_b32_dpp v23, v27 row_ror:8 row_mask:0xf bank_mask:0x3
    s_mov_b32 s63, 0
    buffer_store_dwordx4 v[16:19], v9, s[12:15], s63 offen sc0 sc1
    s_mov_b32 s63, 8192
    buffer_store_dwordx4 v[20:23], v9, s[12:15], s63 offen sc0 sc1
    v_cvt_pk_bf16_f32 v28, v132, v133
    v_cvt_pk_bf16_f32 v29, v134, v135
    v_cvt_pk_bf16_f32 v30, v140, v141
    v_cvt_pk_bf16_f32 v31, v142, v143
    v_cvt_pk_bf16_f32 v32, v148, v149
    v_cvt_pk_bf16_f32 v33, v150, v151
    v_cvt_pk_bf16_f32 v34, v156, v157
    v_cvt_pk_bf16_f32 v35, v158, v159
    v_mov_b32 v36, v28
    v_mov_b32 v37, v29
    v_mov_b32 v38, v30
    v_mov_b32 v39, v31
    v_mov_b32_dpp v28, v32 row_ror:8 row_mask:0xf bank_mask:0xc
    v_mov_b32_dpp v29, v33 row_ror:8 row_mask:0xf bank_mask:0xc
    v_mov_b32_dpp v30, v34 row_ror:8 row_mask:0xf bank_mask:0xc
    v_mov_b32_dpp v31, v35 row_ror:8 row_mask:0xf bank_mask:0xc
    v_mov_b32_dpp v32, v36 row_ror:8 row_mask:0xf bank_mask:0x3
    v_mov_b32_dpp v33, v37 row_ror:8 row_mask:0xf bank_mask:0x3
    v_mov_b32_dpp v34, v38 row_ror:8 row_mask:0xf bank_mask:0x3
    v_mov_b32_dpp v35, v39 row_ror:8 row_mask:0xf bank_mask:0x3
    s_mov_b32 s63, 16384
    buffer_store_dwordx4 v[28:31], v9, s[12:15], s63 offen sc0 sc1
    s_mov_b32 s63, 24576
    buffer_store_dwordx4 v[32:35], v9, s[12:15], s63 offen sc0 sc1
    s_waitcnt lgkmcnt(0)
    s_barrier
    s_cmp_eq_u32 s53, 0
    s_cbranch_scc0 L_aml_42
    v_and_b32 v10, 31, v1
    v_lshlrev_b32 v11, 4, v10
    v_add_u32 v11, 136192, v11
    ds_read_b128 v[12:15], v11
    v_and_b32 v11, 1, v3
    v_cmp_eq_u32 vcc, 1, v11
    s_nop 1
    v_cndmask_b32 v32, v248, v249, vcc
    s_waitcnt lgkmcnt(0)
    v_add_f32 v12, v12, v13
    v_add_f32 v14, v14, v15
    v_add_f32 v33, v12, v14
    v_lshlrev_b32 v10, 9, v10
    s_lshl_b32 s60, s59, 3
    s_add_u32 s60, s60, 102400
    v_add_u32 v10, s60, v10
    s_mov_b32 exec_lo, 0xffffffff
    s_mov_b32 exec_hi, 0x0
    buffer_store_dwordx2 v[32:33], v10, s[12:15], 0 offen sc0 sc1
    s_mov_b64 exec, -1
L_aml_42:
    s_waitcnt vmcnt(0)
    s_barrier
    s_cmp_eq_u32 s53, 0
    s_cbranch_scc0 L_aof_43
    v_lshlrev_b32 v8, 8, v1
    s_lshl_b32 s60, s59, 2
    s_add_u32 s60, s60, 1179648
    v_add_u32 v8, s60, v8
    v_mov_b32 v9, s52
    s_mov_b32 exec_lo, 0xffffffff
    s_mov_b32 exec_hi, 0x0
    buffer_store_dword v9, v8, s[12:15], 0 offen sc0 sc1
    s_mov_b64 exec, -1
L_aof_43:
    s_cmp_ge_u32 s59, 36
    s_cbranch_scc1 L_end
    s_cmp_eq_u32 s53, 0
    s_cbranch_scc0 L_end
    v_lshlrev_b32 v8, 4, v1
    buffer_load_dwordx4 v[16:19], v8, s[4:7], 0 offen
    buffer_load_dwordx4 v[20:23], v8, s[4:7], 0 offen offset:1024
    buffer_load_dwordx4 v[24:27], v8, s[32:35], 0 offen
    buffer_load_dwordx4 v[28:31], v8, s[32:35], 0 offen offset:1024
    s_waitcnt vmcnt(0)
    v_dot2_f32_bf16 v10, v16, v24, 0
    v_dot2_f32_bf16 v11, v20, v28, 0
    v_dot2_f32_bf16 v10, v17, v25, v10
    v_dot2_f32_bf16 v11, v21, v29, v11
    v_dot2_f32_bf16 v10, v18, v26, v10
    v_dot2_f32_bf16 v11, v22, v30, v11
    v_dot2_f32_bf16 v10, v19, v27, v10
    v_dot2_f32_bf16 v11, v23, v31, v11
    s_nop 2
    v_add_f32 v10, v10, v11
    s_nop 1
    v_add_f32_dpp v10, v10, v10 quad_perm:[1,0,3,2] row_mask:0xf bank_mask:0xf
    s_nop 1
    v_add_f32_dpp v10, v10, v10 quad_perm:[2,3,0,1] row_mask:0xf bank_mask:0xf
    s_nop 1
    v_add_f32_dpp v10, v10, v10 row_ror:4 row_mask:0xf bank_mask:0xf
    s_nop 1
    v_add_f32_dpp v10, v10, v10 row_ror:8 row_mask:0xf bank_mask:0xf
    v_mov_b32 v11, v10
    s_nop 1
    v_permlane16_swap_b32 v10, v11
    v_add_f32 v10, v10, v11
    v_mov_b32 v11, v10
    s_nop 1
    v_permlane32_swap_b32 v10, v11
    v_add_f32 v10, v10, v11
    v_mul_f32 v10, 0xbfb8aa3b, v10
    v_exp_f32 v10, v10
    s_nop 0
    v_add_f32 v10, 1.0, v10
    v_rcp_f32 v10, v10
    s_nop 0
    v_sub_f32 v11, 1.0, v10
    s_mul_i32 s60, s59, 6144
    s_add_u32 s60, s60, 524288
    v_add_u32 v8, s60, v8
    s_mov_b32 s62, 3000
L_poll_44:
    s_mov_b32 s63, 0
    buffer_load_dwordx4 v[64:67], v8, s[12:15], s63 offen sc1
    s_waitcnt vmcnt(0)
    v_xor_b32 v12, s52, v65
    v_xor_b32 v13, s52, v67
    v_or_b32 v12, v12, v13
    v_cmp_eq_u32 vcc, 0, v12
    s_cmp_eq_u64 vcc, -1
    s_cbranch_scc1 L_pdone_45
    s_sub_u32 s62, s62, 1
    s_cmp_eq_u32 s62, 0
    s_cbranch_scc0 L_poll_44
L_pdone_45:
    v_mul_f32 v14, v64, v10
    v_mul_f32 v15, v66, v10
    s_mov_b32 s62, 3000
L_poll_46:
    s_mov_b32 s63, 1024
    buffer_load_dwordx4 v[68:71], v8, s[12:15], s63 offen sc1
    s_mov_b32 s63, 2048
    buffer_load_dwordx4 v[72:75], v8, s[12:15], s63 offen sc1
    s_mov_b32 s63, 3072
    buffer_load_dwordx4 v[76:79], v8, s[12:15], s63 offen sc1
    s_waitcnt vmcnt(0)
    v_xor_b32 v12, s52, v69
    v_xor_b32 v13, s52, v71
    v_or_b32 v12, v12, v13
    v_xor_b32 v13, s52, v73
    v_or_b32 v12, v12, v13
    v_xor_b32 v13, s52, v75
    v_or_b32 v12, v12, v13
    v_xor_b32 v13, s52, v77
    v_or_b32 v12, v12, v13
    v_xor_b32 v13, s52, v79
    v_or_b32 v12, v12, v13
    v_cmp_eq_u32 vcc, 0, v12
    s_cmp_eq_u64 vcc, -1
    s_cbranch_scc1 L_pdone_47
    s_sub_u32 s62, s62, 1
    s_cmp_eq_u32 s62, 0
    s_cbranch_scc0 L_poll_46
L_pdone_47:
    v_fma_f32 v14, v68, v10, v14
    v_fma_f32 v15, v70, v10, v15
    v_fma_f32 v14, v72, v10, v14
    v_fma_f32 v15, v74, v10, v15
    v_fma_f32 v14, v76, v10, v14
    v_fma_f32 v15, v78, v10, v15
    s_mov_b32 s62, 3000
L_fp1_48:
    s_mov_b32 s63, 4096
    buffer_load_dwordx4 v[80:83], v8, s[12:15], s63 offen sc1
    s_mov_b32 s63, 5120
    buffer_load_dwordx4 v[84:87], v8, s[12:15], s63 offen sc1
    s_waitcnt vmcnt(0)
    v_xor_b32 v12, s52, v81
    v_xor_b32 v13, s52, v83
    v_or_b32 v12, v12, v13
    v_xor_b32 v13, s52, v85
    v_or_b32 v12, v12, v13
    v_xor_b32 v13, s52, v87
    v_or_b32 v12, v12, v13
    v_cmp_eq_u32 vcc, 0, v12
    s_cmp_eq_u64 vcc, -1
    s_cbranch_scc1 L_fpc_51
    v_cmp_eq_u32 vcc, s52, v81
    v_cmp_eq_u32 s[76:77], s52, v85
    s_or_b64 vcc, vcc, s[76:77]
    s_cbranch_scc1 L_fpl_49_in
    s_sub_u32 s62, s62, 1
    s_cmp_eq_u32 s62, 0
    s_cbranch_scc0 L_fp1_48
    s_branch L_fpc_51
L_fpl_49_in:
    s_mov_b32 s63, 4096
    buffer_load_dwordx4 v[96:99], v8, s[12:15], s63 offen sc1
    s_mov_b32 s63, 5120
    buffer_load_dwordx4 v[100:103], v8, s[12:15], s63 offen sc1
    s_mov_b32 s63, 4096
    buffer_load_dwordx4 v[104:107], v8, s[12:15], s63 offen sc1
    s_mov_b32 s63, 5120
    buffer_load_dwordx4 v[108:111], v8, s[12:15], s63 offen sc1
    s_mov_b32 s63, 4096
    buffer_load_dwordx4 v[112:115], v8, s[12:15], s63 offen sc1
    s_mov_b32 s63, 5120
    buffer_load_dwordx4 v[116:119], v8, s[12:15], s63 offen sc1
    s_mov_b32 s63, 4096
    buffer_load_dwordx4 v[120:123], v8, s[12:15], s63 offen sc1
    s_mov_b32 s63, 5120
    buffer_load_dwordx4 v[124:127], v8, s[12:15], s63 offen sc1
    s_mov_b32 s62, 3000
L_fpl_49:
    s_waitcnt vmcnt(6)
    v_xor_b32 v12, s52, v97
    v_xor_b32 v13, s52, v99
    v_or_b32 v12, v12, v13
    v_xor_b32 v13, s52, v101
    v_or_b32 v12, v12, v13
    v_xor_b32 v13, s52, v103
    v_or_b32 v12, v12, v13
    v_cmp_eq_u32 vcc, 0, v12
    s_cmp_eq_u64 vcc, -1
    s_cbranch_scc1 L_fpd_50_0
    s_mov_b32 s63, 4096
    buffer_load_dwordx4 v[96:99], v8, s[12:15], s63 offen sc1
    s_mov_b32 s63, 5120
    buffer_load_dwordx4 v[100:103], v8, s[12:15], s63 offen sc1
    s_waitcnt vmcnt(6)
    v_xor_b32 v12, s52, v105
    v_xor_b32 v13, s52, v107
    v_or_b32 v12, v12, v13
    v_xor_b32 v13, s52, v109
    v_or_b32 v12, v12, v13
    v_xor_b32 v13, s52, v111
    v_or_b32 v12, v12, v13
    v_cmp_eq_u32 vcc, 0, v12
    s_cmp_eq_u64 vcc, -1
    s_cbranch_scc1 L_fpd_50_1
    s_mov_b32 s63, 4096
    buffer_load_dwordx4 v[104:107], v8, s[12:15], s63 offen sc1
    s_mov_b32 s63, 5120
    buffer_load_dwordx4 v[108:111], v8, s[12:15], s63 offen sc1
    s_waitcnt vmcnt(6)
    v_xor_b32 v12, s52, v113
    v_xor_b32 v13, s52, v115
    v_or_b32 v12, v12, v13
    v_xor_b32 v13, s52, v117
    v_or_b32 v12, v12, v13
    v_xor_b32 v13, s52, v119
    v_or_b32 v12, v12, v13
    v_cmp_eq_u32 vcc, 0, v12
    s_cmp_eq_u64 vcc, -1
    s_cbranch_scc1 L_fpd_50_2
    s_mov_b32 s63, 4096
    buffer_load_dwordx4 v[112:115], v8, s[12:15], s63 offen sc1
    s_mov_b32 s63, 5120
    buffer_load_dwordx4 v[116:119], v8, s[12:15], s63 offen sc1
    s_waitcnt vmcnt(6)
    v_xor_b32 v12, s52, v121
    v_xor_b32 v13, s52, v123
    v_or_b32 v12, v12, v13
    v_xor_b32 v13, s52, v125
    v_or_b32 v12, v12, v13
    v_xor_b32 v13, s52, v127
    v_or_b32 v12, v12, v13
    v_cmp_eq_u32 vcc, 0, v12
    s_cmp_eq_u64 vcc, -1
    s_cbranch_scc1 L_fpd_50_3
    s_mov_b32 s63, 4096
    buffer_load_dwordx4 v[120:123], v8, s[12:15], s63 offen sc1
    s_mov_b32 s63, 5120
    buffer_load_dwordx4 v[124:127], v8, s[12:15], s63 offen sc1
    s_sub_u32 s62, s62, 1
    s_cmp_eq_u32 s62, 0
    s_cbranch_scc0 L_fpl_49
    s_branch L_fpc_51
L_fpd_50_0:
    v_mov_b32 v80, v96
    v_mov_b32 v82, v98
    v_mov_b32 v84, v100
    v_mov_b32 v86, v102
    s_branch L_fpc_51
L_fpd_50_1:
    v_mov_b32 v80, v104
    v_mov_b32 v82, v106
    v_mov_b32 v84, v108
    v_mov_b32 v86, v110
    s_branch L_fpc_51
L_fpd_50_2:
    v_mov_b32 v80, v112
    v_mov_b32 v82, v114
    v_mov_b32 v84, v116
    v_mov_b32 v86, v118
    s_branch L_fpc_51
L_fpd_50_3:
    v_mov_b32 v80, v120
    v_mov_b32 v82, v122
    v_mov_b32 v84, v124
    v_mov_b32 v86, v126
L_fpc_51:
    v_fma_f32 v14, v80, v11, v14
    v_fma_f32 v15, v82, v11, v15
    v_fma_f32 v14, v84, v11, v14
    v_fma_f32 v15, v86, v11, v15
    s_nop 0
    v_add_f32_dpp v14, v14, v14 row_ror:8 row_mask:0xf bank_mask:0xf
    v_add_f32_dpp v15, v15, v15 row_ror:8 row_mask:0xf bank_mask:0xf
    v_mov_b32 v16, v14
    v_mov_b32 v17, v15
    s_nop 0
    v_permlane16_swap_b32 v14, v16
    v_permlane16_swap_b32 v15, v17
    v_add_f32 v14, v14, v16
    v_add_f32 v15, v15, v17
    v_mov_b32 v16, v14
    v_mov_b32 v17, v15
    s_nop 0
    v_permlane32_swap_b32 v14, v16
    v_permlane32_swap_b32 v15, v17
    v_add_f32 v14, v14, v16
    v_add_f32 v15, v15, v17
    v_cvt_pk_bf16_f32 v14, v14, v15
    v_and_b32 v8, 7, v1
    v_lshlrev_b32 v8, 2, v8
    s_lshl_b32 s60, s59, 5
    v_add_u32 v8, s60, v8
    s_mov_b32 exec_lo, 0xff
    s_mov_b32 exec_hi, 0x0
    buffer_store_dword v14, v8, s[36:39], 0 offen
    s_mov_b64 exec, -1
    s_cmp_eq_u32 s59, 0
    s_cbranch_scc0 L_end
    v_mov_b32 v8, 0
    v_mov_b32 v9, s52
    s_mov_b32 exec_lo, 0x1
    s_mov_b32 exec_hi, 0x0
    buffer_store_dword v9, v8, s[12:15], 0 offen offset:0 sc0 sc1
    s_endpgm
L_roleA2:
    s_lshl_b32 s67, s54, 2
    s_add_u32 s67, s67, s55
    s_sub_u32 s67, s67, 8
    s_lshl_b32 s56, s67, 2
    s_add_u32 s56, s56, 130
    s_load_dword s73, s[12:13], 0
    v_lshrrev_b32 v12, 3, v1
    s_mul_i32 s60, s53, 8
    v_add_u32 v12, s60, v12
    v_lshlrev_b32 v11, 13, v12
    v_lshlrev_b32 v12, 1, v12
    v_and_b32 v13, 7, v1
    v_lshlrev_b32 v13, 4, v13
    s_and_b32 s60, s56, 127
    s_lshl_b32 s60, s60, 6
    v_add3_u32 v11, v11, v13, s60
    buffer_load_ushort v132, v12, s[4:7], 0 offen offset:0
    buffer_load_ushort v133, v12, s[4:7], 0 offen offset:128
    buffer_load_ushort v134, v12, s[4:7], 0 offen offset:256
    buffer_load_ushort v135, v12, s[4:7], 0 offen offset:384
    buffer_load_ushort v136, v12, s[4:7], 0 offen offset:512
    buffer_load_ushort v137, v12, s[4:7], 0 offen offset:640
    buffer_load_ushort v138, v12, s[4:7], 0 offen offset:768
    buffer_load_ushort v139, v12, s[4:7], 0 offen offset:896
    buffer_load_ushort v140, v12, s[4:7], 0 offen offset:1024
    s_mov_b32 s63, 0x0
    buffer_load_dwordx4 v[96:99], v11, s[8:11], s63 offen nt
    s_mov_b32 s63, 0x80000
    buffer_load_dwordx4 v[100:103], v11, s[8:11], s63 offen nt
    s_mov_b32 s63, 0x100000
    buffer_load_dwordx4 v[104:107], v11, s[8:11], s63 offen nt
    s_mov_b32 s63, 0x180000
    buffer_load_dwordx4 v[108:111], v11, s[8:11], s63 offen nt
    s_mov_b32 s63, 0x200000
    buffer_load_dwordx4 v[112:115], v11, s[8:11], s63 offen nt
    s_mov_b32 s63, 0x280000
    buffer_load_dwordx4 v[116:119], v11, s[8:11], s63 offen nt
    s_mov_b32 s63, 0x300000
    buffer_load_dwordx4 v[120:123], v11, s[8:11], s63 offen nt
    s_mov_b32 s63, 0x380000
    buffer_load_dwordx4 v[124:127], v11, s[8:11], s63 offen nt
    s_mov_b32 s63, 0x400000
    buffer_load_dwordx4 v[128:131], v11, s[8:11], s63 offen nt
    s_waitcnt lgkmcnt(0)
    s_mul_i32 s52, s73, 1664525
    s_add_u32 s52, s52, 1013904223
    s_waitcnt vmcnt(0)
    v_lshlrev_b32 v13, 16, v132
    v_dot2_f32_bf16 v16, v96, v132, 0
    v_dot2_f32_bf16 v18, v97, v132, 0
    v_dot2_f32_bf16 v20, v98, v132, 0
    v_dot2_f32_bf16 v22, v99, v132, 0
    v_dot2_f32_bf16 v17, v96, v13, 0
    v_dot2_f32_bf16 v19, v97, v13, 0
    v_dot2_f32_bf16 v21, v98, v13, 0
    v_dot2_f32_bf16 v23, v99, v13, 0
    v_lshlrev_b32 v13, 16, v133
    v_dot2_f32_bf16 v16, v100, v133, v16
    v_dot2_f32_bf16 v18, v101, v133, v18
    v_dot2_f32_bf16 v20, v102, v133, v20
    v_dot2_f32_bf16 v22, v103, v133, v22
    v_dot2_f32_bf16 v17, v100, v13, v17
    v_dot2_f32_bf16 v19, v101, v13, v19
    v_dot2_f32_bf16 v21, v102, v13, v21
    v_dot2_f32_bf16 v23, v103, v13, v23
    v_lshlrev_b32 v13, 16, v134
    v_dot2_f32_bf16 v16, v104, v134, v16
    v_dot2_f32_bf16 v18, v105, v134, v18
    v_dot2_f32_bf16 v20, v106, v134, v20
    v_dot2_f32_bf16 v22, v107, v134, v22
    v_dot2_f32_bf16 v17, v104, v13, v17
    v_dot2_f32_bf16 v19, v105, v13, v19
    v_dot2_f32_bf16 v21, v106, v13, v21
    v_dot2_f32_bf16 v23, v107, v13, v23
    v_lshlrev_b32 v13, 16, v135
    v_dot2_f32_bf16 v16, v108, v135, v16
    v_dot2_f32_bf16 v18, v109, v135, v18
    v_dot2_f32_bf16 v20, v110, v135, v20
    v_dot2_f32_bf16 v22, v111, v135, v22
    v_dot2_f32_bf16 v17, v108, v13, v17
    v_dot2_f32_bf16 v19, v109, v13, v19
    v_dot2_f32_bf16 v21, v110, v13, v21
    v_dot2_f32_bf16 v23, v111, v13, v23
    v_lshlrev_b32 v13, 16, v136
    v_dot2_f32_bf16 v16, v112, v136, v16
    v_dot2_f32_bf16 v18, v113, v136, v18
    v_dot2_f32_bf16 v20, v114, v136, v20
    v_dot2_f32_bf16 v22, v115, v136, v22
    v_dot2_f32_bf16 v17, v112, v13, v17
    v_dot2_f32_bf16 v19, v113, v13, v19
    v_dot2_f32_bf16 v21, v114, v13, v21
    v_dot2_f32_bf16 v23, v115, v13, v23
    v_lshlrev_b32 v13, 16, v137
    v_dot2_f32_bf16 v16, v116, v137, v16
    v_dot2_f32_bf16 v18, v117, v137, v18
    v_dot2_f32_bf16 v20, v118, v137, v20
    v_dot2_f32_bf16 v22, v119, v137, v22
    v_dot2_f32_bf16 v17, v116, v13, v17
    v_dot2_f32_bf16 v19, v117, v13, v19
    v_dot2_f32_bf16 v21, v118, v13, v21
    v_dot2_f32_bf16 v23, v119, v13, v23
    v_lshlrev_b32 v13, 16, v138
    v_dot2_f32_bf16 v16, v120, v138, v16
    v_dot2_f32_bf16 v18, v121, v138, v18
    v_dot2_f32_bf16 v20, v122, v138, v20
    v_dot2_f32_bf16 v22, v123, v138, v22
    v_dot2_f32_bf16 v17, v120, v13, v17
    v_dot2_f32_bf16 v19, v121, v13, v19
    v_dot2_f32_bf16 v21, v122, v13, v21
    v_dot2_f32_bf16 v23, v123, v13, v23
    v_lshlrev_b32 v13, 16, v139
    v_dot2_f32_bf16 v16, v124, v139, v16
    v_dot2_f32_bf16 v18, v125, v139, v18
    v_dot2_f32_bf16 v20, v126, v139, v20
    v_dot2_f32_bf16 v22, v127, v139, v22
    v_dot2_f32_bf16 v17, v124, v13, v17
    v_dot2_f32_bf16 v19, v125, v13, v19
    v_dot2_f32_bf16 v21, v126, v13, v21
    v_dot2_f32_bf16 v23, v127, v13, v23
    v_lshlrev_b32 v13, 16, v140
    v_dot2_f32_bf16 v16, v128, v140, v16
    v_dot2_f32_bf16 v18, v129, v140, v18
    v_dot2_f32_bf16 v20, v130, v140, v20
    v_dot2_f32_bf16 v22, v131, v140, v22
    v_dot2_f32_bf16 v17, v128, v13, v17
    v_dot2_f32_bf16 v19, v129, v13, v19
    v_dot2_f32_bf16 v21, v130, v13, v21
    v_dot2_f32_bf16 v23, v131, v13, v23
    v_add_f32_dpp v16, v16, v16 row_ror:8 row_mask:0xf bank_mask:0xf
    v_add_f32_dpp v17, v17, v17 row_ror:8 row_mask:0xf bank_mask:0xf
    v_add_f32_dpp v18, v18, v18 row_ror:8 row_mask:0xf bank_mask:0xf
    v_add_f32_dpp v19, v19, v19 row_ror:8 row_mask:0xf bank_mask:0xf
    v_add_f32_dpp v20, v20, v20 row_ror:8 row_mask:0xf bank_mask:0xf
    v_add_f32_dpp v21, v21, v21 row_ror:8 row_mask:0xf bank_mask:0xf
    v_add_f32_dpp v22, v22, v22 row_ror:8 row_mask:0xf bank_mask:0xf
    v_add_f32_dpp v23, v23, v23 row_ror:8 row_mask:0xf bank_mask:0xf
    v_and_b32 v13, 7, v1
    v_lshlrev_b32 v13, 5, v13
    v_mul_u32_u24 v12, 256, v3
    s_mul_i32 s60, s53, 1024
    s_add_u32 s60, s60, 132608
    v_add3_u32 v11, v13, v12, s60
    s_mov_b32 exec_lo, 0xff00ff
    s_mov_b32 exec_hi, 0xff00ff
    ds_write_b128 v11, v[16:19]
    ds_write_b128 v11, v[20:23] offset:16
    s_mov_b64 exec, -1
    s_waitcnt lgkmcnt(0)
    s_barrier
    s_cmp_eq_u32 s53, 0
    s_cbranch_scc0 L_p1pub_52
    v_lshrrev_b32 v12, 5, v1
    v_lshlrev_b32 v12, 12, v12
    v_and_b32 v13, 31, v1
    v_lshlrev_b32 v13, 3, v13
    v_add3_u32 v11, v12, v13, 0
    v_add_u32 v11, 132608, v11
    ds_read_b64 v[96:97], v11 offset:0
    ds_read_b64 v[98:99], v11 offset:256
    ds_read_b64 v[100:101], v11 offset:512
    ds_read_b64 v[102:103], v11 offset:768
    ds_read_b64 v[104:105], v11 offset:1024
    ds_read_b64 v[106:107], v11 offset:1280
    ds_read_b64 v[108:109], v11 offset:1536
    ds_read_b64 v[110:111], v11 offset:1792
    ds_read_b64 v[112:113], v11 offset:2048
    ds_read_b64 v[114:115], v11 offset:2304
    ds_read_b64 v[116:117], v11 offset:2560
    ds_read_b64 v[118:119], v11 offset:2816
    ds_read_b64 v[120:121], v11 offset:3072
    ds_read_b64 v[122:123], v11 offset:3328
    ds_read_b64 v[124:125], v11 offset:3584
    ds_read_b64 v[126:127], v11 offset:3840
    s_waitcnt lgkmcnt(0)
    v_add_f32 v96, v96, v112
    v_add_f32 v97, v97, v113
    v_add_f32 v98, v98, v114
    v_add_f32 v99, v99, v115
    v_add_f32 v100, v100, v116
    v_add_f32 v101, v101, v117
    v_add_f32 v102, v102, v118
    v_add_f32 v103, v103, v119
    v_add_f32 v104, v104, v120
    v_add_f32 v105, v105, v121
    v_add_f32 v106, v106, v122
    v_add_f32 v107, v107, v123
    v_add_f32 v108, v108, v124
    v_add_f32 v109, v109, v125
    v_add_f32 v110, v110, v126
    v_add_f32 v111, v111, v127
    v_add_f32 v96, v96, v104
    v_add_f32 v97, v97, v105
    v_add_f32 v98, v98, v106
    v_add_f32 v99, v99, v107
    v_add_f32 v100, v100, v108
    v_add_f32 v101, v101, v109
    v_add_f32 v102, v102, v110
    v_add_f32 v103, v103, v111
    v_add_f32 v96, v96, v100
    v_add_f32 v97, v97, v101
    v_add_f32 v98, v98, v102
    v_add_f32 v99, v99, v103
    v_add_f32 v96, v96, v98
    v_add_f32 v97, v97, v99
    v_mov_b32 v98, v96
    v_mov_b32 v99, v97
    s_nop 0
    v_permlane32_swap_b32 v96, v98
    v_permlane32_swap_b32 v97, v99
    v_add_f32 v96, v96, v98
    v_add_f32 v97, v97, v99
    v_cvt_pk_bf16_f32 v100, v96, v97
    v_mov_b32 v101, s52
    s_lshl_b32 s60, s56, 7
    s_add_u32 s60, s60, 4096
    v_add_u32 v11, s60, v13
    s_mov_b32 exec_lo, 0xffffffff
    s_mov_b32 exec_hi, 0x0
    buffer_store_dwordx2 v[100:101], v11, s[12:15], 0 offen sc0 sc1
    s_mov_b64 exec, -1
L_p1pub_52:
    s_barrier
    v_lshrrev_b32 v8, 3, v1
    s_lshl_b32 s60, s53, 6
    v_add_u32 v9, s60, v8
    v_lshlrev_b32 v9, 13, v9
    v_and_b32 v10, 7, v1
    v_lshlrev_b32 v10, 4, v10
    s_lshl_b32 s60, s67, 8
    v_add3_u32 v9, v9, v10, s60
    s_mov_b32 s63, 0
    buffer_load_dwordx4 v[96:99], v9, s[24:27], s63 offen offset:0 nt
    s_mov_b32 s63, 65536
    buffer_load_dwordx4 v[100:103], v9, s[24:27], s63 offen offset:0 nt
    s_mov_b32 s63, 131072
    buffer_load_dwordx4 v[104:107], v9, s[24:27], s63 offen offset:0 nt
    s_mov_b32 s63, 196608
    buffer_load_dwordx4 v[108:111], v9, s[24:27], s63 offen offset:0 nt
    s_mov_b32 s63, 262144
    buffer_load_dwordx4 v[112:115], v9, s[24:27], s63 offen offset:0 nt
    s_mov_b32 s63, 327680
    buffer_load_dwordx4 v[116:119], v9, s[24:27], s63 offen offset:0 nt
    s_mov_b32 s63, 393216
    buffer_load_dwordx4 v[120:123], v9, s[24:27], s63 offen offset:0 nt
    s_mov_b32 s63, 458752
    buffer_load_dwordx4 v[124:127], v9, s[24:27], s63 offen offset:0 nt
    s_mov_b32 s63, 0
    buffer_load_dwordx4 v[128:131], v9, s[24:27], s63 offen offset:128 nt
    s_mov_b32 s63, 65536
    buffer_load_dwordx4 v[132:135], v9, s[24:27], s63 offen offset:128 nt
    s_mov_b32 s63, 131072
    buffer_load_dwordx4 v[136:139], v9, s[24:27], s63 offen offset:128 nt
    s_mov_b32 s63, 196608
    buffer_load_dwordx4 v[140:143], v9, s[24:27], s63 offen offset:128 nt
    s_mov_b32 s63, 262144
    buffer_load_dwordx4 v[144:147], v9, s[24:27], s63 offen offset:128 nt
    s_mov_b32 s63, 327680
    buffer_load_dwordx4 v[148:151], v9, s[24:27], s63 offen offset:128 nt
    s_mov_b32 s63, 393216
    buffer_load_dwordx4 v[152:155], v9, s[24:27], s63 offen offset:128 nt
    s_mov_b32 s63, 458752
    buffer_load_dwordx4 v[156:159], v9, s[24:27], s63 offen offset:128 nt
    s_lshl_b32 s60, s67, 7
    s_lshl_b32 s61, s53, 3
    s_add_u32 s60, s60, s61
    v_add_u32 v9, s60, v8
    v_mul_u32_u24 v9, 1152, v9
    v_add_u32 v9, v9, v10
    s_mov_b32 s63, 0
    buffer_load_dwordx4 v[160:163], v9, s[28:31], s63 offen offset:0 nt
    buffer_load_dwordx4 v[164:167], v9, s[28:31], s63 offen offset:128 nt
    buffer_load_dwordx4 v[168:171], v9, s[28:31], s63 offen offset:256 nt
    buffer_load_dwordx4 v[172:175], v9, s[28:31], s63 offen offset:384 nt
    buffer_load_dwordx4 v[176:179], v9, s[28:31], s63 offen offset:512 nt
    buffer_load_dwordx4 v[180:183], v9, s[28:31], s63 offen offset:640 nt
    buffer_load_dwordx4 v[184:187], v9, s[28:31], s63 offen offset:768 nt
    buffer_load_dwordx4 v[188:191], v9, s[28:31], s63 offen offset:896 nt
    buffer_load_dwordx4 v[192:195], v9, s[28:31], s63 offen offset:1024 nt
    s_mov_b32 s63, 73728
    buffer_load_dwordx4 v[196:199], v9, s[28:31], s63 offen offset:0 nt
    buffer_load_dwordx4 v[200:203], v9, s[28:31], s63 offen offset:128 nt
    buffer_load_dwordx4 v[204:207], v9, s[28:31], s63 offen offset:256 nt
    buffer_load_dwordx4 v[208:211], v9, s[28:31], s63 offen offset:384 nt
    buffer_load_dwordx4 v[212:215], v9, s[28:31], s63 offen offset:512 nt
    buffer_load_dwordx4 v[216:219], v9, s[28:31], s63 offen offset:640 nt
    buffer_load_dwordx4 v[220:223], v9, s[28:31], s63 offen offset:768 nt
    buffer_load_dwordx4 v[224:227], v9, s[28:31], s63 offen offset:896 nt
    buffer_load_dwordx4 v[228:231], v9, s[28:31], s63 offen offset:1024 nt
    v_and_b32 v13, 7, v1
    s_lshl_b32 s60, s53, 3
    v_add_u32 v13, s60, v13
    v_lshlrev_b32 v12, 2, v13
    s_lshl_b32 s60, s67, 8
    s_add_u32 s60, s60, 1179648
    v_add_u32 v12, s60, v12
    v_lshlrev_b32 v11, 3, v13
    s_mov_b32 s62, 3000
L_poll_53:
    buffer_load_dword v13, v12, s[12:15], 0 offen sc1
    s_waitcnt vmcnt(0)
    v_xor_b32 v14, s52, v13
    v_cmp_eq_u32 vcc, 0, v14
    s_cmp_eq_u64 vcc, -1
    s_cbranch_scc1 L_pdone_54
    s_sub_u32 s62, s62, 1
    s_cmp_eq_u32 s62, 0
    s_cbranch_scc0 L_poll_53
L_pdone_54:
    s_lshl_b32 s60, s67, 9
    s_add_u32 s60, s60, 102400
    v_add_u32 v12, s60, v11
    buffer_load_dwordx2 v[14:15], v12, s[12:15], 0 offen sc1
    v_lshlrev_b32 v12, 4, v1
    s_lshl_b32 s60, s53, 18
    s_lshl_b32 s61, s67, 10
    s_add_u32 s60, s60, s61
    s_add_u32 s60, s60, 2097152
    s_add_u32 s63, s60, 0
    buffer_load_dwordx4 v[64:67], v12, s[12:15], s63 offen sc1
    s_add_u32 s63, s60, 32768
    buffer_load_dwordx4 v[68:71], v12, s[12:15], s63 offen sc1
    s_add_u32 s63, s60, 65536
    buffer_load_dwordx4 v[72:75], v12, s[12:15], s63 offen sc1
    s_add_u32 s63, s60, 98304
    buffer_load_dwordx4 v[76:79], v12, s[12:15], s63 offen sc1
    s_add_u32 s63, s60, 131072
    buffer_load_dwordx4 v[80:83], v12, s[12:15], s63 offen sc1
    s_add_u32 s63, s60, 163840
    buffer_load_dwordx4 v[84:87], v12, s[12:15], s63 offen sc1
    s_add_u32 s63, s60, 196608
    buffer_load_dwordx4 v[88:91], v12, s[12:15], s63 offen sc1
    s_add_u32 s63, s60, 229376
    buffer_load_dwordx4 v[92:95], v12, s[12:15], s63 offen sc1
    s_waitcnt vmcnt(8)
    v_mov_b32 v16, v14
    s_nop 1
    v_max_f32_dpp v16, v16, v16 quad_perm:[1,0,3,2] row_mask:0xf bank_mask:0xf
    s_nop 1
    v_max_f32_dpp v16, v16, v16 quad_perm:[2,3,0,1] row_mask:0xf bank_mask:0xf
    s_nop 1
    v_max_f32_dpp v16, v16, v16 row_ror:4 row_mask:0xf bank_mask:0xf
    v_sub_f32 v18, v14, v16
    v_mul_f32 v18, s64, v18
    v_exp_f32 v18, v18
    s_nop 0
    v_mul_f32 v17, v15, v18
    s_nop 1
    v_add_f32_dpp v17, v17, v17 quad_perm:[1,0,3,2] row_mask:0xf bank_mask:0xf
    s_nop 1
    v_add_f32_dpp v17, v17, v17 quad_perm:[2,3,0,1] row_mask:0xf bank_mask:0xf
    s_nop 1
    v_add_f32_dpp v17, v17, v17 row_ror:4 row_mask:0xf bank_mask:0xf
    v_readlane_b32 s80, v18, 0
    v_readlane_b32 s81, v18, 1
    v_readlane_b32 s82, v18, 2
    v_readlane_b32 s83, v18, 3
    v_readlane_b32 s84, v18, 4
    v_readlane_b32 s85, v18, 5
    v_readlane_b32 s86, v18, 6
    v_readlane_b32 s87, v18, 7
    s_lshl_b32 s60, s53, 3
    s_add_u32 s60, s60, 40960
    v_mov_b32 v12, s60
    s_mov_b32 exec_lo, 0x1
    s_mov_b32 exec_hi, 0x0
    ds_write_b64 v12, v[16:17]
    s_mov_b64 exec, -1
    s_waitcnt vmcnt(0)
    v_lshlrev_b32 v28, 16, v64
    v_and_b32 v29, 0xffff0000, v64
    v_mul_f32 v20, s80, v28
    v_mul_f32 v21, s80, v29
    v_lshlrev_b32 v28, 16, v65
    v_and_b32 v29, 0xffff0000, v65
    v_mul_f32 v22, s80, v28
    v_mul_f32 v23, s80, v29
    v_lshlrev_b32 v28, 16, v66
    v_and_b32 v29, 0xffff0000, v66
    v_mul_f32 v24, s80, v28
    v_mul_f32 v25, s80, v29
    v_lshlrev_b32 v28, 16, v67
    v_and_b32 v29, 0xffff0000, v67
    v_mul_f32 v26, s80, v28
    v_mul_f32 v27, s80, v29
    v_lshlrev_b32 v28, 16, v68
    v_and_b32 v29, 0xffff0000, v68
    v_fma_f32 v20, s81, v28, v20
    v_fma_f32 v21, s81, v29, v21
    v_lshlrev_b32 v28, 16, v69
    v_and_b32 v29, 0xffff0000, v69
    v_fma_f32 v22, s81, v28, v22
    v_fma_f32 v23, s81, v29, v23
    v_lshlrev_b32 v28, 16, v70
    v_and_b32 v29, 0xffff0000, v70
    v_fma_f32 v24, s81, v28, v24
    v_fma_f32 v25, s81, v29, v25
    v_lshlrev_b32 v28, 16, v71
    v_and_b32 v29, 0xffff0000, v71
    v_fma_f32 v26, s81, v28, v26
    v_fma_f32 v27, s81, v29, v27
    v_lshlrev_b32 v28, 16, v72
    v_and_b32 v29, 0xffff0000, v72
    v_fma_f32 v20, s82, v28, v20
    v_fma_f32 v21, s82, v29, v21
    v_lshlrev_b32 v28, 16, v73
    v_and_b32 v29, 0xffff0000, v73
    v_fma_f32 v22, s82, v28, v22
    v_fma_f32 v23, s82, v29, v23
    v_lshlrev_b32 v28, 16, v74
    v_and_b32 v29, 0xffff0000, v74
    v_fma_f32 v24, s82, v28, v24
    v_fma_f32 v25, s82, v29, v25
    v_lshlrev_b32 v28, 16, v75
    v_and_b32 v29, 0xffff0000, v75
    v_fma_f32 v26, s82, v28, v26
    v_fma_f32 v27, s82, v29, v27
    v_lshlrev_b32 v28, 16, v76
    v_and_b32 v29, 0xffff0000, v76
    v_fma_f32 v20, s83, v28, v20
    v_fma_f32 v21, s83, v29, v21
    v_lshlrev_b32 v28, 16, v77
    v_and_b32 v29, 0xffff0000, v77
    v_fma_f32 v22, s83, v28, v22
    v_fma_f32 v23, s83, v29, v23
    v_lshlrev_b32 v28, 16, v78
    v_and_b32 v29, 0xffff0000, v78
    v_fma_f32 v24, s83, v28, v24
    v_fma_f32 v25, s83, v29, v25
    v_lshlrev_b32 v28, 16, v79
    v_and_b32 v29, 0xffff0000, v79
    v_fma_f32 v26, s83, v28, v26
    v_fma_f32 v27, s83, v29, v27
    v_lshlrev_b32 v28, 16, v80
    v_and_b32 v29, 0xffff0000, v80
    v_fma_f32 v20, s84, v28, v20
    v_fma_f32 v21, s84, v29, v21
    v_lshlrev_b32 v28, 16, v81
    v_and_b32 v29, 0xffff0000, v81
    v_fma_f32 v22, s84, v28, v22
    v_fma_f32 v23, s84, v29, v23
    v_lshlrev_b32 v28, 16, v82
    v_and_b32 v29, 0xffff0000, v82
    v_fma_f32 v24, s84, v28, v24
    v_fma_f32 v25, s84, v29, v25
    v_lshlrev_b32 v28, 16, v83
    v_and_b32 v29, 0xffff0000, v83
    v_fma_f32 v26, s84, v28, v26
    v_fma_f32 v27, s84, v29, v27
    v_lshlrev_b32 v28, 16, v84
    v_and_b32 v29, 0xffff0000, v84
    v_fma_f32 v20, s85, v28, v20
    v_fma_f32 v21, s85, v29, v21
    v_lshlrev_b32 v28, 16, v85
    v_and_b32 v29, 0xffff0000, v85
    v_fma_f32 v22, s85, v28, v22
    v_fma_f32 v23, s85, v29, v23
    v_lshlrev_b32 v28, 16, v86
    v_and_b32 v29, 0xffff0000, v86
    v_fma_f32 v24, s85, v28, v24
    v_fma_f32 v25, s85, v29, v25
    v_lshlrev_b32 v28, 16, v87
    v_and_b32 v29, 0xffff0000, v87
    v_fma_f32 v26, s85, v28, v26
    v_fma_f32 v27, s85, v29, v27
    v_lshlrev_b32 v28, 16, v88
    v_and_b32 v29, 0xffff0000, v88
    v_fma_f32 v20, s86, v28, v20
    v_fma_f32 v21, s86, v29, v21
    v_lshlrev_b32 v28, 16, v89
    v_and_b32 v29, 0xffff0000, v89
    v_fma_f32 v22, s86, v28, v22
    v_fma_f32 v23, s86, v29, v23
    v_lshlrev_b32 v28, 16, v90
    v_and_b32 v29, 0xffff0000, v90
    v_fma_f32 v24, s86, v28, v24
    v_fma_f32 v25, s86, v29, v25
    v_lshlrev_b32 v28, 16, v91
    v_and_b32 v29, 0xffff0000, v91
    v_fma_f32 v26, s86, v28, v26
    v_fma_f32 v27, s86, v29, v27
    v_lshlrev_b32 v28, 16, v92
    v_and_b32 v29, 0xffff0000, v92
    v_fma_f32 v20, s87, v28, v20
    v_fma_f32 v21, s87, v29, v21
    v_lshlrev_b32 v28, 16, v93
    v_and_b32 v29, 0xffff0000, v93
    v_fma_f32 v22, s87, v28, v22
    v_fma_f32 v23, s87, v29, v23
    v_lshlrev_b32 v28, 16, v94
    v_and_b32 v29, 0xffff0000, v94
    v_fma_f32 v24, s87, v28, v24
    v_fma_f32 v25, s87, v29, v25
    v_lshlrev_b32 v28, 16, v95
    v_and_b32 v29, 0xffff0000, v95
    v_fma_f32 v26, s87, v28, v26
    v_fma_f32 v27, s87, v29, v27
    v_lshrrev_b32 v12, 3, v1
    v_lshlrev_b32 v12, 8, v12
    v_and_b32 v13, 1, v1
    v_lshlrev_b32 v13, 7, v13
    v_bfe_u32 v14, v1, 1, 2
    v_lshlrev_b32 v14, 4, v14
    v_add3_u32 v12, v12, v13, v14
    s_lshl_b32 s60, s53, 11
    v_add_u32 v12, s60, v12
    ds_write_b128 v12, v[20:23] offset:0
    ds_write_b128 v12, v[24:27] offset:64
    s_waitcnt lgkmcnt(0)
    s_barrier
    v_lshlrev_b32 v12, 2, v0
    v_mov_b32 v13, 40960
    ds_read_b128 v[64:67], v13 offset:0
    ds_read_b128 v[68:71], v13 offset:16
    ds_read_b128 v[72:75], v13 offset:32
    ds_read_b128 v[76:79], v13 offset:48
    ds_read_b32 v20, v12 offset:0
    ds_read_b32 v21, v12 offset:2048
    ds_read_b32 v22, v12 offset:4096
    ds_read_b32 v23, v12 offset:6144
    ds_read_b32 v24, v12 offset:8192
    ds_read_b32 v25, v12 offset:10240
    ds_read_b32 v26, v12 offset:12288
    ds_read_b32 v27, v12 offset:14336
    s_waitcnt lgkmcnt(8)
    v_max3_f32 v16, v64, v66, v68
    v_max3_f32 v16, v16, v70, v72
    v_max3_f32 v16, v16, v74, v76
    v_max_f32 v16, v16, v78
    v_sub_f32 v64, v64, v16
    v_sub_f32 v66, v66, v16
    v_sub_f32 v68, v68, v16
    v_sub_f32 v70, v70, v16
    v_sub_f32 v72, v72, v16
    v_sub_f32 v74, v74, v16
    v_sub_f32 v76, v76, v16
    v_sub_f32 v78, v78, v16
    v_mul_f32 v64, s64, v64
    v_mul_f32 v66, s64, v66
    v_mul_f32 v68, s64, v68
    v_mul_f32 v70, s64, v70
    v_mul_f32 v72, s64, v72
    v_mul_f32 v74, s64, v74
    v_mul_f32 v76, s64, v76
    v_mul_f32 v78, s64, v78
    v_exp_f32 v64, v64
    v_exp_f32 v66, v66
    v_exp_f32 v68, v68
    v_exp_f32 v70, v70
    v_exp_f32 v72, v72
    v_exp_f32 v74, v74
    v_exp_f32 v76, v76
    v_exp_f32 v78, v78
    v_mul_f32 v17, v65, v64
    v_fma_f32 v17, v67, v66, v17
    v_fma_f32 v17, v69, v68, v17
    v_fma_f32 v17, v71, v70, v17
    v_fma_f32 v17, v73, v72, v17
    v_fma_f32 v17, v75, v74, v17
    v_fma_f32 v17, v77, v76, v17
    v_fma_f32 v17, v79, v78, v17
    v_rcp_f32 v17, v17
    s_waitcnt lgkmcnt(0)
    v_mul_f32 v20, v20, v64
    v_fma_f32 v20, v21, v66, v20
    v_fma_f32 v20, v22, v68, v20
    v_fma_f32 v20, v23, v70, v20
    v_fma_f32 v20, v24, v72, v20
    v_fma_f32 v20, v25, v74, v20
    v_fma_f32 v20, v26, v76, v20
    v_fma_f32 v20, v27, v78, v20
    v_mul_f32 v20, v20, v17
    v_cvt_pk_bf16_f32 v20, v20, 0
    v_lshlrev_b32 v12, 2, v8
    ds_bpermute_b32 v24, v12, v20 offset:0
    ds_bpermute_b32 v25, v12, v20 offset:32
    ds_bpermute_b32 v26, v12, v20 offset:64
    ds_bpermute_b32 v27, v12, v20 offset:96
    ds_bpermute_b32 v28, v12, v20 offset:128
    ds_bpermute_b32 v29, v12, v20 offset:160
    ds_bpermute_b32 v30, v12, v20 offset:192
    ds_bpermute_b32 v31, v12, v20 offset:224
    s_waitcnt lgkmcnt(0)
    v_lshlrev_b32 v32, 16, v24
    v_dot2_f32_bf16 v40, v96, v24, 0
    v_dot2_f32_bf16 v42, v97, v24, 0
    v_dot2_f32_bf16 v44, v98, v24, 0
    v_dot2_f32_bf16 v46, v99, v24, 0
    v_dot2_f32_bf16 v41, v96, v32, 0
    v_dot2_f32_bf16 v43, v97, v32, 0
    v_dot2_f32_bf16 v45, v98, v32, 0
    v_dot2_f32_bf16 v47, v99, v32, 0
    v_dot2_f32_bf16 v48, v128, v24, 0
    v_dot2_f32_bf16 v50, v129, v24, 0
    v_dot2_f32_bf16 v52, v130, v24, 0
    v_dot2_f32_bf16 v54, v131, v24, 0
    v_dot2_f32_bf16 v49, v128, v32, 0
    v_dot2_f32_bf16 v51, v129, v32, 0
    v_dot2_f32_bf16 v53, v130, v32, 0
    v_dot2_f32_bf16 v55, v131, v32, 0
    v_lshlrev_b32 v32, 16, v25
    v_dot2_f32_bf16 v40, v100, v25, v40
    v_dot2_f32_bf16 v42, v101, v25, v42
    v_dot2_f32_bf16 v44, v102, v25, v44
    v_dot2_f32_bf16 v46, v103, v25, v46
    v_dot2_f32_bf16 v41, v100, v32, v41
    v_dot2_f32_bf16 v43, v101, v32, v43
    v_dot2_f32_bf16 v45, v102, v32, v45
    v_dot2_f32_bf16 v47, v103, v32, v47
    v_dot2_f32_bf16 v48, v132, v25, v48
    v_dot2_f32_bf16 v50, v133, v25, v50
    v_dot2_f32_bf16 v52, v134, v25, v52
    v_dot2_f32_bf16 v54, v135, v25, v54
    v_dot2_f32_bf16 v49, v132, v32, v49
    v_dot2_f32_bf16 v51, v133, v32, v51
    v_dot2_f32_bf16 v53, v134, v32, v53
    v_dot2_f32_bf16 v55, v135, v32, v55
    v_lshlrev_b32 v32, 16, v26
    v_dot2_f32_bf16 v40, v104, v26, v40
    v_dot2_f32_bf16 v42, v105, v26, v42
    v_dot2_f32_bf16 v44, v106, v26, v44
    v_dot2_f32_bf16 v46, v107, v26, v46
    v_dot2_f32_bf16 v41, v104, v32, v41
    v_dot2_f32_bf16 v43, v105, v32, v43
    v_dot2_f32_bf16 v45, v106, v32, v45
    v_dot2_f32_bf16 v47, v107, v32, v47
    v_dot2_f32_bf16 v48, v136, v26, v48
    v_dot2_f32_bf16 v50, v137, v26, v50
    v_dot2_f32_bf16 v52, v138, v26, v52
    v_dot2_f32_bf16 v54, v139, v26, v54
    v_dot2_f32_bf16 v49, v136, v32, v49
    v_dot2_f32_bf16 v51, v137, v32, v51
    v_dot2_f32_bf16 v53, v138, v32, v53
    v_dot2_f32_bf16 v55, v139, v32, v55
    v_lshlrev_b32 v32, 16, v27
    v_dot2_f32_bf16 v40, v108, v27, v40
    v_dot2_f32_bf16 v42, v109, v27, v42
    v_dot2_f32_bf16 v44, v110, v27, v44
    v_dot2_f32_bf16 v46, v111, v27, v46
    v_dot2_f32_bf16 v41, v108, v32, v41
    v_dot2_f32_bf16 v43, v109, v32, v43
    v_dot2_f32_bf16 v45, v110, v32, v45
    v_dot2_f32_bf16 v47, v111, v32, v47
    v_dot2_f32_bf16 v48, v140, v27, v48
    v_dot2_f32_bf16 v50, v141, v27, v50
    v_dot2_f32_bf16 v52, v142, v27, v52
    v_dot2_f32_bf16 v54, v143, v27, v54
    v_dot2_f32_bf16 v49, v140, v32, v49
    v_dot2_f32_bf16 v51, v141, v32, v51
    v_dot2_f32_bf16 v53, v142, v32, v53
    v_dot2_f32_bf16 v55, v143, v32, v55
    v_lshlrev_b32 v32, 16, v28
    v_dot2_f32_bf16 v40, v112, v28, v40
    v_dot2_f32_bf16 v42, v113, v28, v42
    v_dot2_f32_bf16 v44, v114, v28, v44
    v_dot2_f32_bf16 v46, v115, v28, v46
    v_dot2_f32_bf16 v41, v112, v32, v41
    v_dot2_f32_bf16 v43, v113, v32, v43
    v_dot2_f32_bf16 v45, v114, v32, v45
    v_dot2_f32_bf16 v47, v115, v32, v47
    v_dot2_f32_bf16 v48, v144, v28, v48
    v_dot2_f32_bf16 v50, v145, v28, v50
    v_dot2_f32_bf16 v52, v146, v28, v52
    v_dot2_f32_bf16 v54, v147, v28, v54
    v_dot2_f32_bf16 v49, v144, v32, v49
    v_dot2_f32_bf16 v51, v145, v32, v51
    v_dot2_f32_bf16 v53, v146, v32, v53
    v_dot2_f32_bf16 v55, v147, v32, v55
    v_lshlrev_b32 v32, 16, v29
    v_dot2_f32_bf16 v40, v116, v29, v40
    v_dot2_f32_bf16 v42, v117, v29, v42
    v_dot2_f32_bf16 v44, v118, v29, v44
    v_dot2_f32_bf16 v46, v119, v29, v46
    v_dot2_f32_bf16 v41, v116, v32, v41
    v_dot2_f32_bf16 v43, v117, v32, v43
    v_dot2_f32_bf16 v45, v118, v32, v45
    v_dot2_f32_bf16 v47, v119, v32, v47
    v_dot2_f32_bf16 v48, v148, v29, v48
    v_dot2_f32_bf16 v50, v149, v29, v50
    v_dot2_f32_bf16 v52, v150, v29, v52
    v_dot2_f32_bf16 v54, v151, v29, v54
    v_dot2_f32_bf16 v49, v148, v32, v49
    v_dot2_f32_bf16 v51, v149, v32, v51
    v_dot2_f32_bf16 v53, v150, v32, v53
    v_dot2_f32_bf16 v55, v151, v32, v55
    v_lshlrev_b32 v32, 16, v30
    v_dot2_f32_bf16 v40, v120, v30, v40
    v_dot2_f32_bf16 v42, v121, v30, v42
    v_dot2_f32_bf16 v44, v122, v30, v44
    v_dot2_f32_bf16 v46, v123, v30, v46
    v_dot2_f32_bf16 v41, v120, v32, v41
    v_dot2_f32_bf16 v43, v121, v32, v43
    v_dot2_f32_bf16 v45, v122, v32, v45
    v_dot2_f32_bf16 v47, v123, v32, v47
    v_dot2_f32_bf16 v48, v152, v30, v48
    v_dot2_f32_bf16 v50, v153, v30, v50
    v_dot2_f32_bf16 v52, v154, v30, v52
    v_dot2_f32_bf16 v54, v155, v30, v54
    v_dot2_f32_bf16 v49, v152, v32, v49
    v_dot2_f32_bf16 v51, v153, v32, v51
    v_dot2_f32_bf16 v53, v154, v32, v53
    v_dot2_f32_bf16 v55, v155, v32, v55
    v_lshlrev_b32 v32, 16, v31
    v_dot2_f32_bf16 v40, v124, v31, v40
    v_dot2_f32_bf16 v42, v125, v31, v42
    v_dot2_f32_bf16 v44, v126, v31, v44
    v_dot2_f32_bf16 v46, v127, v31, v46
    v_dot2_f32_bf16 v41, v124, v32, v41
    v_dot2_f32_bf16 v43, v125, v32, v43
    v_dot2_f32_bf16 v45, v126, v32, v45
    v_dot2_f32_bf16 v47, v127, v32, v47
    v_dot2_f32_bf16 v48, v156, v31, v48
    v_dot2_f32_bf16 v50, v157, v31, v50
    v_dot2_f32_bf16 v52, v158, v31, v52
    v_dot2_f32_bf16 v54, v159, v31, v54
    v_dot2_f32_bf16 v49, v156, v32, v49
    v_dot2_f32_bf16 v51, v157, v32, v51
    v_dot2_f32_bf16 v53, v158, v32, v53
    v_dot2_f32_bf16 v55, v159, v32, v55
    v_permlane32_swap_b32 v40, v44
    v_permlane32_swap_b32 v41, v45
    v_permlane32_swap_b32 v42, v46
    v_permlane32_swap_b32 v43, v47
    v_add_f32 v40, v40, v44
    v_add_f32 v41, v41, v45
    v_add_f32 v42, v42, v46
    v_add_f32 v43, v43, v47
    s_nop 0
    v_permlane16_swap_b32 v40, v42
    v_permlane16_swap_b32 v41, v43
    v_add_f32 v40, v40, v42
    v_add_f32 v41, v41, v43
    s_nop 0
    v_add_f32_dpp v40, v40, v40 row_ror:8 row_mask:0xf bank_mask:0xf
    v_add_f32_dpp v41, v41, v41 row_ror:8 row_mask:0xf bank_mask:0xf
    v_permlane32_swap_b32 v48, v52
    v_permlane32_swap_b32 v49, v53
    v_permlane32_swap_b32 v50, v54
    v_permlane32_swap_b32 v51, v55
    v_add_f32 v48, v48, v52
    v_add_f32 v49, v49, v53
    v_add_f32 v50, v50, v54
    v_add_f32 v51, v51, v55
    s_nop 0
    v_permlane16_swap_b32 v48, v50
    v_permlane16_swap_b32 v49, v51
    v_add_f32 v48, v48, v50
    v_add_f32 v49, v49, v51
    s_nop 0
    v_add_f32_dpp v48, v48, v48 row_ror:8 row_mask:0xf bank_mask:0xf
    v_add_f32_dpp v49, v49, v49 row_ror:8 row_mask:0xf bank_mask:0xf
    v_and_b32 v13, 7, v1
    v_lshlrev_b32 v13, 5, v13
    v_lshlrev_b32 v14, 3, v3
    v_add_u32 v13, v13, v14
    s_lshl_b32 s60, s53, 9
    v_add_u32 v12, s60, v13
    ds_write_b64 v12, v[40:41] offset:16384
    ds_write_b64 v12, v[48:49] offset:16640
    s_waitcnt lgkmcnt(0)
    s_barrier
    s_lshl_b32 s60, s53, 3
    v_add_u32 v12, s60, v8
    v_lshlrev_b32 v12, 2, v12
    ds_read_b32 v20, v12 offset:16384
    ds_read_b32 v21, v12 offset:16896
    ds_read_b32 v22, v12 offset:17408
    ds_read_b32 v23, v12 offset:17920
    ds_read_b32 v24, v12 offset:18432
    ds_read_b32 v25, v12 offset:18944
    ds_read_b32 v26, v12 offset:19456
    ds_read_b32 v27, v12 offset:19968
    ds_read_b32 v28, v12 offset:16640
    ds_read_b32 v29, v12 offset:17152
    ds_read_b32 v30, v12 offset:17664
    ds_read_b32 v31, v12 offset:18176
    ds_read_b32 v32, v12 offset:18688
    ds_read_b32 v33, v12 offset:19200
    ds_read_b32 v34, v12 offset:19712
    ds_read_b32 v35, v12 offset:20224
    s_waitcnt lgkmcnt(0)
    v_add_f32 v20, v20, v24
    v_add_f32 v21, v21, v25
    v_add_f32 v22, v22, v26
    v_add_f32 v23, v23, v27
    v_add_f32 v28, v28, v32
    v_add_f32 v29, v29, v33
    v_add_f32 v30, v30, v34
    v_add_f32 v31, v31, v35
    v_add_f32 v20, v20, v22
    v_add_f32 v21, v21, v23
    v_add_f32 v28, v28, v30
    v_add_f32 v29, v29, v31
    v_add_f32 v20, v20, v21
    v_add_f32 v28, v28, v29
    v_cvt_pk_bf16_f32 v36, v20, 0
    v_cvt_pk_bf16_f32 v37, 0, v20
    v_cvt_pk_bf16_f32 v38, v28, 0
    v_cvt_pk_bf16_f32 v39, 0, v28
    v_dot2_f32_bf16 v64, v160, v36, 0
    v_dot2_f32_bf16 v65, v160, v37, 0
    v_dot2_f32_bf16 v66, v161, v36, 0
    v_dot2_f32_bf16 v67, v161, v37, 0
    v_dot2_f32_bf16 v68, v162, v36, 0
    v_dot2_f32_bf16 v69, v162, v37, 0
    v_dot2_f32_bf16 v70, v163, v36, 0
    v_dot2_f32_bf16 v71, v163, v37, 0
    v_dot2_f32_bf16 v72, v164, v36, 0
    v_dot2_f32_bf16 v73, v164, v37, 0
    v_dot2_f32_bf16 v74, v165, v36, 0
    v_dot2_f32_bf16 v75, v165, v37, 0
    v_dot2_f32_bf16 v76, v166, v36, 0
    v_dot2_f32_bf16 v77, v166, v37, 0
    v_dot2_f32_bf16 v78, v167, v36, 0
    v_dot2_f32_bf16 v79, v167, v37, 0
    v_dot2_f32_bf16 v80, v168, v36, 0
    v_dot2_f32_bf16 v81, v168, v37, 0
    v_dot2_f32_bf16 v82, v169, v36, 0
    v_dot2_f32_bf16 v83, v169, v37, 0
    v_dot2_f32_bf16 v84, v170, v36, 0
    v_dot2_f32_bf16 v85, v170, v37, 0
    v_dot2_f32_bf16 v86, v171, v36, 0
    v_dot2_f32_bf16 v87, v171, v37, 0
    v_dot2_f32_bf16 v88, v172, v36, 0
    v_dot2_f32_bf16 v89, v172, v37, 0
    v_dot2_f32_bf16 v90, v173, v36, 0
    v_dot2_f32_bf16 v91, v173, v37, 0
    v_dot2_f32_bf16 v92, v174, v36, 0
    v_dot2_f32_bf16 v93, v174, v37, 0
    v_dot2_f32_bf16 v94, v175, v36, 0
    v_dot2_f32_bf16 v95, v175, v37, 0
    v_dot2_f32_bf16 v96, v176, v36, 0
    v_dot2_f32_bf16 v97, v176, v37, 0
    v_dot2_f32_bf16 v98, v177, v36, 0
    v_dot2_f32_bf16 v99, v177, v37, 0
    v_dot2_f32_bf16 v100, v178, v36, 0
    v_dot2_f32_bf16 v101, v178, v37, 0
    v_dot2_f32_bf16 v102, v179, v36, 0
    v_dot2_f32_bf16 v103, v179, v37, 0
    v_dot2_f32_bf16 v104, v180, v36, 0
    v_dot2_f32_bf16 v105, v180, v37, 0
    v_dot2_f32_bf16 v106, v181, v36, 0
    v_dot2_f32_bf16 v107, v181, v37, 0
    v_dot2_f32_bf16 v108, v182, v36, 0
    v_dot2_f32_bf16 v109, v182, v37, 0
    v_dot2_f32_bf16 v110, v183, v36, 0
    v_dot2_f32_bf16 v111, v183, v37, 0
    v_dot2_f32_bf16 v112, v184, v36, 0
    v_dot2_f32_bf16 v113, v184, v37, 0
    v_dot2_f32_bf16 v114, v185, v36, 0
    v_dot2_f32_bf16 v115, v185, v37, 0
    v_dot2_f32_bf16 v116, v186, v36, 0
    v_dot2_f32_bf16 v117, v186, v37, 0
    v_dot2_f32_bf16 v118, v187, v36, 0
    v_dot2_f32_bf16 v119, v187, v37, 0
    v_dot2_f32_bf16 v120, v188, v36, 0
    v_dot2_f32_bf16 v121, v188, v37, 0
    v_dot2_f32_bf16 v122, v189, v36, 0
    v_dot2_f32_bf16 v123, v189, v37, 0
    v_dot2_f32_bf16 v124, v190, v36, 0
    v_dot2_f32_bf16 v125, v190, v37, 0
    v_dot2_f32_bf16 v126, v191, v36, 0
    v_dot2_f32_bf16 v127, v191, v37, 0
    v_dot2_f32_bf16 v128, v192, v36, 0
    v_dot2_f32_bf16 v129, v192, v37, 0
    v_dot2_f32_bf16 v130, v193, v36, 0
    v_dot2_f32_bf16 v131, v193, v37, 0
    v_dot2_f32_bf16 v132, v194, v36, 0
    v_dot2_f32_bf16 v133, v194, v37, 0
    v_dot2_f32_bf16 v134, v195, v36, 0
    v_dot2_f32_bf16 v135, v195, v37, 0
    v_dot2_f32_bf16 v64, v196, v38, v64
    v_dot2_f32_bf16 v65, v196, v39, v65
    v_dot2_f32_bf16 v66, v197, v38, v66
    v_dot2_f32_bf16 v67, v197, v39, v67
    v_dot2_f32_bf16 v68, v198, v38, v68
    v_dot2_f32_bf16 v69, v198, v39, v69
    v_dot2_f32_bf16 v70, v199, v38, v70
    v_dot2_f32_bf16 v71, v199, v39, v71
    v_dot2_f32_bf16 v72, v200, v38, v72
    v_dot2_f32_bf16 v73, v200, v39, v73
    v_dot2_f32_bf16 v74, v201, v38, v74
    v_dot2_f32_bf16 v75, v201, v39, v75
    v_dot2_f32_bf16 v76, v202, v38, v76
    v_dot2_f32_bf16 v77, v202, v39, v77
    v_dot2_f32_bf16 v78, v203, v38, v78
    v_dot2_f32_bf16 v79, v203, v39, v79
    v_dot2_f32_bf16 v80, v204, v38, v80
    v_dot2_f32_bf16 v81, v204, v39, v81
    v_dot2_f32_bf16 v82, v205, v38, v82
    v_dot2_f32_bf16 v83, v205, v39, v83
    v_dot2_f32_bf16 v84, v206, v38, v84
    v_dot2_f32_bf16 v85, v206, v39, v85
    v_dot2_f32_bf16 v86, v207, v38, v86
    v_dot2_f32_bf16 v87, v207, v39, v87
    v_dot2_f32_bf16 v88, v208, v38, v88
    v_dot2_f32_bf16 v89, v208, v39, v89
    v_dot2_f32_bf16 v90, v209, v38, v90
    v_dot2_f32_bf16 v91, v209, v39, v91
    v_dot2_f32_bf16 v92, v210, v38, v92
    v_dot2_f32_bf16 v93, v210, v39, v93
    v_dot2_f32_bf16 v94, v211, v38, v94
    v_dot2_f32_bf16 v95, v211, v39, v95
    v_dot2_f32_bf16 v96, v212, v38, v96
    v_dot2_f32_bf16 v97, v212, v39, v97
    v_dot2_f32_bf16 v98, v213, v38, v98
    v_dot2_f32_bf16 v99, v213, v39, v99
    v_dot2_f32_bf16 v100, v214, v38, v100
    v_dot2_f32_bf16 v101, v214, v39, v101
    v_dot2_f32_bf16 v102, v215, v38, v102
    v_dot2_f32_bf16 v103, v215, v39, v103
    v_dot2_f32_bf16 v104, v216, v38, v104
    v_dot2_f32_bf16 v105, v216, v39, v105
    v_dot2_f32_bf16 v106, v217, v38, v106
    v_dot2_f32_bf16 v107, v217, v39, v107
    v_dot2_f32_bf16 v108, v218, v38, v108
    v_dot2_f32_bf16 v109, v218, v39, v109
    v_dot2_f32_bf16 v110, v219, v38, v110
    v_dot2_f32_bf16 v111, v219, v39, v111
    v_dot2_f32_bf16 v112, v220, v38, v112
    v_dot2_f32_bf16 v113, v220, v39, v113
    v_dot2_f32_bf16 v114, v221, v38, v114
    v_dot2_f32_bf16 v115, v221, v39, v115
    v_dot2_f32_bf16 v116, v222, v38, v116
    v_dot2_f32_bf16 v117, v222, v39, v117
    v_dot2_f32_bf16 v118, v223, v38, v118
    v_dot2_f32_bf16 v119, v223, v39, v119
    v_dot2_f32_bf16 v120, v224, v38, v120
    v_dot2_f32_bf16 v121, v224, v39, v121
    v_dot2_f32_bf16 v122, v225, v38, v122
    v_dot2_f32_bf16 v123, v225, v39, v123
    v_dot2_f32_bf16 v124, v226, v38, v124
    v_dot2_f32_bf16 v125, v226, v39, v125
    v_dot2_f32_bf16 v126, v227, v38, v126
    v_dot2_f32_bf16 v127, v227, v39, v127
    v_dot2_f32_bf16 v128, v228, v38, v128
    v_dot2_f32_bf16 v129, v228, v39, v129
    v_dot2_f32_bf16 v130, v229, v38, v130
    v_dot2_f32_bf16 v131, v229, v39, v131
    v_dot2_f32_bf16 v132, v230, v38, v132
    v_dot2_f32_bf16 v133, v230, v39, v133
    v_dot2_f32_bf16 v134, v231, v38, v134
    v_dot2_f32_bf16 v135, v231, v39, v135
    v_permlane32_swap_b32 v64, v68
    v_permlane32_swap_b32 v65, v69
    v_permlane32_swap_b32 v66, v70
    v_permlane32_swap_b32 v67, v71
    v_add_f32 v64, v64, v68
    v_add_f32 v65, v65, v69
    v_add_f32 v66, v66, v70
    v_add_f32 v67, v67, v71
    s_nop 0
    v_permlane16_swap_b32 v64, v66
    v_permlane16_swap_b32 v65, v67
    v_add_f32 v64, v64, v66
    v_add_f32 v65, v65, v67
    s_nop 0
    v_add_f32_dpp v64, v64, v64 row_ror:8 row_mask:0xf bank_mask:0xf
    v_add_f32_dpp v65, v65, v65 row_ror:8 row_mask:0xf bank_mask:0xf
    v_permlane32_swap_b32 v72, v76
    v_permlane32_swap_b32 v73, v77
    v_permlane32_swap_b32 v74, v78
    v_permlane32_swap_b32 v75, v79
    v_add_f32 v72, v72, v76
    v_add_f32 v73, v73, v77
    v_add_f32 v74, v74, v78
    v_add_f32 v75, v75, v79
    s_nop 0
    v_permlane16_swap_b32 v72, v74
    v_permlane16_swap_b32 v73, v75
    v_add_f32 v72, v72, v74
    v_add_f32 v73, v73, v75
    s_nop 0
    v_add_f32_dpp v72, v72, v72 row_ror:8 row_mask:0xf bank_mask:0xf
    v_add_f32_dpp v73, v73, v73 row_ror:8 row_mask:0xf bank_mask:0xf
    v_permlane32_swap_b32 v80, v84
    v_permlane32_swap_b32 v81, v85
    v_permlane32_swap_b32 v82, v86
    v_permlane32_swap_b32 v83, v87
    v_add_f32 v80, v80, v84
    v_add_f32 v81, v81, v85
    v_add_f32 v82, v82, v86
    v_add_f32 v83, v83, v87
    s_nop 0
    v_permlane16_swap_b32 v80, v82
    v_permlane16_swap_b32 v81, v83
    v_add_f32 v80, v80, v82
    v_add_f32 v81, v81, v83
    s_nop 0
    v_add_f32_dpp v80, v80, v80 row_ror:8 row_mask:0xf bank_mask:0xf
    v_add_f32_dpp v81, v81, v81 row_ror:8 row_mask:0xf bank_mask:0xf
    v_permlane32_swap_b32 v88, v92
    v_permlane32_swap_b32 v89, v93
    v_permlane32_swap_b32 v90, v94
    v_permlane32_swap_b32 v91, v95
    v_add_f32 v88, v88, v92
    v_add_f32 v89, v89, v93
    v_add_f32 v90, v90, v94
    v_add_f32 v91, v91, v95
    s_nop 0
    v_permlane16_swap_b32 v88, v90
    v_permlane16_swap_b32 v89, v91
    v_add_f32 v88, v88, v90
    v_add_f32 v89, v89, v91
    s_nop 0
    v_add_f32_dpp v88, v88, v88 row_ror:8 row_mask:0xf bank_mask:0xf
    v_add_f32_dpp v89, v89, v89 row_ror:8 row_mask:0xf bank_mask:0xf
    v_permlane32_swap_b32 v96, v100
    v_permlane32_swap_b32 v97, v101
    v_permlane32_swap_b32 v98, v102
    v_permlane32_swap_b32 v99, v103
    v_add_f32 v96, v96, v100
    v_add_f32 v97, v97, v101
    v_add_f32 v98, v98, v102
    v_add_f32 v99, v99, v103
    s_nop 0
    v_permlane16_swap_b32 v96, v98
    v_permlane16_swap_b32 v97, v99
    v_add_f32 v96, v96, v98
    v_add_f32 v97, v97, v99
    s_nop 0
    v_add_f32_dpp v96, v96, v96 row_ror:8 row_mask:0xf bank_mask:0xf
    v_add_f32_dpp v97, v97, v97 row_ror:8 row_mask:0xf bank_mask:0xf
    v_permlane32_swap_b32 v104, v108
    v_permlane32_swap_b32 v105, v109
    v_permlane32_swap_b32 v106, v110
    v_permlane32_swap_b32 v107, v111
    v_add_f32 v104, v104, v108
    v_add_f32 v105, v105, v109
    v_add_f32 v106, v106, v110
    v_add_f32 v107, v107, v111
    s_nop 0
    v_permlane16_swap_b32 v104, v106
    v_permlane16_swap_b32 v105, v107
    v_add_f32 v104, v104, v106
    v_add_f32 v105, v105, v107
    s_nop 0
    v_add_f32_dpp v104, v104, v104 row_ror:8 row_mask:0xf bank_mask:0xf
    v_add_f32_dpp v105, v105, v105 row_ror:8 row_mask:0xf bank_mask:0xf
    v_permlane32_swap_b32 v112, v116
    v_permlane32_swap_b32 v113, v117
    v_permlane32_swap_b32 v114, v118
    v_permlane32_swap_b32 v115, v119
    v_add_f32 v112, v112, v116
    v_add_f32 v113, v113, v117
    v_add_f32 v114, v114, v118
    v_add_f32 v115, v115, v119
    s_nop 0
    v_permlane16_swap_b32 v112, v114
    v_permlane16_swap_b32 v113, v115
    v_add_f32 v112, v112, v114
    v_add_f32 v113, v113, v115
    s_nop 0
    v_add_f32_dpp v112, v112, v112 row_ror:8 row_mask:0xf bank_mask:0xf
    v_add_f32_dpp v113, v113, v113 row_ror:8 row_mask:0xf bank_mask:0xf
    v_permlane32_swap_b32 v120, v124
    v_permlane32_swap_b32 v121, v125
    v_permlane32_swap_b32 v122, v126
    v_permlane32_swap_b32 v123, v127
    v_add_f32 v120, v120, v124
    v_add_f32 v121, v121, v125
    v_add_f32 v122, v122, v126
    v_add_f32 v123, v123, v127
    s_nop 0
    v_permlane16_swap_b32 v120, v122
    v_permlane16_swap_b32 v121, v123
    v_add_f32 v120, v120, v122
    v_add_f32 v121, v121, v123
    s_nop 0
    v_add_f32_dpp v120, v120, v120 row_ror:8 row_mask:0xf bank_mask:0xf
    v_add_f32_dpp v121, v121, v121 row_ror:8 row_mask:0xf bank_mask:0xf
    v_permlane32_swap_b32 v128, v132
    v_permlane32_swap_b32 v129, v133
    v_permlane32_swap_b32 v130, v134
    v_permlane32_swap_b32 v131, v135
    v_add_f32 v128, v128, v132
    v_add_f32 v129, v129, v133
    v_add_f32 v130, v130, v134
    v_add_f32 v131, v131, v135
    s_nop 0
    v_permlane16_swap_b32 v128, v130
    v_permlane16_swap_b32 v129, v131
    v_add_f32 v128, v128, v130
    v_add_f32 v129, v129, v131
    s_nop 0
    v_add_f32_dpp v128, v128, v128 row_ror:8 row_mask:0xf bank_mask:0xf
    v_add_f32_dpp v129, v129, v129 row_ror:8 row_mask:0xf bank_mask:0xf
    s_mul_i32 s60, s53, 2304
    v_add_u32 v12, s60, v13
    ds_write_b64 v12, v[64:65] offset:20480
    ds_write_b64 v12, v[72:73] offset:20736
    ds_write_b64 v12, v[80:81] offset:20992
    ds_write_b64 v12, v[88:89] offset:21248
    ds_write_b64 v12, v[96:97] offset:21504
    ds_write_b64 v12, v[104:105] offset:21760
    ds_write_b64 v12, v[112:113] offset:22016
    ds_write_b64 v12, v[120:121] offset:22272
    ds_write_b64 v12, v[128:129] offset:22528
    s_waitcnt lgkmcnt(0)
    s_barrier
    v_lshlrev_b32 v12, 2, v0
    ds_read_b32 v20, v12 offset:20480
    ds_read_b32 v21, v12 offset:22784
    ds_read_b32 v22, v12 offset:25088
    ds_read_b32 v23, v12 offset:27392
    ds_read_b32 v24, v12 offset:29696
    ds_read_b32 v25, v12 offset:32000
    ds_read_b32 v26, v12 offset:34304
    ds_read_b32 v27, v12 offset:36608
    s_waitcnt lgkmcnt(0)
    v_add_f32 v20, v20, v24
    v_add_f32 v21, v21, v25
    v_add_f32 v22, v22, v26
    v_add_f32 v23, v23, v27
    v_add_f32 v20, v20, v22
    v_add_f32 v21, v21, v23
    v_add_f32 v20, v20, v21
    v_mov_b32 v21, s52
    v_lshrrev_b32 v12, 4, v0
    v_mul_u32_u24 v12, 6144, v12
    v_and_b32 v14, 15, v0
    v_lshlrev_b32 v14, 3, v14
    s_lshl_b32 s60, s67, 7
    s_add_u32 s60, s60, 524288
    v_add3_u32 v12, v12, v14, s60
    buffer_store_dwordx2 v[20:21], v12, s[12:15], 0 offen sc0 sc1
    s_cmp_eq_u32 s53, 0
    s_cbranch_scc0 L_aout_56
    v_lshlrev_b32 v12, 2, v0
    ds_read_b32 v20, v12 offset:22528
    ds_read_b32 v21, v12 offset:24832
    ds_read_b32 v22, v12 offset:27136
    ds_read_b32 v23, v12 offset:29440
    ds_read_b32 v24, v12 offset:31744
    ds_read_b32 v25, v12 offset:34048
    ds_read_b32 v26, v12 offset:36352
    ds_read_b32 v27, v12 offset:38656
    s_waitcnt lgkmcnt(0)
    v_add_f32 v20, v20, v24
    v_add_f32 v21, v21, v25
    v_add_f32 v22, v22, v26
    v_add_f32 v23, v23, v27
    v_add_f32 v20, v20, v22
    v_add_f32 v21, v21, v23
    v_add_f32 v20, v20, v21
    v_mov_b32 v21, s52
    v_lshrrev_b32 v12, 4, v0
    v_add_u32 v12, 32, v12
    v_mul_u32_u24 v12, 6144, v12
    v_and_b32 v14, 15, v0
    v_lshlrev_b32 v14, 3, v14
    s_lshl_b32 s60, s67, 7
    s_add_u32 s60, s60, 524288
    v_add3_u32 v12, v12, v14, s60
    buffer_store_dwordx2 v[20:21], v12, s[12:15], 0 offen sc0 sc1
L_aout_56:
    s_endpgm
L_end:
    s_endpgm
.section .rodata,"a"
.p2align 6
.amdhsa_kernel gated_mix__compressed_kv_cla__gqa_block_cached__decode_kernel
  .amdhsa_next_free_vgpr 256
  .amdhsa_next_free_sgpr 102
  .amdhsa_accum_offset 256
  .amdhsa_group_segment_fixed_size 0
  .amdhsa_kernarg_size 120
  .amdhsa_user_sgpr_count 2
  .amdhsa_user_sgpr_kernarg_segment_ptr 1
  .amdhsa_system_sgpr_workgroup_id_x 1
  .amdhsa_float_denorm_mode_32 3
.end_amdhsa_kernel
```
